```python
import torch

def _softmax(x, axis=-1):
    return torch.softmax(x, dim=axis)
def _gelu(x):
    return torch.nn.functional.gelu(x, approximate="tanh")
def _silu(x):
    return torch.nn.functional.silu(x)
def _sigmoid(x):
    return torch.sigmoid(x)
def _layernorm(x, axis=-1, eps=1e-5):
    m = x.mean(dim=axis, keepdim=True)
    v = x.var(dim=axis, keepdim=True, unbiased=False)
    return (x - m) / torch.sqrt(v + eps)
def _scatter_add(tgt, idx, src, axis=0):
    return tgt.clone().index_add_(axis, idx, src)
def _segment_sum(src, seg, n):
    out = torch.zeros((n,) + src.shape[1:], dtype=src.dtype)
    return out.index_add_(0, seg, src)
def _pad(x, pw):
    flat = tuple(v for pair in reversed(pw) for v in pair)
    return torch.nn.functional.pad(x, flat)

kernel_name = 'interleave_layers__linear_attn_block__mixer_channel_mlp__prompt'

def setup_inputs():

    _w = (lambda a: (lambda t: t.to(torch.bfloat16) if t.is_floating_point() else t)(torch.as_tensor(a)))
    def _A_setup():
        B, S, D = 1, 2048, 512
        return {
            "x": _w((lambda *s: torch.randn(*s, dtype=torch.bfloat16) * 0.05)(B, S, D)),
            "wqkv": _w((lambda *s: torch.randn(*s, dtype=torch.bfloat16) * 0.1)(D, 3 * D)),
            "wo": _w((lambda *s: torch.randn(*s, dtype=torch.bfloat16) * 0.05)(D, D)),
        }
    _A_in = _A_setup()

    def _B_setup():
        B, S, D, F = 1, 2048, 512, 1792
        return {
            "x": _w((lambda *s: torch.randn(*s, dtype=torch.bfloat16) * 0.05)(B, S, D)),
            "w1": _w((lambda *s: torch.randn(*s, dtype=torch.bfloat16) * 3.2)(D, F) * (D ** -0.5)),
            "b1": _w((lambda *s: torch.randn(*s, dtype=torch.bfloat16) * 0.8)(F)),
            "w2": _w((lambda *s: torch.randn(*s, dtype=torch.bfloat16) * 0.8)(F, D) * (F ** -0.5)),
            "b2": _w((lambda *s: torch.randn(*s, dtype=torch.bfloat16) * 0.8)(D)),
        }
    _B_in = _B_setup()

    return {
        "A_x": _A_in["x"],
        "A_wqkv": _A_in["wqkv"],
        "A_wo": _A_in["wo"],
        "B_x": _B_in["x"],
        "B_w1": _B_in["w1"],
        "B_b1": _B_in["b1"],
        "B_w2": _B_in["w2"],
        "B_b2": _B_in["b2"],
    }

def reference(A_x, A_wqkv, A_wo, B_x, B_w1, B_b1, B_w2, B_b2):
    def _A_ref(x, wqkv, wo):
        B, S, D = x.shape
        H = 32; Dh = D // H
        qkv = (lambda x, *d: x.permute(*d))((x @ wqkv).reshape(B, S, 3, H, Dh), 2, 0, 3, 1, 4)
        q, k, v = qkv[0], qkv[1], qkv[2]
        phi = lambda t: torch.where(t > 0, t + 1, torch.exp(t)) + 1e-6
        pq, pk = phi(q), phi(k)
        kv = torch.einsum("bhsd,bhse->bhde", pk, v)
        z = torch.einsum("bhsd->bhd", pk)
        num = torch.einsum("bhqd,bhde->bhqe", pq, kv)
        den = torch.einsum("bhqd,bhd->bhq", pq, z)[..., None] + 1e-6
        o = num / den
        return (lambda x, *d: x.permute(*d))(o, 0, 2, 1, 3).reshape(B, S, D) @ wo

    def _B_ref(x, w1, b1, w2, b2):
        y = _layernorm(x, axis=-1)
        h = _gelu(torch.einsum("bsd,df->bsf", y, w1) + b1)
        return torch.einsum("bsf,fd->bsd", h, w2) + b2

    x = A_x
    x = x + _A_ref(_layernorm(x, axis=-1), A_wqkv, A_wo)
    x = x + _B_ref(_layernorm(x, axis=-1), B_w1, B_b1, B_w2, B_b2)
    x = x + _A_ref(_layernorm(x, axis=-1), A_wqkv, A_wo)
    x = x + _B_ref(_layernorm(x, axis=-1), B_w1, B_b1, B_w2, B_b2)
    return x
```

```asm
; @launch grid=(256,1,1) block=(256,1,1) lds=163840
.amdgcn_target "amdgcn-amd-amdhsa--gfx950"
.text
.globl interleave_layers__linear_attn_block__mixer_channel_mlp__prompt_kernel
.p2align 8
.type interleave_layers__linear_attn_block__mixer_channel_mlp__prompt_kernel,@function
interleave_layers__linear_attn_block__mixer_channel_mlp__prompt_kernel:
s_cmp_ge_u32 s2, 256
s_cbranch_scc1 Lend
s_getpc_b64 s[86:87]
Lpc0:
s_lshr_b32 s54, s2, 3
s_lshl_b32 s54, s54, 12
v_lshlrev_b32 v1, 4, v0
v_add_u32 v1, s54, v1
v_min_u32 v1, Lend-Lpc0-16, v1
v_and_b32 v1, -4, v1
global_load_dwordx4 v[20:23], v1, s[86:87]
s_load_dwordx16 s[64:79], s[0:1], 0
s_load_dwordx4 s[80:83], s[0:1], 64
s_load_dwordx2 s[84:85], s[0:1], 80
v_lshrrev_b32 v1, 6, v0
v_and_b32 v2, 63, v0
v_readfirstlane_b32 s48, v1
s_mov_b32 s53, s2
s_and_b32 s54, s2, 7
s_lshr_b32 s55, s2, 3
s_and_b32 s52, s55, 15
s_lshr_b32 s55, s55, 4
s_lshl_b32 s51, s54, 1
s_add_u32 s51, s51, s55
s_lshr_b32 s54, s52, 3
s_lshl_b32 s49, s51, 1
s_add_u32 s49, s49, s54
s_and_b32 s50, s52, 7
s_mov_b32 s60, 0x3b000000
v_lshlrev_b32 v255, 4, v2
v_lshrrev_b32 v253, 3, v2
v_bfe_u32 v3, v2, 1, 2
v_bfe_u32 v4, v2, 4, 2
v_xor_b32 v3, v3, v4
v_lshlrev_b32 v3, 5, v3
v_and_b32 v4, 1, v2
v_lshl_add_u32 v252, v4, 4, v3
v_lshrrev_b32 v3, 2, v2
v_lshlrev_b32 v3, 7, v3
v_bfe_u32 v4, v2, 3, 2
v_lshl_add_u32 v3, v4, 5, v3
v_and_b32 v4, 3, v2
v_lshl_add_u32 v254, v4, 3, v3
v_mov_b32 v3, 0x3f803f80
v_accvgpr_write_b32 a236, v3
v_accvgpr_write_b32 a237, v3
v_accvgpr_write_b32 a238, v3
v_accvgpr_write_b32 a239, v3
s_waitcnt lgkmcnt(0)
s_mov_b32 s8, s64
s_mov_b32 s9, s65
s_mov_b32 s10, 2097152
s_mov_b32 s11, 0x20000
s_mov_b32 s12, s66
s_mov_b32 s13, s67
s_mov_b32 s14, 1572864
s_mov_b32 s15, 0x20000
s_mov_b32 s16, s68
s_mov_b32 s17, s69
s_mov_b32 s18, 524288
s_mov_b32 s19, 0x20000
s_mov_b32 s20, s72
s_mov_b32 s21, s73
s_mov_b32 s22, 1835008
s_mov_b32 s23, 0x20000
s_mov_b32 s24, s76
s_mov_b32 s25, s77
s_mov_b32 s26, 1835008
s_mov_b32 s27, 0x20000
s_mov_b32 s28, s84
s_mov_b32 s29, s85
s_mov_b32 s30, 268435456
s_mov_b32 s31, 0x20000
s_mov_b32 s32, s80
s_mov_b32 s33, s81
s_mov_b32 s34, 2097152
s_mov_b32 s35, 0x20000
s_mov_b32 s36, s74
s_mov_b32 s37, s75
s_mov_b32 s38, 3584
s_mov_b32 s39, 0x20000
s_mov_b32 s40, s78
s_mov_b32 s41, s79
s_mov_b32 s42, 1024
s_mov_b32 s43, 0x20000
s_mov_b32 s44, s82
s_mov_b32 s45, s83
v_lshlrev_b32 v231, 3, v255
s_lshl_b32 s54, s49, 3
s_add_u32 s54, s54, s50
s_lshl_b32 s54, s54, 2
s_add_u32 s54, s54, s48
s_lshl_b32 s54, s54, 11
s_mov_b64 exec, 0xffff
buffer_load_dword a7, v231, s[8:11], s54 offen
s_mov_b64 exec, -1
s_lshr_b32 s54, s53, 3
s_lshl_b32 s54, s54, 2
s_add_u32 s54, s54, s48
s_mul_i32 s54, s54, 12288
v_lshrrev_b32 v192, 8, v255
v_lshl_add_u32 v192, v192, 10, v231
buffer_load_dword a8, v192, s[12:15], s54 offen offset:1024
s_cmp_ge_u32 s53, 64
s_cbranch_scc1 Z1
v_lshlrev_b32 v1, 4, v0
s_lshl_b32 s54, s53, 12
v_mov_b32 v4, 0
v_mov_b32 v5, 0
v_mov_b32 v6, 0
v_mov_b32 v7, 0
buffer_store_dwordx4 v[4:7], v1, s[28:31], s54 offen sc1
Z1:
v_lshrrev_b32 v16, 2, v255
s_lshl_b32 s54, s52, 8
s_lshl_b32 s55, s50, 7
buffer_load_dword v240, v16, s[36:39], s54 offen
buffer_load_dword v242, v16, s[40:43], s55 offen
v_xor_b32 v8, 0, v255
v_xor_b32 v9, 16, v255
v_xor_b32 v10, 32, v255
v_xor_b32 v11, 48, v255
v_xor_b32 v12, 64, v255
v_xor_b32 v13, 80, v255
v_xor_b32 v14, 96, v255
v_xor_b32 v15, 112, v255
s_lshl_b32 s55, s48, 14
s_lshl_b32 s54, s49, 16
s_add_u32 s54, s54, s55
s_add_u32 s55, s55, 94208
s_add_u32 m0, s55, 0
s_add_u32 s56, s54, 0
buffer_load_dwordx4 v8, s[8:11], s56 offen offset:0 lds
buffer_load_dwordx4 v9, s[8:11], s56 offen offset:1024 lds
buffer_load_dwordx4 v10, s[8:11], s56 offen offset:2048 lds
buffer_load_dwordx4 v11, s[8:11], s56 offen offset:3072 lds
s_add_u32 m0, s55, 4096
s_add_u32 s56, s54, 4096
buffer_load_dwordx4 v12, s[8:11], s56 offen offset:0 lds
buffer_load_dwordx4 v13, s[8:11], s56 offen offset:1024 lds
buffer_load_dwordx4 v14, s[8:11], s56 offen offset:2048 lds
buffer_load_dwordx4 v15, s[8:11], s56 offen offset:3072 lds
s_add_u32 m0, s55, 8192
s_add_u32 s56, s54, 8192
buffer_load_dwordx4 v8, s[8:11], s56 offen offset:0 lds
buffer_load_dwordx4 v9, s[8:11], s56 offen offset:1024 lds
buffer_load_dwordx4 v10, s[8:11], s56 offen offset:2048 lds
buffer_load_dwordx4 v11, s[8:11], s56 offen offset:3072 lds
s_add_u32 m0, s55, 12288
s_add_u32 s56, s54, 12288
buffer_load_dwordx4 v12, s[8:11], s56 offen offset:0 lds
buffer_load_dwordx4 v13, s[8:11], s56 offen offset:1024 lds
buffer_load_dwordx4 v14, s[8:11], s56 offen offset:2048 lds
buffer_load_dwordx4 v15, s[8:11], s56 offen offset:3072 lds
s_lshl_b32 s58, s50, 7
v_mul_u32_u24 v232, 3072, v253
v_add_u32 v232, v232, v252
v_add_u32 v233, 23552, v232
v_add_u32 v234, 47104, v232
v_add_u32 v235, 70656, v232
s_lshr_b32 s54, s48, 1
s_mul_i32 s54, s54, 98304
s_add_u32 s94, s58, s54
s_and_b32 s54, s48, 1
s_lshl_b32 s54, s54, 10
s_add_u32 s94, s94, s54
s_lshl_b32 s95, s48, 12
s_cmp_lt_u32 s48, 3
s_cselect_b32 s88, 196608, 0
s_cselect_b32 s89, 16384, 0
s_add_u32 s88, s88, s94
s_add_u32 s89, s89, s95
s_add_u32 m0, s95, 0
s_add_u32 s47, s94, 1024
buffer_load_dwordx4 v232, s[12:15], s47 offen offset:0 lds
buffer_load_dwordx4 v233, s[12:15], s47 offen offset:1024 lds
buffer_load_dwordx4 v234, s[12:15], s47 offen offset:2048 lds
buffer_load_dwordx4 v235, s[12:15], s47 offen offset:3072 lds
s_add_u32 m0, s95, 16384
s_add_u32 s47, s94, 197632
buffer_load_dwordx4 v232, s[12:15], s47 offen offset:0 lds
buffer_load_dwordx4 v233, s[12:15], s47 offen offset:1024 lds
buffer_load_dwordx4 v234, s[12:15], s47 offen offset:2048 lds
buffer_load_dwordx4 v235, s[12:15], s47 offen offset:3072 lds
s_add_u32 m0, s95, 32768
s_add_u32 s47, s94, 394240
buffer_load_dwordx4 v232, s[12:15], s47 offen offset:0 lds
buffer_load_dwordx4 v233, s[12:15], s47 offen offset:1024 lds
buffer_load_dwordx4 v234, s[12:15], s47 offen offset:2048 lds
buffer_load_dwordx4 v235, s[12:15], s47 offen offset:3072 lds
s_getreg_b32 s54, hwreg(HW_REG_XCC_ID, 0, 3)
s_lshl_b32 s54, s54, 3
s_lshl_b64 s[64:65], 1, s54
v_mov_b32 v16, s64
v_mov_b32 v17, s65
s_lshl_b32 s54, s51, 3
v_mov_b32 v18, s54
s_cmp_eq_u32 s48, 0
s_cselect_b64 exec, 1, 0
global_atomic_add_x2 v18, v[16:17], s[44:45] offset:128 sc1
s_mov_b64 exec, -1
v_lshrrev_b32 v2, 4, v255
v_bfe_u32 v3, v2, 5, 1
v_and_b32 v4, 7, v2
v_xor_b32 v3, v3, v4
v_lshlrev_b32 v3, 4, v3
v_bfe_u32 v4, v2, 4, 1
v_lshl_add_u32 v3, v4, 3, v3
v_and_b32 v4, 15, v2
v_lshl_add_u32 v3, v4, 10, v3
s_and_b32 s54, s48, 1
s_lshl_b32 s54, s54, 15
s_add_u32 s54, s54, 94208
v_add_u32 v224, s54, v3
s_lshl_b32 s54, s48, 14
s_lshl_b32 s55, s50, 7
s_add_u32 s54, s54, s55
s_add_u32 s54, s54, 94208
v_add_u32 v228, s54, v3
v_xor_b32 v225, 32, v224
v_xor_b32 v229, 32, v228
v_xor_b32 v226, 64, v224
v_xor_b32 v230, 64, v228
v_xor_b32 v227, 96, v224
v_xor_b32 v231, 96, v228
s_waitcnt vmcnt(13)
v_lshrrev_b32 v2, 1, v255
v_add_u32 v2, 159744, v2
v_and_b32 v241, 0xffff0000, v240
v_lshlrev_b32 v240, 16, v240
v_mul_f32 v240, 0x3eeff558, v240
v_mul_f32 v241, 0x3eeff558, v241
ds_write_b64 v2, v[240:241] offset:1536
v_and_b32 v243, 0xffff0000, v242
v_lshlrev_b32 v242, 16, v242
ds_write_b64 v2, v[242:243] offset:2048
v_mov_b32 v4, 0
ds_write_b32 v2, v4
s_barrier
v_accvgpr_read_b32 v240, a236
v_mov_b32 v236, 0
v_mov_b32 v237, 0
v_mov_b32 v238, 0
v_mov_b32 v239, 0
s_lshl_b32 s54, s48, 8
s_or_b32 s54, s54, s53
v_mov_b32 v194, 0
v_mov_b32 v195, 1
s_cmp_lt_u32 s54, 64
s_cselect_b64 exec, 1, 0
global_atomic_add v194, v195, s[44:45] sc1
s_mov_b64 exec, -1
ds_read_b64 v[0:1], v224 offset:0
ds_read_b64 v[2:3], v225 offset:0
ds_read_b64 v[64:65], v224 offset:16384
ds_read_b64 v[66:67], v225 offset:16384
ds_read_b64 v[4:5], v226 offset:0
ds_read_b64 v[6:7], v227 offset:0
ds_read_b64 v[68:69], v226 offset:16384
ds_read_b64 v[70:71], v227 offset:16384
ds_read_b64 v[8:9], v224 offset:128
ds_read_b64 v[10:11], v225 offset:128
ds_read_b64 v[72:73], v224 offset:16512
ds_read_b64 v[74:75], v225 offset:16512
s_waitcnt lgkmcnt(8)
ds_read_b64 v[12:13], v226 offset:128
s_add_u32 m0, s95, 49152
s_add_u32 s47, s94, 590848
buffer_load_dwordx4 v232, s[12:15], s47 offen offset:0 lds
v_dot2_f32_bf16 v236, v0, v240, v236
v_dot2_f32_bf16 v237, v0, v0, v237
v_dot2_f32_bf16 v238, v64, v240, v238
v_dot2_f32_bf16 v239, v64, v64, v239
ds_read_b64 v[14:15], v227 offset:128
v_dot2_f32_bf16 v236, v1, v240, v236
v_dot2_f32_bf16 v237, v1, v1, v237
v_dot2_f32_bf16 v238, v65, v240, v238
v_dot2_f32_bf16 v239, v65, v65, v239
ds_read_b64 v[76:77], v226 offset:16512
v_dot2_f32_bf16 v236, v2, v240, v236
v_dot2_f32_bf16 v237, v2, v2, v237
v_dot2_f32_bf16 v238, v66, v240, v238
v_dot2_f32_bf16 v239, v66, v66, v239
ds_read_b64 v[78:79], v227 offset:16512
buffer_load_dwordx4 v233, s[12:15], s47 offen offset:1024 lds
v_dot2_f32_bf16 v236, v3, v240, v236
v_dot2_f32_bf16 v237, v3, v3, v237
v_dot2_f32_bf16 v238, v67, v240, v238
v_dot2_f32_bf16 v239, v67, v67, v239
s_waitcnt lgkmcnt(8)
ds_read_b64 v[16:17], v224 offset:256
v_dot2_f32_bf16 v236, v4, v240, v236
v_dot2_f32_bf16 v237, v4, v4, v237
v_dot2_f32_bf16 v238, v68, v240, v238
v_dot2_f32_bf16 v239, v68, v68, v239
ds_read_b64 v[18:19], v225 offset:256
v_dot2_f32_bf16 v236, v5, v240, v236
v_dot2_f32_bf16 v237, v5, v5, v237
v_dot2_f32_bf16 v238, v69, v240, v238
v_dot2_f32_bf16 v239, v69, v69, v239
ds_read_b64 v[80:81], v224 offset:16640
buffer_load_dwordx4 v234, s[12:15], s47 offen offset:2048 lds
v_dot2_f32_bf16 v236, v6, v240, v236
v_dot2_f32_bf16 v237, v6, v6, v237
v_dot2_f32_bf16 v238, v70, v240, v238
v_dot2_f32_bf16 v239, v70, v70, v239
ds_read_b64 v[82:83], v225 offset:16640
v_dot2_f32_bf16 v236, v7, v240, v236
v_dot2_f32_bf16 v237, v7, v7, v237
v_dot2_f32_bf16 v238, v71, v240, v238
v_dot2_f32_bf16 v239, v71, v71, v239
s_waitcnt lgkmcnt(8)
ds_read_b64 v[20:21], v226 offset:256
v_dot2_f32_bf16 v236, v8, v240, v236
v_dot2_f32_bf16 v237, v8, v8, v237
v_dot2_f32_bf16 v238, v72, v240, v238
v_dot2_f32_bf16 v239, v72, v72, v239
ds_read_b64 v[22:23], v227 offset:256
buffer_load_dwordx4 v235, s[12:15], s47 offen offset:3072 lds
v_dot2_f32_bf16 v236, v9, v240, v236
v_dot2_f32_bf16 v237, v9, v9, v237
v_dot2_f32_bf16 v238, v73, v240, v238
v_dot2_f32_bf16 v239, v73, v73, v239
ds_read_b64 v[84:85], v226 offset:16640
v_dot2_f32_bf16 v236, v10, v240, v236
v_dot2_f32_bf16 v237, v10, v10, v237
v_dot2_f32_bf16 v238, v74, v240, v238
v_dot2_f32_bf16 v239, v74, v74, v239
ds_read_b64 v[86:87], v227 offset:16640
v_dot2_f32_bf16 v236, v11, v240, v236
v_dot2_f32_bf16 v237, v11, v11, v237
v_dot2_f32_bf16 v238, v75, v240, v238
v_dot2_f32_bf16 v239, v75, v75, v239
s_waitcnt lgkmcnt(8)
ds_read_b64 v[24:25], v224 offset:384
s_add_u32 m0, s95, 65536
s_add_u32 s47, s94, 787456
buffer_load_dwordx4 v232, s[12:15], s47 offen offset:0 lds
v_dot2_f32_bf16 v236, v12, v240, v236
v_dot2_f32_bf16 v237, v12, v12, v237
v_dot2_f32_bf16 v238, v76, v240, v238
v_dot2_f32_bf16 v239, v76, v76, v239
ds_read_b64 v[26:27], v225 offset:384
v_dot2_f32_bf16 v236, v13, v240, v236
v_dot2_f32_bf16 v237, v13, v13, v237
v_dot2_f32_bf16 v238, v77, v240, v238
v_dot2_f32_bf16 v239, v77, v77, v239
ds_read_b64 v[88:89], v224 offset:16768
v_dot2_f32_bf16 v236, v14, v240, v236
v_dot2_f32_bf16 v237, v14, v14, v237
v_dot2_f32_bf16 v238, v78, v240, v238
v_dot2_f32_bf16 v239, v78, v78, v239
ds_read_b64 v[90:91], v225 offset:16768
buffer_load_dwordx4 v233, s[12:15], s47 offen offset:1024 lds
v_dot2_f32_bf16 v236, v15, v240, v236
v_dot2_f32_bf16 v237, v15, v15, v237
v_dot2_f32_bf16 v238, v79, v240, v238
v_dot2_f32_bf16 v239, v79, v79, v239
s_waitcnt lgkmcnt(8)
ds_read_b64 v[28:29], v226 offset:384
v_dot2_f32_bf16 v236, v16, v240, v236
v_dot2_f32_bf16 v237, v16, v16, v237
v_dot2_f32_bf16 v238, v80, v240, v238
v_dot2_f32_bf16 v239, v80, v80, v239
ds_read_b64 v[30:31], v227 offset:384
v_dot2_f32_bf16 v236, v17, v240, v236
v_dot2_f32_bf16 v237, v17, v17, v237
v_dot2_f32_bf16 v238, v81, v240, v238
v_dot2_f32_bf16 v239, v81, v81, v239
ds_read_b64 v[92:93], v226 offset:16768
buffer_load_dwordx4 v234, s[12:15], s47 offen offset:2048 lds
v_dot2_f32_bf16 v236, v18, v240, v236
v_dot2_f32_bf16 v237, v18, v18, v237
v_dot2_f32_bf16 v238, v82, v240, v238
v_dot2_f32_bf16 v239, v82, v82, v239
ds_read_b64 v[94:95], v227 offset:16768
v_dot2_f32_bf16 v236, v19, v240, v236
v_dot2_f32_bf16 v237, v19, v19, v237
v_dot2_f32_bf16 v238, v83, v240, v238
v_dot2_f32_bf16 v239, v83, v83, v239
s_waitcnt lgkmcnt(8)
ds_read_b64 v[32:33], v224 offset:512
v_dot2_f32_bf16 v236, v20, v240, v236
v_dot2_f32_bf16 v237, v20, v20, v237
v_dot2_f32_bf16 v238, v84, v240, v238
v_dot2_f32_bf16 v239, v84, v84, v239
ds_read_b64 v[34:35], v225 offset:512
buffer_load_dwordx4 v235, s[12:15], s47 offen offset:3072 lds
v_dot2_f32_bf16 v236, v21, v240, v236
v_dot2_f32_bf16 v237, v21, v21, v237
v_dot2_f32_bf16 v238, v85, v240, v238
v_dot2_f32_bf16 v239, v85, v85, v239
ds_read_b64 v[96:97], v224 offset:16896
v_dot2_f32_bf16 v236, v22, v240, v236
v_dot2_f32_bf16 v237, v22, v22, v237
v_dot2_f32_bf16 v238, v86, v240, v238
v_dot2_f32_bf16 v239, v86, v86, v239
ds_read_b64 v[98:99], v225 offset:16896
v_dot2_f32_bf16 v236, v23, v240, v236
v_dot2_f32_bf16 v237, v23, v23, v237
v_dot2_f32_bf16 v238, v87, v240, v238
v_dot2_f32_bf16 v239, v87, v87, v239
s_waitcnt lgkmcnt(8)
ds_read_b64 v[36:37], v226 offset:512
s_add_u32 m0, s89, 65536
s_add_u32 s47, s88, 787456
buffer_load_dwordx4 v232, s[12:15], s47 offen offset:0 lds
v_dot2_f32_bf16 v236, v24, v240, v236
v_dot2_f32_bf16 v237, v24, v24, v237
v_dot2_f32_bf16 v238, v88, v240, v238
v_dot2_f32_bf16 v239, v88, v88, v239
ds_read_b64 v[38:39], v227 offset:512
v_dot2_f32_bf16 v236, v25, v240, v236
v_dot2_f32_bf16 v237, v25, v25, v237
v_dot2_f32_bf16 v238, v89, v240, v238
v_dot2_f32_bf16 v239, v89, v89, v239
ds_read_b64 v[100:101], v226 offset:16896
v_dot2_f32_bf16 v236, v26, v240, v236
v_dot2_f32_bf16 v237, v26, v26, v237
v_dot2_f32_bf16 v238, v90, v240, v238
v_dot2_f32_bf16 v239, v90, v90, v239
ds_read_b64 v[102:103], v227 offset:16896
buffer_load_dwordx4 v233, s[12:15], s47 offen offset:1024 lds
v_dot2_f32_bf16 v236, v27, v240, v236
v_dot2_f32_bf16 v237, v27, v27, v237
v_dot2_f32_bf16 v238, v91, v240, v238
v_dot2_f32_bf16 v239, v91, v91, v239
s_waitcnt lgkmcnt(8)
ds_read_b64 v[40:41], v224 offset:640
v_dot2_f32_bf16 v236, v28, v240, v236
v_dot2_f32_bf16 v237, v28, v28, v237
v_dot2_f32_bf16 v238, v92, v240, v238
v_dot2_f32_bf16 v239, v92, v92, v239
ds_read_b64 v[42:43], v225 offset:640
v_dot2_f32_bf16 v236, v29, v240, v236
v_dot2_f32_bf16 v237, v29, v29, v237
v_dot2_f32_bf16 v238, v93, v240, v238
v_dot2_f32_bf16 v239, v93, v93, v239
ds_read_b64 v[104:105], v224 offset:17024
buffer_load_dwordx4 v234, s[12:15], s47 offen offset:2048 lds
v_dot2_f32_bf16 v236, v30, v240, v236
v_dot2_f32_bf16 v237, v30, v30, v237
v_dot2_f32_bf16 v238, v94, v240, v238
v_dot2_f32_bf16 v239, v94, v94, v239
ds_read_b64 v[106:107], v225 offset:17024
v_dot2_f32_bf16 v236, v31, v240, v236
v_dot2_f32_bf16 v237, v31, v31, v237
v_dot2_f32_bf16 v238, v95, v240, v238
v_dot2_f32_bf16 v239, v95, v95, v239
s_waitcnt lgkmcnt(8)
ds_read_b64 v[44:45], v226 offset:640
v_dot2_f32_bf16 v236, v32, v240, v236
v_dot2_f32_bf16 v237, v32, v32, v237
v_dot2_f32_bf16 v238, v96, v240, v238
v_dot2_f32_bf16 v239, v96, v96, v239
ds_read_b64 v[46:47], v227 offset:640
buffer_load_dwordx4 v235, s[12:15], s47 offen offset:3072 lds
v_dot2_f32_bf16 v236, v33, v240, v236
v_dot2_f32_bf16 v237, v33, v33, v237
v_dot2_f32_bf16 v238, v97, v240, v238
v_dot2_f32_bf16 v239, v97, v97, v239
ds_read_b64 v[108:109], v226 offset:17024
v_dot2_f32_bf16 v236, v34, v240, v236
v_dot2_f32_bf16 v237, v34, v34, v237
v_dot2_f32_bf16 v238, v98, v240, v238
v_dot2_f32_bf16 v239, v98, v98, v239
ds_read_b64 v[110:111], v227 offset:17024
v_dot2_f32_bf16 v236, v35, v240, v236
v_dot2_f32_bf16 v237, v35, v35, v237
v_dot2_f32_bf16 v238, v99, v240, v238
v_dot2_f32_bf16 v239, v99, v99, v239
s_waitcnt lgkmcnt(8)
ds_read_b64 v[48:49], v224 offset:768
v_lshlrev_b32 v193, 3, v255
s_lshr_b32 s54, s53, 3
s_lshl_b32 s54, s54, 2
s_add_u32 s54, s54, s48
s_mul_i32 s54, s54, 12288
v_lshrrev_b32 v192, 7, v255
v_lshl_add_u32 v192, v192, 11, v193
s_mov_b32 exec_hi, 0
buffer_load_dword a9, v192, s[12:15], s54 offen
s_mov_b64 exec, -1
v_dot2_f32_bf16 v236, v36, v240, v236
v_dot2_f32_bf16 v237, v36, v36, v237
v_dot2_f32_bf16 v238, v100, v240, v238
v_dot2_f32_bf16 v239, v100, v100, v239
ds_read_b64 v[50:51], v225 offset:768
v_dot2_f32_bf16 v236, v37, v240, v236
v_dot2_f32_bf16 v237, v37, v37, v237
v_dot2_f32_bf16 v238, v101, v240, v238
v_dot2_f32_bf16 v239, v101, v101, v239
ds_read_b64 v[112:113], v224 offset:17152
v_dot2_f32_bf16 v236, v38, v240, v236
v_dot2_f32_bf16 v237, v38, v38, v237
v_dot2_f32_bf16 v238, v102, v240, v238
v_dot2_f32_bf16 v239, v102, v102, v239
ds_read_b64 v[114:115], v225 offset:17152
v_lshlrev_b32 v193, 3, v255
s_lshr_b32 s54, s53, 3
s_lshl_b32 s54, s54, 2
s_add_u32 s54, s54, s48
s_lshl_b32 s54, s54, 12
v_bfe_u32 v193, v193, 0, 12
buffer_load_dword a2, v193, s[16:19], s54 offen
v_lshlrev_b32 v193, 3, v255
v_dot2_f32_bf16 v236, v39, v240, v236
v_dot2_f32_bf16 v237, v39, v39, v237
v_dot2_f32_bf16 v238, v103, v240, v238
v_dot2_f32_bf16 v239, v103, v103, v239
s_waitcnt lgkmcnt(8)
ds_read_b64 v[52:53], v226 offset:768
v_dot2_f32_bf16 v236, v40, v240, v236
v_dot2_f32_bf16 v237, v40, v40, v237
v_dot2_f32_bf16 v238, v104, v240, v238
v_dot2_f32_bf16 v239, v104, v104, v239
ds_read_b64 v[54:55], v227 offset:768
v_dot2_f32_bf16 v236, v41, v240, v236
v_dot2_f32_bf16 v237, v41, v41, v237
v_dot2_f32_bf16 v238, v105, v240, v238
v_dot2_f32_bf16 v239, v105, v105, v239
ds_read_b64 v[116:117], v226 offset:17152
v_dot2_f32_bf16 v236, v42, v240, v236
v_dot2_f32_bf16 v237, v42, v42, v237
v_dot2_f32_bf16 v238, v106, v240, v238
v_dot2_f32_bf16 v239, v106, v106, v239
ds_read_b64 v[118:119], v227 offset:17152
v_dot2_f32_bf16 v236, v43, v240, v236
v_dot2_f32_bf16 v237, v43, v43, v237
v_dot2_f32_bf16 v238, v107, v240, v238
v_dot2_f32_bf16 v239, v107, v107, v239
s_waitcnt lgkmcnt(8)
ds_read_b64 v[56:57], v224 offset:896
v_dot2_f32_bf16 v236, v44, v240, v236
v_dot2_f32_bf16 v237, v44, v44, v237
v_dot2_f32_bf16 v238, v108, v240, v238
v_dot2_f32_bf16 v239, v108, v108, v239
ds_read_b64 v[58:59], v225 offset:896
v_dot2_f32_bf16 v236, v45, v240, v236
v_dot2_f32_bf16 v237, v45, v45, v237
v_dot2_f32_bf16 v238, v109, v240, v238
v_dot2_f32_bf16 v239, v109, v109, v239
ds_read_b64 v[120:121], v224 offset:17280
v_dot2_f32_bf16 v236, v46, v240, v236
v_dot2_f32_bf16 v237, v46, v46, v237
v_dot2_f32_bf16 v238, v110, v240, v238
v_dot2_f32_bf16 v239, v110, v110, v239
ds_read_b64 v[122:123], v225 offset:17280
v_dot2_f32_bf16 v236, v47, v240, v236
v_dot2_f32_bf16 v237, v47, v47, v237
v_dot2_f32_bf16 v238, v111, v240, v238
v_dot2_f32_bf16 v239, v111, v111, v239
s_waitcnt lgkmcnt(8)
ds_read_b64 v[60:61], v226 offset:896
v_dot2_f32_bf16 v236, v48, v240, v236
v_dot2_f32_bf16 v237, v48, v48, v237
v_dot2_f32_bf16 v238, v112, v240, v238
v_dot2_f32_bf16 v239, v112, v112, v239
ds_read_b64 v[62:63], v227 offset:896
v_dot2_f32_bf16 v236, v49, v240, v236
v_dot2_f32_bf16 v237, v49, v49, v237
v_dot2_f32_bf16 v238, v113, v240, v238
v_dot2_f32_bf16 v239, v113, v113, v239
ds_read_b64 v[124:125], v226 offset:17280
v_dot2_f32_bf16 v236, v50, v240, v236
v_dot2_f32_bf16 v237, v50, v50, v237
v_dot2_f32_bf16 v238, v114, v240, v238
v_dot2_f32_bf16 v239, v114, v114, v239
ds_read_b64 v[126:127], v227 offset:17280
v_dot2_f32_bf16 v236, v51, v240, v236
v_dot2_f32_bf16 v237, v51, v51, v237
v_dot2_f32_bf16 v238, v115, v240, v238
v_dot2_f32_bf16 v239, v115, v115, v239
s_waitcnt lgkmcnt(8)
ds_read_b64 v[244:245], v228
v_dot2_f32_bf16 v236, v52, v240, v236
v_dot2_f32_bf16 v237, v52, v52, v237
v_dot2_f32_bf16 v238, v116, v240, v238
v_dot2_f32_bf16 v239, v116, v116, v239
ds_read_b64 v[246:247], v229
v_dot2_f32_bf16 v236, v53, v240, v236
v_dot2_f32_bf16 v237, v53, v53, v237
v_dot2_f32_bf16 v238, v117, v240, v238
v_dot2_f32_bf16 v239, v117, v117, v239
ds_read_b64 v[248:249], v230
v_dot2_f32_bf16 v236, v54, v240, v236
v_dot2_f32_bf16 v237, v54, v54, v237
v_dot2_f32_bf16 v238, v118, v240, v238
v_dot2_f32_bf16 v239, v118, v118, v239
ds_read_b64 v[250:251], v231
v_dot2_f32_bf16 v236, v55, v240, v236
v_dot2_f32_bf16 v237, v55, v55, v237
v_dot2_f32_bf16 v238, v119, v240, v238
v_dot2_f32_bf16 v239, v119, v119, v239
s_waitcnt lgkmcnt(8)
v_dot2_f32_bf16 v236, v56, v240, v236
v_dot2_f32_bf16 v237, v56, v56, v237
v_dot2_f32_bf16 v238, v120, v240, v238
v_dot2_f32_bf16 v239, v120, v120, v239
v_dot2_f32_bf16 v236, v57, v240, v236
v_dot2_f32_bf16 v237, v57, v57, v237
v_dot2_f32_bf16 v238, v121, v240, v238
v_dot2_f32_bf16 v239, v121, v121, v239
v_dot2_f32_bf16 v236, v58, v240, v236
v_dot2_f32_bf16 v237, v58, v58, v237
v_dot2_f32_bf16 v238, v122, v240, v238
v_dot2_f32_bf16 v239, v122, v122, v239
v_dot2_f32_bf16 v236, v59, v240, v236
v_dot2_f32_bf16 v237, v59, v59, v237
v_dot2_f32_bf16 v238, v123, v240, v238
v_dot2_f32_bf16 v239, v123, v123, v239
s_waitcnt lgkmcnt(4)
v_dot2_f32_bf16 v236, v60, v240, v236
v_dot2_f32_bf16 v237, v60, v60, v237
v_dot2_f32_bf16 v238, v124, v240, v238
v_dot2_f32_bf16 v239, v124, v124, v239
v_dot2_f32_bf16 v236, v61, v240, v236
v_dot2_f32_bf16 v237, v61, v61, v237
v_dot2_f32_bf16 v238, v125, v240, v238
v_dot2_f32_bf16 v239, v125, v125, v239
v_dot2_f32_bf16 v236, v62, v240, v236
v_dot2_f32_bf16 v237, v62, v62, v237
v_dot2_f32_bf16 v238, v126, v240, v238
v_dot2_f32_bf16 v239, v126, v126, v239
v_dot2_f32_bf16 v236, v63, v240, v236
v_dot2_f32_bf16 v237, v63, v63, v237
v_dot2_f32_bf16 v238, v127, v240, v238
v_dot2_f32_bf16 v239, v127, v127, v239
s_waitcnt lgkmcnt(0)
s_lshr_b32 s54, s48, 1
s_lshl_b32 s54, s54, 6
v_xor_b32 v224, s54, v254
v_xor_b32 v225, 32, v224
v_add_u32 v226, 65536, v224
v_add_u32 v227, 65536, v225
v_add_u32 v228, 131072, v224
v_add_u32 v229, 131072, v225
s_mul_i32 s94, s48, 98304
s_add_u32 s94, s94, s58
s_lshl_b32 s95, s48, 12
s_mul_i32 s92, s48, 24576
s_add_u32 s92, s92, s58
s_add_u32 s92, s92, 1474560
s_lshl_b32 s93, s48, 10
s_add_u32 s93, s93, 32768
s_add_u32 s54, s48, 23
s_lshr_b32 s55, s54, 1
s_mul_i32 s55, s55, 98304
s_and_b32 s54, s54, 1
s_lshl_b32 s54, s54, 10
s_add_u32 s54, s54, s55
s_add_u32 s88, s54, s58
s_add_u32 s54, s88, 394240
s_sub_u32 s90, s94, 98304
s_cmp_eq_u32 s48, 0
s_cselect_b32 s90, s54, s90
s_waitcnt vmcnt(2)
s_barrier
ds_read_b64_tr_b16 v[192:193], v224 offset:0
ds_read_b64_tr_b16 v[194:195], v224 offset:2048
ds_read_b64_tr_b16 v[196:197], v225 offset:0
ds_read_b64_tr_b16 v[198:199], v225 offset:2048
ds_read_b64_tr_b16 v[200:201], v224 offset:4096
ds_read_b64_tr_b16 v[202:203], v224 offset:6144
ds_read_b64_tr_b16 v[204:205], v225 offset:4096
ds_read_b64_tr_b16 v[206:207], v225 offset:6144
ds_read_b64_tr_b16 v[208:209], v224 offset:8192
ds_read_b64_tr_b16 v[210:211], v224 offset:10240
ds_read_b64_tr_b16 v[212:213], v225 offset:8192
ds_read_b64_tr_b16 v[214:215], v225 offset:10240
s_waitcnt lgkmcnt(10)
v_mfma_f32_16x16x32_bf16 v[128:131], v[0:3], v[192:195], 0
ds_read_b64_tr_b16 v[216:217], v224 offset:12288
s_add_u32 m0, s95, 94208
v_mfma_f32_16x16x32_bf16 v[144:147], v[64:67], v[192:195], 0
ds_read_b64_tr_b16 v[218:219], v224 offset:14336
v_mfma_f32_16x16x32_bf16 v[160:163], a[236:239], v[192:195], 0
s_waitcnt lgkmcnt(10)
v_mfma_f32_16x16x32_bf16 v[132:135], v[0:3], v[196:199], 0
ds_read_b64_tr_b16 v[220:221], v225 offset:12288
s_add_u32 s47, s88, 1024
v_mfma_f32_16x16x32_bf16 v[148:151], v[64:67], v[196:199], 0
ds_read_b64_tr_b16 v[222:223], v225 offset:14336
v_mfma_f32_16x16x32_bf16 v[164:167], a[236:239], v[196:199], 0
s_waitcnt lgkmcnt(10)
v_mfma_f32_16x16x32_bf16 v[136:139], v[0:3], v[200:203], 0
ds_read_b64_tr_b16 v[192:193], v224 offset:16384
buffer_load_dwordx4 v232, s[12:15], s47 offen offset:0 lds
v_mfma_f32_16x16x32_bf16 v[152:155], v[64:67], v[200:203], 0
ds_read_b64_tr_b16 v[194:195], v224 offset:18432
v_mfma_f32_16x16x32_bf16 v[168:171], a[236:239], v[200:203], 0
s_waitcnt lgkmcnt(10)
v_mfma_f32_16x16x32_bf16 v[140:143], v[0:3], v[204:207], 0
ds_read_b64_tr_b16 v[196:197], v225 offset:16384
buffer_load_dwordx4 v233, s[12:15], s47 offen offset:1024 lds
v_mfma_f32_16x16x32_bf16 v[156:159], v[64:67], v[204:207], 0
ds_read_b64_tr_b16 v[198:199], v225 offset:18432
v_mfma_f32_16x16x32_bf16 v[172:175], a[236:239], v[204:207], 0
s_waitcnt lgkmcnt(10)
v_mfma_f32_16x16x32_bf16 v[128:131], v[4:7], v[208:211], v[128:131]
ds_read_b64_tr_b16 v[200:201], v224 offset:20480
buffer_load_dwordx4 v234, s[12:15], s47 offen offset:2048 lds
v_mfma_f32_16x16x32_bf16 v[144:147], v[68:71], v[208:211], v[144:147]
ds_read_b64_tr_b16 v[202:203], v224 offset:22528
v_mfma_f32_16x16x32_bf16 v[160:163], a[236:239], v[208:211], v[160:163]
s_waitcnt lgkmcnt(10)
v_mfma_f32_16x16x32_bf16 v[132:135], v[4:7], v[212:215], v[132:135]
ds_read_b64_tr_b16 v[204:205], v225 offset:20480
buffer_load_dwordx4 v235, s[12:15], s47 offen offset:3072 lds
v_mfma_f32_16x16x32_bf16 v[148:151], v[68:71], v[212:215], v[148:151]
ds_read_b64_tr_b16 v[206:207], v225 offset:22528
v_mfma_f32_16x16x32_bf16 v[164:167], a[236:239], v[212:215], v[164:167]
s_waitcnt lgkmcnt(10)
v_mfma_f32_16x16x32_bf16 v[136:139], v[4:7], v[216:219], v[136:139]
ds_read_b64_tr_b16 v[208:209], v224 offset:24576
s_add_u32 m0, s95, 110592
v_mfma_f32_16x16x32_bf16 v[152:155], v[68:71], v[216:219], v[152:155]
ds_read_b64_tr_b16 v[210:211], v224 offset:26624
v_mfma_f32_16x16x32_bf16 v[168:171], a[236:239], v[216:219], v[168:171]
s_waitcnt lgkmcnt(10)
v_mfma_f32_16x16x32_bf16 v[140:143], v[4:7], v[220:223], v[140:143]
ds_read_b64_tr_b16 v[212:213], v225 offset:24576
s_add_u32 s47, s88, 197632
v_mfma_f32_16x16x32_bf16 v[156:159], v[68:71], v[220:223], v[156:159]
ds_read_b64_tr_b16 v[214:215], v225 offset:26624
v_mfma_f32_16x16x32_bf16 v[172:175], a[236:239], v[220:223], v[172:175]
s_waitcnt lgkmcnt(10)
v_mfma_f32_16x16x32_bf16 v[128:131], v[8:11], v[192:195], v[128:131]
ds_read_b64_tr_b16 v[216:217], v224 offset:28672
buffer_load_dwordx4 v232, s[12:15], s47 offen offset:0 lds
v_mfma_f32_16x16x32_bf16 v[144:147], v[72:75], v[192:195], v[144:147]
ds_read_b64_tr_b16 v[218:219], v224 offset:30720
v_mfma_f32_16x16x32_bf16 v[160:163], a[236:239], v[192:195], v[160:163]
s_waitcnt lgkmcnt(10)
v_mfma_f32_16x16x32_bf16 v[132:135], v[8:11], v[196:199], v[132:135]
ds_read_b64_tr_b16 v[220:221], v225 offset:28672
buffer_load_dwordx4 v233, s[12:15], s47 offen offset:1024 lds
v_mfma_f32_16x16x32_bf16 v[148:151], v[72:75], v[196:199], v[148:151]
ds_read_b64_tr_b16 v[222:223], v225 offset:30720
v_mfma_f32_16x16x32_bf16 v[164:167], a[236:239], v[196:199], v[164:167]
s_waitcnt lgkmcnt(10)
v_mfma_f32_16x16x32_bf16 v[136:139], v[8:11], v[200:203], v[136:139]
ds_read_b64_tr_b16 v[192:193], v224 offset:32768
buffer_load_dwordx4 v234, s[12:15], s47 offen offset:2048 lds
v_mfma_f32_16x16x32_bf16 v[152:155], v[72:75], v[200:203], v[152:155]
ds_read_b64_tr_b16 v[194:195], v224 offset:34816
v_mfma_f32_16x16x32_bf16 v[168:171], a[236:239], v[200:203], v[168:171]
s_waitcnt lgkmcnt(10)
v_mfma_f32_16x16x32_bf16 v[140:143], v[8:11], v[204:207], v[140:143]
ds_read_b64_tr_b16 v[196:197], v225 offset:32768
buffer_load_dwordx4 v235, s[12:15], s47 offen offset:3072 lds
v_mfma_f32_16x16x32_bf16 v[156:159], v[72:75], v[204:207], v[156:159]
ds_read_b64_tr_b16 v[198:199], v225 offset:34816
v_mfma_f32_16x16x32_bf16 v[172:175], a[236:239], v[204:207], v[172:175]
s_waitcnt lgkmcnt(10)
v_mfma_f32_16x16x32_bf16 v[128:131], v[12:15], v[208:211], v[128:131]
ds_read_b64_tr_b16 v[200:201], v224 offset:36864
s_add_u32 m0, s95, 126976
v_mfma_f32_16x16x32_bf16 v[144:147], v[76:79], v[208:211], v[144:147]
ds_read_b64_tr_b16 v[202:203], v224 offset:38912
v_mfma_f32_16x16x32_bf16 v[160:163], a[236:239], v[208:211], v[160:163]
s_waitcnt lgkmcnt(10)
v_mfma_f32_16x16x32_bf16 v[132:135], v[12:15], v[212:215], v[132:135]
ds_read_b64_tr_b16 v[204:205], v225 offset:36864
s_add_u32 s47, s90, 0
v_mfma_f32_16x16x32_bf16 v[148:151], v[76:79], v[212:215], v[148:151]
ds_read_b64_tr_b16 v[206:207], v225 offset:38912
v_mfma_f32_16x16x32_bf16 v[164:167], a[236:239], v[212:215], v[164:167]
s_waitcnt lgkmcnt(10)
v_mfma_f32_16x16x32_bf16 v[136:139], v[12:15], v[216:219], v[136:139]
ds_read_b64_tr_b16 v[208:209], v224 offset:40960
buffer_load_dwordx4 v232, s[12:15], s47 offen offset:0 lds
v_mfma_f32_16x16x32_bf16 v[152:155], v[76:79], v[216:219], v[152:155]
ds_read_b64_tr_b16 v[210:211], v224 offset:43008
v_mfma_f32_16x16x32_bf16 v[168:171], a[236:239], v[216:219], v[168:171]
s_waitcnt lgkmcnt(10)
v_mfma_f32_16x16x32_bf16 v[140:143], v[12:15], v[220:223], v[140:143]
ds_read_b64_tr_b16 v[212:213], v225 offset:40960
buffer_load_dwordx4 v233, s[12:15], s47 offen offset:1024 lds
v_mfma_f32_16x16x32_bf16 v[156:159], v[76:79], v[220:223], v[156:159]
ds_read_b64_tr_b16 v[214:215], v225 offset:43008
v_mfma_f32_16x16x32_bf16 v[172:175], a[236:239], v[220:223], v[172:175]
s_waitcnt lgkmcnt(10)
v_mfma_f32_16x16x32_bf16 v[128:131], v[16:19], v[192:195], v[128:131]
ds_read_b64_tr_b16 v[216:217], v224 offset:45056
buffer_load_dwordx4 v234, s[12:15], s47 offen offset:2048 lds
v_mfma_f32_16x16x32_bf16 v[144:147], v[80:83], v[192:195], v[144:147]
ds_read_b64_tr_b16 v[218:219], v224 offset:47104
v_mfma_f32_16x16x32_bf16 v[160:163], a[236:239], v[192:195], v[160:163]
s_waitcnt lgkmcnt(10)
v_mfma_f32_16x16x32_bf16 v[132:135], v[16:19], v[196:199], v[132:135]
ds_read_b64_tr_b16 v[220:221], v225 offset:45056
buffer_load_dwordx4 v235, s[12:15], s47 offen offset:3072 lds
v_mfma_f32_16x16x32_bf16 v[148:151], v[80:83], v[196:199], v[148:151]
ds_read_b64_tr_b16 v[222:223], v225 offset:47104
v_mfma_f32_16x16x32_bf16 v[164:167], a[236:239], v[196:199], v[164:167]
s_waitcnt lgkmcnt(10)
v_mfma_f32_16x16x32_bf16 v[136:139], v[16:19], v[200:203], v[136:139]
ds_read_b64_tr_b16 v[192:193], v224 offset:49152
s_add_u32 m0, s95, 143360
v_mfma_f32_16x16x32_bf16 v[152:155], v[80:83], v[200:203], v[152:155]
ds_read_b64_tr_b16 v[194:195], v224 offset:51200
v_mfma_f32_16x16x32_bf16 v[168:171], a[236:239], v[200:203], v[168:171]
s_waitcnt lgkmcnt(10)
v_mfma_f32_16x16x32_bf16 v[140:143], v[16:19], v[204:207], v[140:143]
ds_read_b64_tr_b16 v[196:197], v225 offset:49152
s_add_u32 s47, s94, 294912
v_mfma_f32_16x16x32_bf16 v[156:159], v[80:83], v[204:207], v[156:159]
ds_read_b64_tr_b16 v[198:199], v225 offset:51200
v_mfma_f32_16x16x32_bf16 v[172:175], a[236:239], v[204:207], v[172:175]
s_waitcnt lgkmcnt(10)
v_mfma_f32_16x16x32_bf16 v[128:131], v[20:23], v[208:211], v[128:131]
ds_read_b64_tr_b16 v[200:201], v224 offset:53248
buffer_load_dwordx4 v232, s[12:15], s47 offen offset:0 lds
v_mfma_f32_16x16x32_bf16 v[144:147], v[84:87], v[208:211], v[144:147]
ds_read_b64_tr_b16 v[202:203], v224 offset:55296
v_mfma_f32_16x16x32_bf16 v[160:163], a[236:239], v[208:211], v[160:163]
s_waitcnt lgkmcnt(10)
v_mfma_f32_16x16x32_bf16 v[132:135], v[20:23], v[212:215], v[132:135]
ds_read_b64_tr_b16 v[204:205], v225 offset:53248
buffer_load_dwordx4 v233, s[12:15], s47 offen offset:1024 lds
v_mfma_f32_16x16x32_bf16 v[148:151], v[84:87], v[212:215], v[148:151]
ds_read_b64_tr_b16 v[206:207], v225 offset:55296
v_mfma_f32_16x16x32_bf16 v[164:167], a[236:239], v[212:215], v[164:167]
s_waitcnt lgkmcnt(10)
v_mfma_f32_16x16x32_bf16 v[136:139], v[20:23], v[216:219], v[136:139]
ds_read_b64_tr_b16 v[208:209], v224 offset:57344
buffer_load_dwordx4 v234, s[12:15], s47 offen offset:2048 lds
v_mfma_f32_16x16x32_bf16 v[152:155], v[84:87], v[216:219], v[152:155]
ds_read_b64_tr_b16 v[210:211], v224 offset:59392
v_mfma_f32_16x16x32_bf16 v[168:171], a[236:239], v[216:219], v[168:171]
s_waitcnt lgkmcnt(10)
v_mfma_f32_16x16x32_bf16 v[140:143], v[20:23], v[220:223], v[140:143]
ds_read_b64_tr_b16 v[212:213], v225 offset:57344
buffer_load_dwordx4 v235, s[12:15], s47 offen offset:3072 lds
v_mfma_f32_16x16x32_bf16 v[156:159], v[84:87], v[220:223], v[156:159]
ds_read_b64_tr_b16 v[214:215], v225 offset:59392
v_mfma_f32_16x16x32_bf16 v[172:175], a[236:239], v[220:223], v[172:175]
s_waitcnt lgkmcnt(10)
v_mfma_f32_16x16x32_bf16 v[128:131], v[24:27], v[192:195], v[128:131]
ds_read_b64_tr_b16 v[216:217], v224 offset:61440
v_lshlrev_b32 v231, 3, v255
v_mfma_f32_16x16x32_bf16 v[144:147], v[88:91], v[192:195], v[144:147]
ds_read_b64_tr_b16 v[218:219], v224 offset:63488
v_mfma_f32_16x16x32_bf16 v[160:163], a[236:239], v[192:195], v[160:163]
s_waitcnt lgkmcnt(10)
v_mfma_f32_16x16x32_bf16 v[132:135], v[24:27], v[196:199], v[132:135]
ds_read_b64_tr_b16 v[220:221], v225 offset:61440
s_lshr_b32 s47, s53, 3
v_mfma_f32_16x16x32_bf16 v[148:151], v[88:91], v[196:199], v[148:151]
ds_read_b64_tr_b16 v[222:223], v225 offset:63488
s_lshl_b32 s47, s47, 2
v_mfma_f32_16x16x32_bf16 v[164:167], a[236:239], v[196:199], v[164:167]
s_waitcnt lgkmcnt(10)
v_mfma_f32_16x16x32_bf16 v[136:139], v[24:27], v[200:203], v[136:139]
ds_read_b64_tr_b16 v[192:193], v226 offset:0
s_add_u32 s47, s47, s48
v_mfma_f32_16x16x32_bf16 v[152:155], v[88:91], v[200:203], v[152:155]
ds_read_b64_tr_b16 v[194:195], v226 offset:2048
v_mfma_f32_16x16x32_bf16 v[168:171], a[236:239], v[200:203], v[168:171]
s_waitcnt lgkmcnt(10)
v_mfma_f32_16x16x32_bf16 v[140:143], v[24:27], v[204:207], v[140:143]
ds_read_b64_tr_b16 v[196:197], v227 offset:0
s_mul_i32 s47, s47, 14336
v_mfma_f32_16x16x32_bf16 v[156:159], v[88:91], v[204:207], v[156:159]
ds_read_b64_tr_b16 v[198:199], v227 offset:2048
buffer_load_dword a3, v231, s[20:23], s47 offen
v_mfma_f32_16x16x32_bf16 v[172:175], a[236:239], v[204:207], v[172:175]
s_waitcnt lgkmcnt(10)
v_mfma_f32_16x16x32_bf16 v[128:131], v[28:31], v[208:211], v[128:131]
ds_read_b64_tr_b16 v[200:201], v226 offset:4096
v_mov_b32 v176, v236
v_mfma_f32_16x16x32_bf16 v[144:147], v[92:95], v[208:211], v[144:147]
ds_read_b64_tr_b16 v[202:203], v226 offset:6144
v_mov_b32 v177, v237
v_mfma_f32_16x16x32_bf16 v[160:163], a[236:239], v[208:211], v[160:163]
v_mov_b32 v178, v238
s_waitcnt lgkmcnt(10)
v_mfma_f32_16x16x32_bf16 v[132:135], v[28:31], v[212:215], v[132:135]
ds_read_b64_tr_b16 v[204:205], v227 offset:4096
v_mov_b32 v179, v239
v_mfma_f32_16x16x32_bf16 v[148:151], v[92:95], v[212:215], v[148:151]
ds_read_b64_tr_b16 v[206:207], v227 offset:6144
v_permlane16_swap_b32 v176, v236
v_mfma_f32_16x16x32_bf16 v[164:167], a[236:239], v[212:215], v[164:167]
v_permlane16_swap_b32 v177, v237
s_waitcnt lgkmcnt(10)
v_mfma_f32_16x16x32_bf16 v[136:139], v[28:31], v[216:219], v[136:139]
ds_read_b64_tr_b16 v[208:209], v226 offset:8192
v_permlane16_swap_b32 v178, v238
v_permlane16_swap_b32 v179, v239
v_mfma_f32_16x16x32_bf16 v[152:155], v[92:95], v[216:219], v[152:155]
ds_read_b64_tr_b16 v[210:211], v226 offset:10240
v_add_f32 v236, v236, v176
v_add_f32 v237, v237, v177
v_mfma_f32_16x16x32_bf16 v[168:171], a[236:239], v[216:219], v[168:171]
s_waitcnt lgkmcnt(10)
v_mfma_f32_16x16x32_bf16 v[140:143], v[28:31], v[220:223], v[140:143]
ds_read_b64_tr_b16 v[212:213], v227 offset:8192
v_add_f32 v238, v238, v178
v_mfma_f32_16x16x32_bf16 v[156:159], v[92:95], v[220:223], v[156:159]
ds_read_b64_tr_b16 v[214:215], v227 offset:10240
v_add_f32 v239, v239, v179
v_mfma_f32_16x16x32_bf16 v[172:175], a[236:239], v[220:223], v[172:175]
v_mov_b32 v176, v236
s_waitcnt lgkmcnt(10)
v_mfma_f32_16x16x32_bf16 v[128:131], v[32:35], v[192:195], v[128:131]
ds_read_b64_tr_b16 v[216:217], v226 offset:12288
v_mov_b32 v177, v237
v_mfma_f32_16x16x32_bf16 v[144:147], v[96:99], v[192:195], v[144:147]
ds_read_b64_tr_b16 v[218:219], v226 offset:14336
v_mov_b32 v178, v238
v_mfma_f32_16x16x32_bf16 v[160:163], a[236:239], v[192:195], v[160:163]
v_mov_b32 v179, v239
s_waitcnt lgkmcnt(10)
v_mfma_f32_16x16x32_bf16 v[132:135], v[32:35], v[196:199], v[132:135]
ds_read_b64_tr_b16 v[220:221], v227 offset:12288
v_permlane32_swap_b32 v176, v236
v_permlane32_swap_b32 v177, v237
v_mfma_f32_16x16x32_bf16 v[148:151], v[96:99], v[196:199], v[148:151]
ds_read_b64_tr_b16 v[222:223], v227 offset:14336
v_permlane32_swap_b32 v178, v238
v_permlane32_swap_b32 v179, v239
v_mfma_f32_16x16x32_bf16 v[164:167], a[236:239], v[196:199], v[164:167]
s_waitcnt lgkmcnt(10)
v_mfma_f32_16x16x32_bf16 v[136:139], v[32:35], v[200:203], v[136:139]
ds_read_b64_tr_b16 v[192:193], v226 offset:16384
v_add_f32 v236, v236, v176
v_mfma_f32_16x16x32_bf16 v[152:155], v[96:99], v[200:203], v[152:155]
ds_read_b64_tr_b16 v[194:195], v226 offset:18432
v_add_f32 v237, v237, v177
v_mfma_f32_16x16x32_bf16 v[168:171], a[236:239], v[200:203], v[168:171]
v_add_f32 v238, v238, v178
s_waitcnt lgkmcnt(10)
v_mfma_f32_16x16x32_bf16 v[140:143], v[32:35], v[204:207], v[140:143]
ds_read_b64_tr_b16 v[196:197], v227 offset:16384
v_add_f32 v239, v239, v179
v_mul_f32 v236, 0x3b000000, v236
v_mfma_f32_16x16x32_bf16 v[156:159], v[96:99], v[204:207], v[156:159]
ds_read_b64_tr_b16 v[198:199], v227 offset:18432
v_mul_f32 v176, v236, v236
v_fma_f32 v237, v237, s60, -v176
v_mfma_f32_16x16x32_bf16 v[172:175], a[236:239], v[204:207], v[172:175]
s_waitcnt lgkmcnt(10)
v_mfma_f32_16x16x32_bf16 v[128:131], v[36:39], v[208:211], v[128:131]
ds_read_b64_tr_b16 v[200:201], v226 offset:20480
v_max_f32 v237, 0, v237
v_mfma_f32_16x16x32_bf16 v[144:147], v[100:103], v[208:211], v[144:147]
ds_read_b64_tr_b16 v[202:203], v226 offset:22528
v_add_f32 v237, 0x3727c5ac, v237
v_mfma_f32_16x16x32_bf16 v[160:163], a[236:239], v[208:211], v[160:163]
v_rsq_f32 v176, v237
s_waitcnt lgkmcnt(10)
v_mfma_f32_16x16x32_bf16 v[132:135], v[36:39], v[212:215], v[132:135]
ds_read_b64_tr_b16 v[204:205], v227 offset:20480
v_mul_f32 v237, -v236, v176
v_mfma_f32_16x16x32_bf16 v[148:151], v[100:103], v[212:215], v[148:151]
ds_read_b64_tr_b16 v[206:207], v227 offset:22528
v_mov_b32 v236, v176
v_mfma_f32_16x16x32_bf16 v[164:167], a[236:239], v[212:215], v[164:167]
v_mul_f32 v238, 0x3b000000, v238
s_waitcnt lgkmcnt(10)
v_mfma_f32_16x16x32_bf16 v[136:139], v[36:39], v[216:219], v[136:139]
ds_read_b64_tr_b16 v[208:209], v226 offset:24576
v_mul_f32 v177, v238, v238
v_fma_f32 v239, v239, s60, -v177
v_mfma_f32_16x16x32_bf16 v[152:155], v[100:103], v[216:219], v[152:155]
ds_read_b64_tr_b16 v[210:211], v226 offset:26624
v_max_f32 v239, 0, v239
v_add_f32 v239, 0x3727c5ac, v239
v_mfma_f32_16x16x32_bf16 v[168:171], a[236:239], v[216:219], v[168:171]
s_waitcnt lgkmcnt(10)
v_mfma_f32_16x16x32_bf16 v[140:143], v[36:39], v[220:223], v[140:143]
ds_read_b64_tr_b16 v[212:213], v227 offset:24576
v_rsq_f32 v177, v239
v_mfma_f32_16x16x32_bf16 v[156:159], v[100:103], v[220:223], v[156:159]
ds_read_b64_tr_b16 v[214:215], v227 offset:26624
v_mul_f32 v239, -v238, v177
v_mfma_f32_16x16x32_bf16 v[172:175], a[236:239], v[220:223], v[172:175]
v_mov_b32 v238, v177
s_waitcnt lgkmcnt(10)
s_waitcnt vmcnt(5)
s_barrier
v_mfma_f32_16x16x32_bf16 v[128:131], v[40:43], v[192:195], v[128:131]
ds_read_b64_tr_b16 v[216:217], v226 offset:28672
s_lshl_b32 s54, s48, 8
v_mfma_f32_16x16x32_bf16 v[144:147], v[104:107], v[192:195], v[144:147]
ds_read_b64_tr_b16 v[218:219], v226 offset:30720
s_add_u32 s54, s54, 162304
v_mfma_f32_16x16x32_bf16 v[160:163], a[236:239], v[192:195], v[160:163]
v_bfe_u32 v241, v255, 4, 4
s_waitcnt lgkmcnt(10)
v_mfma_f32_16x16x32_bf16 v[132:135], v[40:43], v[196:199], v[132:135]
ds_read_b64_tr_b16 v[220:221], v227 offset:28672
v_lshl_add_u32 v241, v241, 2, s54
ds_write_b32 v241, v236 offset:0
v_mfma_f32_16x16x32_bf16 v[148:151], v[104:107], v[196:199], v[148:151]
ds_read_b64_tr_b16 v[222:223], v227 offset:30720
ds_write_b32 v241, v237 offset:128
ds_write_b32 v241, v238 offset:64
v_mfma_f32_16x16x32_bf16 v[164:167], a[236:239], v[196:199], v[164:167]
s_waitcnt lgkmcnt(10)
v_mfma_f32_16x16x32_bf16 v[136:139], v[40:43], v[200:203], v[136:139]
ds_read_b64_tr_b16 v[192:193], v226 offset:32768
ds_write_b32 v241, v239 offset:192
v_mfma_f32_16x16x32_bf16 v[152:155], v[104:107], v[200:203], v[152:155]
ds_read_b64_tr_b16 v[194:195], v226 offset:34816
v_lshrrev_b32 v242, 8, v255
v_mfma_f32_16x16x32_bf16 v[168:171], a[236:239], v[200:203], v[168:171]
v_lshl_add_u32 v242, v242, 4, s54
s_waitcnt lgkmcnt(10)
v_mfma_f32_16x16x32_bf16 v[140:143], v[40:43], v[204:207], v[140:143]
ds_read_b64_tr_b16 v[196:197], v227 offset:32768
ds_read_b128 v[176:179], v242 offset:0
ds_read_b128 v[180:183], v242 offset:64
v_mfma_f32_16x16x32_bf16 v[156:159], v[104:107], v[204:207], v[156:159]
ds_read_b64_tr_b16 v[198:199], v227 offset:34816
ds_read_b128 v[184:187], v242 offset:128
ds_read_b128 v[188:191], v242 offset:192
v_mfma_f32_16x16x32_bf16 v[172:175], a[236:239], v[204:207], v[172:175]
s_waitcnt lgkmcnt(10)
v_mfma_f32_16x16x32_bf16 v[128:131], v[44:47], v[208:211], v[128:131]
ds_read_b64_tr_b16 v[200:201], v226 offset:36864
s_add_u32 m0, s95, 0
v_mfma_f32_16x16x32_bf16 v[144:147], v[108:111], v[208:211], v[144:147]
ds_read_b64_tr_b16 v[202:203], v226 offset:38912
v_mfma_f32_16x16x32_bf16 v[160:163], a[236:239], v[208:211], v[160:163]
s_waitcnt lgkmcnt(10)
v_mfma_f32_16x16x32_bf16 v[132:135], v[44:47], v[212:215], v[132:135]
ds_read_b64_tr_b16 v[204:205], v227 offset:36864
s_add_u32 s47, s94, 688128
v_mfma_f32_16x16x32_bf16 v[148:151], v[108:111], v[212:215], v[148:151]
ds_read_b64_tr_b16 v[206:207], v227 offset:38912
v_mfma_f32_16x16x32_bf16 v[164:167], a[236:239], v[212:215], v[164:167]
s_waitcnt lgkmcnt(10)
v_mfma_f32_16x16x32_bf16 v[136:139], v[44:47], v[216:219], v[136:139]
ds_read_b64_tr_b16 v[208:209], v226 offset:40960
buffer_load_dwordx4 v232, s[12:15], s47 offen offset:0 lds
v_mfma_f32_16x16x32_bf16 v[152:155], v[108:111], v[216:219], v[152:155]
ds_read_b64_tr_b16 v[210:211], v226 offset:43008
v_mfma_f32_16x16x32_bf16 v[168:171], a[236:239], v[216:219], v[168:171]
s_waitcnt lgkmcnt(10)
v_mfma_f32_16x16x32_bf16 v[140:143], v[44:47], v[220:223], v[140:143]
ds_read_b64_tr_b16 v[212:213], v227 offset:40960
buffer_load_dwordx4 v233, s[12:15], s47 offen offset:1024 lds
v_mfma_f32_16x16x32_bf16 v[156:159], v[108:111], v[220:223], v[156:159]
ds_read_b64_tr_b16 v[214:215], v227 offset:43008
buffer_load_dwordx4 v234, s[12:15], s47 offen offset:2048 lds
v_mfma_f32_16x16x32_bf16 v[172:175], a[236:239], v[220:223], v[172:175]
s_waitcnt lgkmcnt(10)
v_mfma_f32_16x16x32_bf16 v[128:131], v[48:51], v[192:195], v[128:131]
ds_read_b64_tr_b16 v[216:217], v226 offset:45056
buffer_load_dwordx4 v235, s[12:15], s47 offen offset:3072 lds
v_mfma_f32_16x16x32_bf16 v[144:147], v[112:115], v[192:195], v[144:147]
ds_read_b64_tr_b16 v[218:219], v226 offset:47104
v_mfma_f32_16x16x32_bf16 v[160:163], a[236:239], v[192:195], v[160:163]
s_waitcnt lgkmcnt(10)
v_mfma_f32_16x16x32_bf16 v[132:135], v[48:51], v[196:199], v[132:135]
ds_read_b64_tr_b16 v[220:221], v227 offset:45056
s_add_u32 m0, s95, 16384
v_mfma_f32_16x16x32_bf16 v[148:151], v[112:115], v[196:199], v[148:151]
ds_read_b64_tr_b16 v[222:223], v227 offset:47104
v_mfma_f32_16x16x32_bf16 v[164:167], a[236:239], v[196:199], v[164:167]
s_waitcnt lgkmcnt(10)
v_mfma_f32_16x16x32_bf16 v[136:139], v[48:51], v[200:203], v[136:139]
ds_read_b64_tr_b16 v[192:193], v226 offset:49152
s_add_u32 s47, s94, 1081344
v_mfma_f32_16x16x32_bf16 v[152:155], v[112:115], v[200:203], v[152:155]
ds_read_b64_tr_b16 v[194:195], v226 offset:51200
v_mfma_f32_16x16x32_bf16 v[168:171], a[236:239], v[200:203], v[168:171]
s_waitcnt lgkmcnt(10)
v_mfma_f32_16x16x32_bf16 v[140:143], v[48:51], v[204:207], v[140:143]
ds_read_b64_tr_b16 v[196:197], v227 offset:49152
buffer_load_dwordx4 v232, s[12:15], s47 offen offset:0 lds
v_mfma_f32_16x16x32_bf16 v[156:159], v[112:115], v[204:207], v[156:159]
ds_read_b64_tr_b16 v[198:199], v227 offset:51200
buffer_load_dwordx4 v233, s[12:15], s47 offen offset:1024 lds
v_mfma_f32_16x16x32_bf16 v[172:175], a[236:239], v[204:207], v[172:175]
s_waitcnt lgkmcnt(10)
v_mfma_f32_16x16x32_bf16 v[128:131], v[52:55], v[208:211], v[128:131]
ds_read_b64_tr_b16 v[200:201], v226 offset:53248
buffer_load_dwordx4 v234, s[12:15], s47 offen offset:2048 lds
v_mfma_f32_16x16x32_bf16 v[144:147], v[116:119], v[208:211], v[144:147]
ds_read_b64_tr_b16 v[202:203], v226 offset:55296
v_mfma_f32_16x16x32_bf16 v[160:163], a[236:239], v[208:211], v[160:163]
s_waitcnt lgkmcnt(10)
v_mfma_f32_16x16x32_bf16 v[132:135], v[52:55], v[212:215], v[132:135]
ds_read_b64_tr_b16 v[204:205], v227 offset:53248
buffer_load_dwordx4 v235, s[12:15], s47 offen offset:3072 lds
v_mfma_f32_16x16x32_bf16 v[148:151], v[116:119], v[212:215], v[148:151]
ds_read_b64_tr_b16 v[206:207], v227 offset:55296
v_mfma_f32_16x16x32_bf16 v[164:167], a[236:239], v[212:215], v[164:167]
s_waitcnt lgkmcnt(10)
v_mfma_f32_16x16x32_bf16 v[136:139], v[52:55], v[216:219], v[136:139]
ds_read_b64_tr_b16 v[208:209], v226 offset:57344
s_mov_b32 m0, s93
v_mfma_f32_16x16x32_bf16 v[152:155], v[116:119], v[216:219], v[152:155]
ds_read_b64_tr_b16 v[210:211], v226 offset:59392
v_mfma_f32_16x16x32_bf16 v[168:171], a[236:239], v[216:219], v[168:171]
s_waitcnt lgkmcnt(10)
v_mfma_f32_16x16x32_bf16 v[140:143], v[52:55], v[220:223], v[140:143]
ds_read_b64_tr_b16 v[212:213], v227 offset:57344
s_nop 0
v_mfma_f32_16x16x32_bf16 v[156:159], v[116:119], v[220:223], v[156:159]
ds_read_b64_tr_b16 v[214:215], v227 offset:59392
buffer_load_dwordx4 v232, s[12:15], s92 offen lds
v_mfma_f32_16x16x32_bf16 v[172:175], a[236:239], v[220:223], v[172:175]
s_waitcnt lgkmcnt(10)
v_mfma_f32_16x16x32_bf16 v[128:131], v[56:59], v[192:195], v[128:131]
ds_read_b64_tr_b16 v[216:217], v226 offset:61440
s_lshl_b32 s54, s51, 3
v_mfma_f32_16x16x32_bf16 v[144:147], v[120:123], v[192:195], v[144:147]
ds_read_b64_tr_b16 v[218:219], v226 offset:63488
v_mfma_f32_16x16x32_bf16 v[160:163], a[236:239], v[192:195], v[160:163]
s_waitcnt lgkmcnt(10)
v_mfma_f32_16x16x32_bf16 v[132:135], v[56:59], v[196:199], v[132:135]
ds_read_b64_tr_b16 v[220:221], v227 offset:61440
v_mov_b32 v230, s54
v_mfma_f32_16x16x32_bf16 v[148:151], v[120:123], v[196:199], v[148:151]
ds_read_b64_tr_b16 v[222:223], v227 offset:63488
v_mfma_f32_16x16x32_bf16 v[164:167], a[236:239], v[196:199], v[164:167]
s_waitcnt lgkmcnt(10)
v_mfma_f32_16x16x32_bf16 v[136:139], v[56:59], v[200:203], v[136:139]
v_mov_b32 v231, 0
v_mfma_f32_16x16x32_bf16 v[152:155], v[120:123], v[200:203], v[152:155]
v_mfma_f32_16x16x32_bf16 v[168:171], a[236:239], v[200:203], v[168:171]
s_waitcnt lgkmcnt(8)
v_mfma_f32_16x16x32_bf16 v[140:143], v[56:59], v[204:207], v[140:143]
global_load_dword v240, v231, s[44:45] sc1
v_mfma_f32_16x16x32_bf16 v[156:159], v[120:123], v[204:207], v[156:159]
global_load_dwordx2 v[242:243], v230, s[44:45] offset:128 sc1
v_mfma_f32_16x16x32_bf16 v[172:175], a[236:239], v[204:207], v[172:175]
s_waitcnt lgkmcnt(6)
v_mfma_f32_16x16x32_bf16 v[128:131], v[60:63], v[208:211], v[128:131]
v_lshlrev_b32 v241, 3, v255
s_lshl_b32 s47, s49, 3
s_add_u32 s47, s47, s50
v_mfma_f32_16x16x32_bf16 v[144:147], v[124:127], v[208:211], v[144:147]
s_lshr_b32 s89, s47, 1
s_cmp_eq_u32 s48, 1
s_mov_b32 s91, 40960
v_mfma_f32_16x16x32_bf16 v[160:163], a[236:239], v[208:211], v[160:163]
s_cselect_b32 s91, 0, s91
s_waitcnt lgkmcnt(4)
v_mfma_f32_16x16x32_bf16 v[132:135], v[60:63], v[212:215], v[132:135]
s_mul_i32 s89, s89, s91
s_lshl_b32 s47, s47, 13
s_add_u32 s47, s47, s89
v_mfma_f32_16x16x32_bf16 v[148:151], v[124:127], v[212:215], v[148:151]
s_mov_b32 s89, 11534336
s_cmp_eq_u32 s48, 1
s_cselect_b32 s89, 5242880, s89
v_mfma_f32_16x16x32_bf16 v[164:167], a[236:239], v[212:215], v[164:167]
s_add_u32 s47, s47, s89
s_waitcnt lgkmcnt(2)
v_mfma_f32_16x16x32_bf16 v[136:139], v[60:63], v[216:219], v[136:139]
s_and_b32 s89, s50, 1
s_lshl_b32 s89, s89, 12
s_sub_u32 s89, 16384, s89
v_mfma_f32_16x16x32_bf16 v[152:155], v[124:127], v[216:219], v[152:155]
s_cmp_ge_u32 s48, 2
s_cselect_b32 s89, s89, 0
s_add_u32 s47, s47, s89
v_mfma_f32_16x16x32_bf16 v[168:171], a[236:239], v[216:219], v[168:171]
s_lshr_b32 s89, s48, 1
s_waitcnt lgkmcnt(0)
v_mfma_f32_16x16x32_bf16 v[140:143], v[60:63], v[220:223], v[140:143]
s_sub_u32 s89, 13, s89
v_bfe_u32 v241, v241, 0, s89
s_lshl_b32 s89, s49, 12
v_mfma_f32_16x16x32_bf16 v[156:159], v[124:127], v[220:223], v[156:159]
s_add_u32 s89, s89, 262144
s_cmp_eq_u32 s48, 2
s_cselect_b32 s47, s89, s47
v_mfma_f32_16x16x32_bf16 v[172:175], a[236:239], v[220:223], v[172:175]
buffer_load_dword a0, v241, s[28:31], s47 offen
v_lshlrev_b32 v241, 3, v255
s_barrier
v_mul_u32_u24 v232, 1024, v253
v_add_u32 v232, v232, v252
v_add_u32 v233, 7168, v232
v_add_u32 v234, 14336, v232
v_add_u32 v235, 21504, v232
s_lshl_b32 s62, s48, 17
s_lshl_b32 s54, s50, 7
s_add_u32 s62, s62, s54
s_lshl_b32 s63, s48, 14
v_mov_b32 v192, 0x3fb8aa3b
v_mov_b32 v193, 0xb5c1a2a0
s_mov_b32 s61, 0x358637bd
v_mov_b32 v194, s61
v_mov_b32 v195, 0
v_accvgpr_write_b32 a224, v160
v_mov_b32 v196, v160
v_accvgpr_write_b32 a225, v164
v_mov_b32 v197, v164
v_accvgpr_write_b32 a226, v168
v_mov_b32 v198, v168
v_accvgpr_write_b32 a227, v172
v_mov_b32 v199, v172
v_pk_fma_f32 v[216:217], v[184:185], v[196:197], v[194:195] op_sel:[0,0,0] op_sel_hi:[1,0,0]
v_pk_fma_f32 v[218:219], v[186:187], v[196:197], v[194:195] op_sel:[0,0,0] op_sel_hi:[1,0,0]
v_pk_fma_f32 v[220:221], v[188:189], v[196:197], v[194:195] op_sel:[0,0,0] op_sel_hi:[1,0,0]
v_pk_fma_f32 v[222:223], v[190:191], v[196:197], v[194:195] op_sel:[0,0,0] op_sel_hi:[1,0,0]
v_pk_fma_f32 v[128:129], v[128:129], v[176:177], v[216:217]
v_pk_fma_f32 v[130:131], v[130:131], v[178:179], v[218:219]
v_pk_fma_f32 v[144:145], v[144:145], v[180:181], v[220:221]
s_add_u32 m0, s63, 49152
s_add_u32 s47, s62, 0
buffer_load_dwordx4 v232, s[16:19], s47 offen offset:0 lds
v_pk_fma_f32 v[146:147], v[146:147], v[182:183], v[222:223]
v_pk_fma_f32 v[216:217], v[128:129], v[192:193], v[192:193] op_sel:[0,0,1] op_sel_hi:[1,0,1]
v_pk_fma_f32 v[218:219], v[130:131], v[192:193], v[192:193] op_sel:[0,0,1] op_sel_hi:[1,0,1]
v_pk_fma_f32 v[220:221], v[144:145], v[192:193], v[192:193] op_sel:[0,0,1] op_sel_hi:[1,0,1]
v_pk_fma_f32 v[222:223], v[146:147], v[192:193], v[192:193] op_sel:[0,0,1] op_sel_hi:[1,0,1]
v_exp_f32_e64 v216, v216 clamp
v_exp_f32_e64 v218, v218 clamp
v_exp_f32_e64 v220, v220 clamp
v_exp_f32_e64 v222, v222 clamp
v_exp_f32_e64 v217, v217 clamp
v_exp_f32_e64 v219, v219 clamp
v_exp_f32_e64 v221, v221 clamp
v_exp_f32_e64 v223, v223 clamp
v_max_f32 v128, s61, v128
v_max_f32 v130, s61, v130
v_max_f32 v144, s61, v144
v_max_f32 v146, s61, v146
v_max_f32 v129, s61, v129
v_max_f32 v131, s61, v131
v_max_f32 v145, s61, v145
buffer_load_dwordx4 v233, s[16:19], s47 offen offset:1024 lds
v_max_f32 v147, s61, v147
v_pk_add_f32 v[128:129], v[128:129], v[216:217]
v_pk_add_f32 v[130:131], v[130:131], v[218:219]
v_pk_add_f32 v[144:145], v[144:145], v[220:221]
v_pk_add_f32 v[146:147], v[146:147], v[222:223]
v_cvt_pk_bf16_f32 v200, v128, v129
v_cvt_pk_bf16_f32 v201, v130, v131
v_cvt_pk_bf16_f32 v202, v144, v145
v_cvt_pk_bf16_f32 v203, v146, v147
v_pk_fma_f32 v[216:217], v[184:185], v[196:197], v[194:195] op_sel:[0,1,0] op_sel_hi:[1,1,0]
v_pk_fma_f32 v[218:219], v[186:187], v[196:197], v[194:195] op_sel:[0,1,0] op_sel_hi:[1,1,0]
v_pk_fma_f32 v[220:221], v[188:189], v[196:197], v[194:195] op_sel:[0,1,0] op_sel_hi:[1,1,0]
v_pk_fma_f32 v[222:223], v[190:191], v[196:197], v[194:195] op_sel:[0,1,0] op_sel_hi:[1,1,0]
v_pk_fma_f32 v[132:133], v[132:133], v[176:177], v[216:217]
v_pk_fma_f32 v[134:135], v[134:135], v[178:179], v[218:219]
v_pk_fma_f32 v[148:149], v[148:149], v[180:181], v[220:221]
v_pk_fma_f32 v[150:151], v[150:151], v[182:183], v[222:223]
v_pk_fma_f32 v[216:217], v[132:133], v[192:193], v[192:193] op_sel:[0,0,1] op_sel_hi:[1,0,1]
v_pk_fma_f32 v[218:219], v[134:135], v[192:193], v[192:193] op_sel:[0,0,1] op_sel_hi:[1,0,1]
v_pk_fma_f32 v[220:221], v[148:149], v[192:193], v[192:193] op_sel:[0,0,1] op_sel_hi:[1,0,1]
buffer_load_dwordx4 v234, s[16:19], s47 offen offset:2048 lds
v_pk_fma_f32 v[222:223], v[150:151], v[192:193], v[192:193] op_sel:[0,0,1] op_sel_hi:[1,0,1]
v_exp_f32_e64 v216, v216 clamp
v_exp_f32_e64 v218, v218 clamp
v_exp_f32_e64 v220, v220 clamp
v_exp_f32_e64 v222, v222 clamp
v_exp_f32_e64 v217, v217 clamp
v_exp_f32_e64 v219, v219 clamp
v_exp_f32_e64 v221, v221 clamp
v_exp_f32_e64 v223, v223 clamp
v_max_f32 v132, s61, v132
v_max_f32 v134, s61, v134
v_max_f32 v148, s61, v148
v_max_f32 v150, s61, v150
v_max_f32 v133, s61, v133
v_max_f32 v135, s61, v135
v_max_f32 v149, s61, v149
v_max_f32 v151, s61, v151
v_pk_add_f32 v[132:133], v[132:133], v[216:217]
v_pk_add_f32 v[134:135], v[134:135], v[218:219]
v_pk_add_f32 v[148:149], v[148:149], v[220:221]
buffer_load_dwordx4 v235, s[16:19], s47 offen offset:3072 lds
v_pk_add_f32 v[150:151], v[150:151], v[222:223]
v_cvt_pk_bf16_f32 v204, v132, v133
v_cvt_pk_bf16_f32 v205, v134, v135
v_cvt_pk_bf16_f32 v206, v148, v149
v_cvt_pk_bf16_f32 v207, v150, v151
v_pk_fma_f32 v[216:217], v[184:185], v[198:199], v[194:195] op_sel:[0,0,1] op_sel_hi:[1,0,1]
v_pk_fma_f32 v[218:219], v[186:187], v[198:199], v[194:195] op_sel:[0,0,1] op_sel_hi:[1,0,1]
v_pk_fma_f32 v[220:221], v[188:189], v[198:199], v[194:195] op_sel:[0,0,1] op_sel_hi:[1,0,1]
v_pk_fma_f32 v[222:223], v[190:191], v[198:199], v[194:195] op_sel:[0,0,1] op_sel_hi:[1,0,1]
v_pk_fma_f32 v[136:137], v[136:137], v[176:177], v[216:217]
v_pk_fma_f32 v[138:139], v[138:139], v[178:179], v[218:219]
v_pk_fma_f32 v[152:153], v[152:153], v[180:181], v[220:221]
v_pk_fma_f32 v[154:155], v[154:155], v[182:183], v[222:223]
v_cvt_pk_bf16_f32 v208, v136, v137
v_cvt_pk_bf16_f32 v209, v138, v139
v_cvt_pk_bf16_f32 v210, v152, v153
v_cvt_pk_bf16_f32 v211, v154, v155
v_pk_fma_f32 v[216:217], v[184:185], v[198:199], v[194:195] op_sel:[0,1,1] op_sel_hi:[1,1,1]
v_pk_fma_f32 v[218:219], v[186:187], v[198:199], v[194:195] op_sel:[0,1,1] op_sel_hi:[1,1,1]
v_pk_fma_f32 v[220:221], v[188:189], v[198:199], v[194:195] op_sel:[0,1,1] op_sel_hi:[1,1,1]
s_add_u32 m0, s63, 53248
s_add_u32 s47, s62, 32768
buffer_load_dwordx4 v232, s[16:19], s47 offen offset:0 lds
v_pk_fma_f32 v[222:223], v[190:191], v[198:199], v[194:195] op_sel:[0,1,1] op_sel_hi:[1,1,1]
v_pk_fma_f32 v[140:141], v[140:141], v[176:177], v[216:217]
v_pk_fma_f32 v[142:143], v[142:143], v[178:179], v[218:219]
v_pk_fma_f32 v[156:157], v[156:157], v[180:181], v[220:221]
v_pk_fma_f32 v[158:159], v[158:159], v[182:183], v[222:223]
v_cvt_pk_bf16_f32 v212, v140, v141
v_cvt_pk_bf16_f32 v213, v142, v143
v_cvt_pk_bf16_f32 v214, v156, v157
v_cvt_pk_bf16_f32 v215, v158, v159
v_mfma_f32_16x16x32_bf16 v[128:131], v[200:203], v[208:211], 0
v_mfma_f32_16x16x32_bf16 v[132:135], v[200:203], a[236:239], 0
v_mfma_f32_16x16x32_bf16 v[136:139], v[204:207], v[212:215], 0
v_mfma_f32_16x16x32_bf16 v[140:143], v[204:207], a[236:239], 0
s_and_b32 s54, s48, 1
s_lshl_b32 s54, s54, 2
s_and_b32 s55, s48, 2
s_add_u32 s54, s54, s55
s_lshl_b32 s55, s54, 10
v_add_u32 v216, s55, v255
s_lshl_b32 s55, s54, 6
v_lshrrev_b32 v217, 8, v255
v_lshl_add_u32 v217, v217, 4, s55
ds_write_b128 v216, v[128:131] offset:36864
ds_write_b128 v217, v[132:135] offset:45056
ds_write_b128 v216, v[136:139] offset:37888
ds_write_b128 v217, v[140:143] offset:45120
v_lshrrev_b32 v216, 2, v255
s_lshl_b32 s54, s48, 10
s_add_u32 s54, s54, 36864
v_add_u32 v217, s54, v216
s_lshl_b32 s54, s48, 6
s_add_u32 s54, s54, 45056
v_add_u32 v218, s54, v216
s_lshl_b32 s55, s50, 2
s_add_u32 s55, s55, s48
s_lshl_b32 s92, s55, 10
s_add_u32 s92, s92, 131072
s_lshl_b32 s93, s55, 6
s_add_u32 s93, s93, 163840
s_waitcnt vmcnt(6) lgkmcnt(0)
s_barrier
ds_read2st64_b32 v[128:129], v217 offset0:0 offset1:16
ds_read2st64_b32 v[130:131], v217 offset0:1 offset1:17
ds_read2st64_b32 v[132:133], v217 offset0:2 offset1:18
ds_read2st64_b32 v[134:135], v217 offset0:3 offset1:19
ds_read2st64_b32 v[136:137], v218 offset0:0 offset1:1
s_mov_b32 s57, 100000
ZP2:
v_sad_u8 v240, v242, 0, v240
v_sad_u8 v240, v243, 0, v240
v_cmp_ne_u32 vcc, 80, v240
s_sub_u32 s57, s57, 1
s_nop 3
s_cbranch_vccz ZP3
global_load_dword v240, v231, s[44:45] sc1
global_load_dwordx2 v[242:243], v230, s[44:45] offset:128 sc1
s_waitcnt vmcnt(0)
s_cmp_lg_u32 s57, 0
s_cbranch_scc1 ZP2
ZP3:
v_or_b32 v240, v242, v243
v_and_b32 v240, 0x0f0f0f0f, v240
s_nop 0
v_readfirstlane_b32 s46, v240
s_waitcnt lgkmcnt(0)
v_add_f32 v128, v128, v129
v_add_f32 v130, v130, v131
v_add_f32 v132, v132, v133
v_add_f32 v134, v134, v135
v_add_f32 v136, v136, v137
buffer_atomic_add_f32 v128, v216, s[28:31], s92 offen offset:0 sc1
buffer_atomic_add_f32 v130, v216, s[28:31], s92 offen offset:256 sc1
buffer_atomic_add_f32 v132, v216, s[28:31], s92 offen offset:512 sc1
buffer_atomic_add_f32 v134, v216, s[28:31], s92 offen offset:768 sc1
s_mov_b64 exec, 0xffff
buffer_atomic_add_f32 v136, v216, s[28:31], s93 offen sc1
s_mov_b64 exec, -1
ds_read_b64_tr_b16 v[192:193], v228 offset:0
ds_read_b64_tr_b16 v[194:195], v228 offset:2048
ds_read_b64_tr_b16 v[196:197], v229 offset:0
ds_read_b64_tr_b16 v[198:199], v229 offset:2048
ds_read_b64_tr_b16 v[200:201], v228 offset:4096
ds_read_b64_tr_b16 v[202:203], v228 offset:6144
ds_read_b64_tr_b16 v[204:205], v229 offset:4096
ds_read_b64_tr_b16 v[206:207], v229 offset:6144
ds_read_b64_tr_b16 v[208:209], v228 offset:8192
ds_read_b64_tr_b16 v[210:211], v228 offset:10240
ds_read_b64_tr_b16 v[212:213], v229 offset:8192
ds_read_b64_tr_b16 v[214:215], v229 offset:10240
s_waitcnt lgkmcnt(10)
v_mfma_f32_16x16x32_bf16 v[168:171], v[192:195], v[0:3], 0
ds_read_b64_tr_b16 v[216:217], v228 offset:12288
v_mfma_f32_16x16x32_bf16 v[176:179], v[192:195], v[64:67], 0
ds_read_b64_tr_b16 v[218:219], v228 offset:14336
v_mfma_f32_16x16x32_bf16 v[184:187], v[192:195], a[236:239], 0
s_waitcnt lgkmcnt(10)
v_mfma_f32_16x16x32_bf16 v[172:175], v[196:199], v[0:3], 0
ds_read_b64_tr_b16 v[220:221], v229 offset:12288
buffer_load_dwordx4 v233, s[16:19], s47 offen offset:1024 lds
v_mfma_f32_16x16x32_bf16 v[180:183], v[196:199], v[64:67], 0
ds_read_b64_tr_b16 v[222:223], v229 offset:14336
v_mfma_f32_16x16x32_bf16 v[188:191], v[196:199], a[236:239], 0
s_waitcnt lgkmcnt(10)
v_mfma_f32_16x16x32_bf16 v[168:171], v[200:203], v[4:7], v[168:171]
ds_read_b64_tr_b16 v[192:193], v228 offset:16384
v_mfma_f32_16x16x32_bf16 v[176:179], v[200:203], v[68:71], v[176:179]
ds_read_b64_tr_b16 v[194:195], v228 offset:18432
v_mfma_f32_16x16x32_bf16 v[184:187], v[200:203], a[236:239], v[184:187]
s_waitcnt lgkmcnt(10)
v_mfma_f32_16x16x32_bf16 v[172:175], v[204:207], v[4:7], v[172:175]
ds_read_b64_tr_b16 v[196:197], v229 offset:16384
buffer_load_dwordx4 v234, s[16:19], s47 offen offset:2048 lds
v_mfma_f32_16x16x32_bf16 v[180:183], v[204:207], v[68:71], v[180:183]
ds_read_b64_tr_b16 v[198:199], v229 offset:18432
v_mfma_f32_16x16x32_bf16 v[188:191], v[204:207], a[236:239], v[188:191]
s_waitcnt lgkmcnt(10)
v_mfma_f32_16x16x32_bf16 v[168:171], v[208:211], v[8:11], v[168:171]
ds_read_b64_tr_b16 v[200:201], v228 offset:20480
v_mfma_f32_16x16x32_bf16 v[176:179], v[208:211], v[72:75], v[176:179]
ds_read_b64_tr_b16 v[202:203], v228 offset:22528
v_mfma_f32_16x16x32_bf16 v[184:187], v[208:211], a[236:239], v[184:187]
s_waitcnt lgkmcnt(10)
v_mfma_f32_16x16x32_bf16 v[172:175], v[212:215], v[8:11], v[172:175]
ds_read_b64_tr_b16 v[204:205], v229 offset:20480
buffer_load_dwordx4 v235, s[16:19], s47 offen offset:3072 lds
v_mfma_f32_16x16x32_bf16 v[180:183], v[212:215], v[72:75], v[180:183]
ds_read_b64_tr_b16 v[206:207], v229 offset:22528
v_mfma_f32_16x16x32_bf16 v[188:191], v[212:215], a[236:239], v[188:191]
s_waitcnt lgkmcnt(10)
v_mfma_f32_16x16x32_bf16 v[168:171], v[216:219], v[12:15], v[168:171]
ds_read_b64_tr_b16 v[208:209], v228 offset:24576
v_mfma_f32_16x16x32_bf16 v[176:179], v[216:219], v[76:79], v[176:179]
ds_read_b64_tr_b16 v[210:211], v228 offset:26624
v_mfma_f32_16x16x32_bf16 v[184:187], v[216:219], a[236:239], v[184:187]
s_waitcnt lgkmcnt(10)
v_mfma_f32_16x16x32_bf16 v[172:175], v[220:223], v[12:15], v[172:175]
ds_read_b64_tr_b16 v[212:213], v229 offset:24576
s_add_u32 m0, s63, 57344
v_mfma_f32_16x16x32_bf16 v[180:183], v[220:223], v[76:79], v[180:183]
ds_read_b64_tr_b16 v[214:215], v229 offset:26624
v_mfma_f32_16x16x32_bf16 v[188:191], v[220:223], a[236:239], v[188:191]
s_waitcnt lgkmcnt(10)
v_mfma_f32_16x16x32_bf16 v[168:171], v[192:195], v[16:19], v[168:171]
ds_read_b64_tr_b16 v[216:217], v224 offset:0
v_mfma_f32_16x16x32_bf16 v[176:179], v[192:195], v[80:83], v[176:179]
ds_read_b64_tr_b16 v[218:219], v224 offset:2048
v_mfma_f32_16x16x32_bf16 v[184:187], v[192:195], a[236:239], v[184:187]
s_waitcnt lgkmcnt(10)
v_mfma_f32_16x16x32_bf16 v[172:175], v[196:199], v[16:19], v[172:175]
ds_read_b64_tr_b16 v[220:221], v225 offset:0
s_add_u32 s47, s62, 65536
v_mfma_f32_16x16x32_bf16 v[180:183], v[196:199], v[80:83], v[180:183]
ds_read_b64_tr_b16 v[222:223], v225 offset:2048
v_mfma_f32_16x16x32_bf16 v[188:191], v[196:199], a[236:239], v[188:191]
s_waitcnt lgkmcnt(10)
v_mfma_f32_16x16x32_bf16 v[168:171], v[200:203], v[20:23], v[168:171]
ds_read_b64_tr_b16 v[192:193], v224 offset:4096
v_mfma_f32_16x16x32_bf16 v[176:179], v[200:203], v[84:87], v[176:179]
ds_read_b64_tr_b16 v[194:195], v224 offset:6144
v_mfma_f32_16x16x32_bf16 v[184:187], v[200:203], a[236:239], v[184:187]
s_waitcnt lgkmcnt(10)
v_mfma_f32_16x16x32_bf16 v[172:175], v[204:207], v[20:23], v[172:175]
ds_read_b64_tr_b16 v[196:197], v225 offset:4096
buffer_load_dwordx4 v232, s[16:19], s47 offen offset:0 lds
v_mfma_f32_16x16x32_bf16 v[180:183], v[204:207], v[84:87], v[180:183]
ds_read_b64_tr_b16 v[198:199], v225 offset:6144
v_mfma_f32_16x16x32_bf16 v[188:191], v[204:207], a[236:239], v[188:191]
s_waitcnt lgkmcnt(10)
v_mfma_f32_16x16x32_bf16 v[168:171], v[208:211], v[24:27], v[168:171]
ds_read_b64_tr_b16 v[200:201], v224 offset:8192
v_mfma_f32_16x16x32_bf16 v[176:179], v[208:211], v[88:91], v[176:179]
ds_read_b64_tr_b16 v[202:203], v224 offset:10240
v_mfma_f32_16x16x32_bf16 v[184:187], v[208:211], a[236:239], v[184:187]
s_waitcnt lgkmcnt(10)
v_mfma_f32_16x16x32_bf16 v[172:175], v[212:215], v[24:27], v[172:175]
ds_read_b64_tr_b16 v[204:205], v225 offset:8192
buffer_load_dwordx4 v233, s[16:19], s47 offen offset:1024 lds
v_mfma_f32_16x16x32_bf16 v[180:183], v[212:215], v[88:91], v[180:183]
ds_read_b64_tr_b16 v[206:207], v225 offset:10240
v_mfma_f32_16x16x32_bf16 v[188:191], v[212:215], a[236:239], v[188:191]
s_waitcnt lgkmcnt(10)
v_mfma_f32_16x16x32_bf16 v[168:171], v[216:219], v[28:31], v[168:171]
ds_read_b64_tr_b16 v[208:209], v224 offset:12288
buffer_load_dwordx4 v234, s[16:19], s47 offen offset:2048 lds
v_mfma_f32_16x16x32_bf16 v[176:179], v[216:219], v[92:95], v[176:179]
ds_read_b64_tr_b16 v[210:211], v224 offset:14336
v_mfma_f32_16x16x32_bf16 v[184:187], v[216:219], a[236:239], v[184:187]
s_waitcnt lgkmcnt(10)
v_mfma_f32_16x16x32_bf16 v[172:175], v[220:223], v[28:31], v[172:175]
ds_read_b64_tr_b16 v[212:213], v225 offset:12288
v_mfma_f32_16x16x32_bf16 v[180:183], v[220:223], v[92:95], v[180:183]
ds_read_b64_tr_b16 v[214:215], v225 offset:14336
v_mfma_f32_16x16x32_bf16 v[188:191], v[220:223], a[236:239], v[188:191]
s_waitcnt lgkmcnt(10)
v_mfma_f32_16x16x32_bf16 v[168:171], v[192:195], v[32:35], v[168:171]
ds_read_b64_tr_b16 v[216:217], v224 offset:16384
buffer_load_dwordx4 v235, s[16:19], s47 offen offset:3072 lds
v_mfma_f32_16x16x32_bf16 v[176:179], v[192:195], v[96:99], v[176:179]
ds_read_b64_tr_b16 v[218:219], v224 offset:18432
v_mfma_f32_16x16x32_bf16 v[184:187], v[192:195], a[236:239], v[184:187]
s_waitcnt lgkmcnt(10)
v_mfma_f32_16x16x32_bf16 v[172:175], v[196:199], v[32:35], v[172:175]
ds_read_b64_tr_b16 v[220:221], v225 offset:16384
v_mfma_f32_16x16x32_bf16 v[180:183], v[196:199], v[96:99], v[180:183]
ds_read_b64_tr_b16 v[222:223], v225 offset:18432
v_mfma_f32_16x16x32_bf16 v[188:191], v[196:199], a[236:239], v[188:191]
s_waitcnt lgkmcnt(10)
v_mfma_f32_16x16x32_bf16 v[168:171], v[200:203], v[36:39], v[168:171]
ds_read_b64_tr_b16 v[192:193], v224 offset:20480
s_add_u32 m0, s63, 61440
v_mfma_f32_16x16x32_bf16 v[176:179], v[200:203], v[100:103], v[176:179]
ds_read_b64_tr_b16 v[194:195], v224 offset:22528
v_mfma_f32_16x16x32_bf16 v[184:187], v[200:203], a[236:239], v[184:187]
s_waitcnt lgkmcnt(10)
v_mfma_f32_16x16x32_bf16 v[172:175], v[204:207], v[36:39], v[172:175]
ds_read_b64_tr_b16 v[196:197], v225 offset:20480
v_mfma_f32_16x16x32_bf16 v[180:183], v[204:207], v[100:103], v[180:183]
ds_read_b64_tr_b16 v[198:199], v225 offset:22528
v_mfma_f32_16x16x32_bf16 v[188:191], v[204:207], a[236:239], v[188:191]
s_waitcnt lgkmcnt(10)
v_mfma_f32_16x16x32_bf16 v[168:171], v[208:211], v[40:43], v[168:171]
ds_read_b64_tr_b16 v[200:201], v224 offset:24576
s_add_u32 s47, s62, 98304
v_mfma_f32_16x16x32_bf16 v[176:179], v[208:211], v[104:107], v[176:179]
ds_read_b64_tr_b16 v[202:203], v224 offset:26624
v_mfma_f32_16x16x32_bf16 v[184:187], v[208:211], a[236:239], v[184:187]
s_waitcnt lgkmcnt(10)
v_mfma_f32_16x16x32_bf16 v[172:175], v[212:215], v[40:43], v[172:175]
ds_read_b64_tr_b16 v[204:205], v225 offset:24576
v_mfma_f32_16x16x32_bf16 v[180:183], v[212:215], v[104:107], v[180:183]
ds_read_b64_tr_b16 v[206:207], v225 offset:26624
v_mfma_f32_16x16x32_bf16 v[188:191], v[212:215], a[236:239], v[188:191]
s_waitcnt lgkmcnt(10)
v_mfma_f32_16x16x32_bf16 v[168:171], v[216:219], v[44:47], v[168:171]
ds_read_b64_tr_b16 v[208:209], v224 offset:28672
buffer_load_dwordx4 v232, s[16:19], s47 offen offset:0 lds
v_mfma_f32_16x16x32_bf16 v[176:179], v[216:219], v[108:111], v[176:179]
ds_read_b64_tr_b16 v[210:211], v224 offset:30720
v_mfma_f32_16x16x32_bf16 v[184:187], v[216:219], a[236:239], v[184:187]
s_waitcnt lgkmcnt(10)
v_mfma_f32_16x16x32_bf16 v[172:175], v[220:223], v[44:47], v[172:175]
ds_read_b64_tr_b16 v[212:213], v225 offset:28672
v_mfma_f32_16x16x32_bf16 v[180:183], v[220:223], v[108:111], v[180:183]
ds_read_b64_tr_b16 v[214:215], v225 offset:30720
v_mfma_f32_16x16x32_bf16 v[188:191], v[220:223], a[236:239], v[188:191]
s_waitcnt lgkmcnt(10)
v_mfma_f32_16x16x32_bf16 v[168:171], v[192:195], v[48:51], v[168:171]
ds_read_b64_tr_b16 v[216:217], v224 offset:32768
buffer_load_dwordx4 v233, s[16:19], s47 offen offset:1024 lds
v_mfma_f32_16x16x32_bf16 v[176:179], v[192:195], v[112:115], v[176:179]
ds_read_b64_tr_b16 v[218:219], v224 offset:34816
v_mfma_f32_16x16x32_bf16 v[184:187], v[192:195], a[236:239], v[184:187]
s_waitcnt lgkmcnt(10)
v_mfma_f32_16x16x32_bf16 v[172:175], v[196:199], v[48:51], v[172:175]
ds_read_b64_tr_b16 v[220:221], v225 offset:32768
v_mfma_f32_16x16x32_bf16 v[180:183], v[196:199], v[112:115], v[180:183]
ds_read_b64_tr_b16 v[222:223], v225 offset:34816
v_mfma_f32_16x16x32_bf16 v[188:191], v[196:199], a[236:239], v[188:191]
s_waitcnt lgkmcnt(10)
v_mfma_f32_16x16x32_bf16 v[168:171], v[200:203], v[52:55], v[168:171]
buffer_load_dwordx4 v234, s[16:19], s47 offen offset:2048 lds
v_mfma_f32_16x16x32_bf16 v[176:179], v[200:203], v[116:119], v[176:179]
v_mfma_f32_16x16x32_bf16 v[184:187], v[200:203], a[236:239], v[184:187]
s_waitcnt lgkmcnt(8)
v_mfma_f32_16x16x32_bf16 v[172:175], v[204:207], v[52:55], v[172:175]
buffer_load_dwordx4 v235, s[16:19], s47 offen offset:3072 lds
v_mfma_f32_16x16x32_bf16 v[180:183], v[204:207], v[116:119], v[180:183]
v_mfma_f32_16x16x32_bf16 v[188:191], v[204:207], a[236:239], v[188:191]
s_waitcnt lgkmcnt(6)
v_mfma_f32_16x16x32_bf16 v[168:171], v[208:211], v[56:59], v[168:171]
v_mfma_f32_16x16x32_bf16 v[176:179], v[208:211], v[120:123], v[176:179]
v_mfma_f32_16x16x32_bf16 v[184:187], v[208:211], a[236:239], v[184:187]
s_waitcnt lgkmcnt(4)
v_mfma_f32_16x16x32_bf16 v[172:175], v[212:215], v[56:59], v[172:175]
v_mfma_f32_16x16x32_bf16 v[180:183], v[212:215], v[120:123], v[180:183]
v_mfma_f32_16x16x32_bf16 v[188:191], v[212:215], a[236:239], v[188:191]
s_waitcnt lgkmcnt(2)
v_mfma_f32_16x16x32_bf16 v[168:171], v[216:219], v[60:63], v[168:171]
v_mfma_f32_16x16x32_bf16 v[176:179], v[216:219], v[124:127], v[176:179]
v_mfma_f32_16x16x32_bf16 v[184:187], v[216:219], a[236:239], v[184:187]
s_waitcnt lgkmcnt(0)
v_mfma_f32_16x16x32_bf16 v[172:175], v[220:223], v[60:63], v[172:175]
v_mfma_f32_16x16x32_bf16 v[180:183], v[220:223], v[124:127], v[180:183]
v_mfma_f32_16x16x32_bf16 v[188:191], v[220:223], a[236:239], v[188:191]
v_mov_b32 v216, 159744
v_mov_b32 v217, 1
s_lshl_b32 s54, s50, 5
s_add_u32 s54, s54, s49
s_lshr_b32 s54, s54, 0
s_lshl_b32 s54, s54, 7
s_and_b32 s55, s49, 0
s_lshl_b32 s55, s55, 2
s_add_u32 s54, s54, s55
s_add_u32 s54, s54, 32768
s_waitcnt vmcnt(11)
s_mov_b64 exec, 1
ds_add_rtn_u32 v218, v216, v217
s_waitcnt lgkmcnt(0)
v_cmp_ne_u32 vcc, 3, v218
s_nop 4
s_cbranch_vccnz KS4
buffer_store_dword v217, off, s[28:31], s54 sc1
KS4:
s_mov_b64 exec, -1
v_mov_b32 v192, 0x3fb8aa3b
v_mov_b32 v193, 0xb5c1a2a0
v_mov_b32 v194, s61
v_accvgpr_write_b32 a228, v184
v_accvgpr_write_b32 a229, v185
v_accvgpr_write_b32 a230, v186
v_accvgpr_write_b32 a231, v187
v_accvgpr_write_b32 a232, v188
v_accvgpr_write_b32 a233, v189
v_accvgpr_write_b32 a234, v190
v_accvgpr_write_b32 a235, v191
s_and_b32 s54, s48, 1
s_lshl_b32 s54, s54, 1
s_lshl_b32 s55, s49, 2
s_add_u32 s54, s54, s55
s_mul_i32 s54, s54, 57344
s_lshl_b32 s55, s50, 1
s_lshr_b32 s56, s48, 1
s_add_u32 s55, s55, s56
s_lshl_b32 s55, s55, 10
s_add_u32 s54, s54, s55
s_add_u32 s54, s54, 11534336
v_pk_fma_f32 v[216:217], v[184:185], v[236:237], v[194:195] op_sel:[0,1,0] op_sel_hi:[1,1,0]
v_pk_fma_f32 v[218:219], v[186:187], v[236:237], v[194:195] op_sel:[0,1,0] op_sel_hi:[1,1,0]
v_pk_fma_f32 v[220:221], v[188:189], v[236:237], v[194:195] op_sel:[0,1,0] op_sel_hi:[1,1,0]
v_pk_fma_f32 v[222:223], v[190:191], v[236:237], v[194:195] op_sel:[0,1,0] op_sel_hi:[1,1,0]
v_pk_fma_f32 v[168:169], v[168:169], v[236:237], v[216:217] op_sel:[0,0,0] op_sel_hi:[1,0,1]
v_pk_fma_f32 v[170:171], v[170:171], v[236:237], v[218:219] op_sel:[0,0,0] op_sel_hi:[1,0,1]
v_pk_fma_f32 v[172:173], v[172:173], v[236:237], v[220:221] op_sel:[0,0,0] op_sel_hi:[1,0,1]
v_pk_fma_f32 v[174:175], v[174:175], v[236:237], v[222:223] op_sel:[0,0,0] op_sel_hi:[1,0,1]
v_pk_fma_f32 v[216:217], v[168:169], v[192:193], v[192:193] op_sel:[0,0,1] op_sel_hi:[1,0,1]
v_pk_fma_f32 v[218:219], v[170:171], v[192:193], v[192:193] op_sel:[0,0,1] op_sel_hi:[1,0,1]
v_pk_fma_f32 v[220:221], v[172:173], v[192:193], v[192:193] op_sel:[0,0,1] op_sel_hi:[1,0,1]
v_pk_fma_f32 v[222:223], v[174:175], v[192:193], v[192:193] op_sel:[0,0,1] op_sel_hi:[1,0,1]
v_exp_f32_e64 v216, v216 clamp
v_exp_f32_e64 v218, v218 clamp
v_exp_f32_e64 v220, v220 clamp
v_exp_f32_e64 v222, v222 clamp
v_exp_f32_e64 v217, v217 clamp
v_exp_f32_e64 v219, v219 clamp
v_exp_f32_e64 v221, v221 clamp
v_exp_f32_e64 v223, v223 clamp
v_max_f32 v168, s61, v168
v_max_f32 v170, s61, v170
v_max_f32 v172, s61, v172
v_max_f32 v174, s61, v174
v_max_f32 v169, s61, v169
v_max_f32 v171, s61, v171
v_max_f32 v173, s61, v173
v_max_f32 v175, s61, v175
v_pk_add_f32 v[168:169], v[168:169], v[216:217]
v_pk_add_f32 v[170:171], v[170:171], v[218:219]
v_pk_add_f32 v[172:173], v[172:173], v[220:221]
v_pk_add_f32 v[174:175], v[174:175], v[222:223]
v_cvt_pk_bf16_f32 v200, v168, v169
v_cvt_pk_bf16_f32 v201, v170, v171
v_cvt_pk_bf16_f32 v202, v172, v173
v_cvt_pk_bf16_f32 v203, v174, v175
buffer_store_dwordx4 v[200:203], v255, s[28:31], s54 offen
s_add_u32 s54, s54, 57344
v_pk_fma_f32 v[216:217], v[184:185], v[238:239], v[194:195] op_sel:[0,1,0] op_sel_hi:[1,1,0]
v_pk_fma_f32 v[218:219], v[186:187], v[238:239], v[194:195] op_sel:[0,1,0] op_sel_hi:[1,1,0]
v_pk_fma_f32 v[220:221], v[188:189], v[238:239], v[194:195] op_sel:[0,1,0] op_sel_hi:[1,1,0]
v_pk_fma_f32 v[222:223], v[190:191], v[238:239], v[194:195] op_sel:[0,1,0] op_sel_hi:[1,1,0]
v_pk_fma_f32 v[176:177], v[176:177], v[238:239], v[216:217] op_sel:[0,0,0] op_sel_hi:[1,0,1]
v_pk_fma_f32 v[178:179], v[178:179], v[238:239], v[218:219] op_sel:[0,0,0] op_sel_hi:[1,0,1]
v_pk_fma_f32 v[180:181], v[180:181], v[238:239], v[220:221] op_sel:[0,0,0] op_sel_hi:[1,0,1]
v_pk_fma_f32 v[182:183], v[182:183], v[238:239], v[222:223] op_sel:[0,0,0] op_sel_hi:[1,0,1]
v_pk_fma_f32 v[216:217], v[176:177], v[192:193], v[192:193] op_sel:[0,0,1] op_sel_hi:[1,0,1]
v_pk_fma_f32 v[218:219], v[178:179], v[192:193], v[192:193] op_sel:[0,0,1] op_sel_hi:[1,0,1]
v_pk_fma_f32 v[220:221], v[180:181], v[192:193], v[192:193] op_sel:[0,0,1] op_sel_hi:[1,0,1]
v_pk_fma_f32 v[222:223], v[182:183], v[192:193], v[192:193] op_sel:[0,0,1] op_sel_hi:[1,0,1]
v_exp_f32_e64 v216, v216 clamp
v_exp_f32_e64 v218, v218 clamp
v_exp_f32_e64 v220, v220 clamp
v_exp_f32_e64 v222, v222 clamp
v_exp_f32_e64 v217, v217 clamp
v_exp_f32_e64 v219, v219 clamp
v_exp_f32_e64 v221, v221 clamp
v_exp_f32_e64 v223, v223 clamp
v_max_f32 v176, s61, v176
v_max_f32 v178, s61, v178
v_max_f32 v180, s61, v180
v_max_f32 v182, s61, v182
v_max_f32 v177, s61, v177
v_max_f32 v179, s61, v179
v_max_f32 v181, s61, v181
v_max_f32 v183, s61, v183
v_pk_add_f32 v[176:177], v[176:177], v[216:217]
v_pk_add_f32 v[178:179], v[178:179], v[218:219]
v_pk_add_f32 v[180:181], v[180:181], v[220:221]
v_pk_add_f32 v[182:183], v[182:183], v[222:223]
v_cvt_pk_bf16_f32 v204, v176, v177
v_cvt_pk_bf16_f32 v205, v178, v179
v_cvt_pk_bf16_f32 v206, v180, v181
v_cvt_pk_bf16_f32 v207, v182, v183
buffer_store_dwordx4 v[204:207], v255, s[28:31], s54 offen
s_add_u32 s55, s63, 49152
v_add_u32 v224, s55, v254
v_xor_b32 v225, 32, v224
v_xor_b32 v226, 64, v224
v_xor_b32 v227, 96, v224
s_lshl_b32 s59, s49, 7
s_add_u32 s59, s59, 0
s_lshl_b32 s56, s50, 2
s_add_u32 s56, s56, s48
s_lshl_b32 s56, s56, 2
s_add_u32 s56, s56, s59
v_bfe_u32 v231, v255, 4, 3
v_lshlrev_b32 v231, 2, v231
s_waitcnt vmcnt(0)
s_mov_b64 exec, 1
v_mov_b32 v243, 1
s_cmp_lg_u32 s46, 0
s_cbranch_scc1 SG6
buffer_store_dword v243, off, s[28:31], s56
s_branch SG5
SG6:
buffer_wbl2 sc1
s_waitcnt vmcnt(0)
buffer_store_dword v243, off, s[28:31], s56 sc1
SG5:
s_mov_b64 exec, -1
v_lshlrev_b32 v229, 3, v255
s_lshr_b32 s47, s53, 3
s_lshl_b32 s47, s47, 2
s_add_u32 s47, s47, s48
s_mul_i32 s47, s47, 14336
s_add_u32 s47, s47, 6144
buffer_load_dword v112, v229, s[20:23], s47 offen
ds_read_b64_tr_b16 v[64:65], v224 offset:0
ds_read_b64_tr_b16 v[66:67], v224 offset:2048
ds_read_b64_tr_b16 v[68:69], v225 offset:0
ds_read_b64_tr_b16 v[70:71], v225 offset:2048
ds_read_b64_tr_b16 v[72:73], v226 offset:0
ds_read_b64_tr_b16 v[74:75], v226 offset:2048
ds_read_b64_tr_b16 v[76:77], v227 offset:0
ds_read_b64_tr_b16 v[78:79], v227 offset:2048
ds_read_b64_tr_b16 v[80:81], v224 offset:4096
ds_read_b64_tr_b16 v[82:83], v224 offset:6144
ds_read_b64_tr_b16 v[84:85], v225 offset:4096
ds_read_b64_tr_b16 v[86:87], v225 offset:6144
ds_read_b64_tr_b16 v[88:89], v226 offset:4096
ds_read_b64_tr_b16 v[90:91], v226 offset:6144
ds_read_b64_tr_b16 v[92:93], v227 offset:4096
ds_read_b64_tr_b16 v[94:95], v227 offset:6144
ds_read_b64_tr_b16 v[96:97], v224 offset:8192
ds_read_b64_tr_b16 v[98:99], v224 offset:10240
ds_read_b64_tr_b16 v[100:101], v225 offset:8192
ds_read_b64_tr_b16 v[102:103], v225 offset:10240
ds_read_b64_tr_b16 v[104:105], v226 offset:8192
ds_read_b64_tr_b16 v[106:107], v226 offset:10240
ds_read_b64_tr_b16 v[108:109], v227 offset:8192
ds_read_b64_tr_b16 v[110:111], v227 offset:10240
ds_read_b64_tr_b16 a[240:241], v224 offset:12288
ds_read_b64_tr_b16 a[242:243], v224 offset:14336
ds_read_b64_tr_b16 a[244:245], v225 offset:12288
ds_read_b64_tr_b16 a[246:247], v225 offset:14336
ds_read_b64_tr_b16 a[248:249], v226 offset:12288
ds_read_b64_tr_b16 a[250:251], v226 offset:14336
ds_read_b64_tr_b16 a[252:253], v227 offset:12288
ds_read_b64_tr_b16 a[254:255], v227 offset:14336
s_mul_i32 s54, s49, 229376
s_mul_i32 s55, s48, 4096
s_add_u32 s54, s54, s55
s_add_u32 s54, s54, 11534336
s_add_u32 s55, s48, 0
s_and_b32 s55, s55, 3
s_mul_i32 s55, s55, 57344
s_add_u32 s62, s54, s55
s_add_u32 s55, s48, 1
s_and_b32 s55, s55, 3
s_mul_i32 s55, s55, 57344
s_add_u32 s63, s54, s55
s_add_u32 s55, s48, 2
s_and_b32 s55, s55, 3
s_mul_i32 s55, s55, 57344
s_add_u32 s64, s54, s55
s_add_u32 s55, s48, 3
s_and_b32 s55, s55, 3
s_mul_i32 s55, s55, 57344
s_add_u32 s65, s54, s55
v_mul_u32_u24 v232, 3584, v253
v_add_u32 v232, v232, v252
v_add_u32 v233, 27648, v232
v_add_u32 v234, 55296, v232
v_add_u32 v235, 82944, v232
v_bfe_u32 v228, v255, 4, 4
v_lshrrev_b32 v229, 6, v255
v_and_b32 v229, 12, v229
v_sub_u32 v228, v228, v229
v_cmp_gt_u32 vcc, 4, v228
v_mov_b32 v126, 0x3f80
v_mov_b32 v127, 0
v_lshlrev_b32 v228, 4, v228
v_cndmask_b32 v126, 0, v126, vcc
v_lshlrev_b64 v[126:127], v228, v[126:127]
v_bfe_u32 v224, v255, 4, 1
v_cmp_eq_u32_e64 s[90:91], 0, v224
v_lshlrev_b32 v224, 6, v224
v_lshrrev_b32 v225, 8, v255
v_lshl_add_u32 v224, v225, 4, v224
s_lshl_b32 s88, s48, 13
s_lshl_b32 s92, s48, 13
s_add_u32 s88, s88, 32768
s_add_u32 s92, s92, 131072
s_add_u32 s93, s92, 4096
s_lshl_b32 s94, s48, 9
s_add_u32 s94, s94, 163840
s_mul_i32 s58, s48, 114688
s_lshl_b32 s54, s52, 8
s_add_u32 s58, s58, s54
s_lshl_b32 s95, s48, 12
s_lshl_b32 s54, s48, 5
s_add_u32 s59, s59, s54
s_waitcnt lgkmcnt(0)
s_barrier
s_mov_b32 s57, 100000
PL7:
buffer_load_dword v230, v231, s[28:31], s59 offen sc1
s_waitcnt vmcnt(0)
v_cmp_ne_u32 vcc, 1, v230
s_sub_u32 s57, s57, 1
s_nop 3
s_cbranch_vccz PL8
s_cmp_lg_u32 s57, 0
s_cbranch_scc1 PL7
PL8:
buffer_load_dwordx4 v[0:3], v255, s[28:31], s62 offen offset:0 sc1
buffer_load_dwordx4 v[16:19], v255, s[28:31], s63 offen offset:0 sc1
buffer_load_dwordx4 v[32:35], v255, s[28:31], s64 offen offset:0 sc1
buffer_load_dwordx4 v[48:51], v255, s[28:31], s65 offen offset:0 sc1
buffer_load_dwordx4 v[4:7], v255, s[28:31], s62 offen offset:1024 sc1
buffer_load_dwordx4 v[20:23], v255, s[28:31], s63 offen offset:1024 sc1
buffer_load_dwordx4 v[36:39], v255, s[28:31], s64 offen offset:1024 sc1
buffer_load_dwordx4 v[52:55], v255, s[28:31], s65 offen offset:1024 sc1
buffer_load_dwordx4 v[8:11], v255, s[28:31], s62 offen offset:2048 sc1
buffer_load_dwordx4 v[24:27], v255, s[28:31], s63 offen offset:2048 sc1
buffer_load_dwordx4 v[40:43], v255, s[28:31], s64 offen offset:2048 sc1
buffer_load_dwordx4 v[56:59], v255, s[28:31], s65 offen offset:2048 sc1
buffer_load_dwordx4 v[12:15], v255, s[28:31], s62 offen offset:3072 sc1
buffer_load_dwordx4 v[28:31], v255, s[28:31], s63 offen offset:3072 sc1
buffer_load_dwordx4 v[44:47], v255, s[28:31], s64 offen offset:3072 sc1
buffer_load_dwordx4 v[60:63], v255, s[28:31], s65 offen offset:3072 sc1
v_lshrrev_b32 v231, 4, v255
v_lshlrev_b32 v231, 7, v231
v_bfe_u32 v230, v255, 4, 0
v_lshl_add_u32 v231, v230, 2, v231
s_mov_b32 s57, 100000
PL9:
buffer_load_dword v230, v231, s[28:31], s88 offen sc1
s_waitcnt vmcnt(0)
v_cmp_ne_u32 vcc, 1, v230
s_sub_u32 s57, s57, 1
s_nop 3
s_cbranch_vccz PL10
s_cmp_lg_u32 s57, 0
s_cbranch_scc1 PL9
PL10:
buffer_load_dwordx4 v[160:163], v224, s[28:31], s94 offen offset:0 sc1
buffer_load_dwordx4 v[128:131], v255, s[28:31], s92 offen offset:0 sc1
buffer_load_dwordx4 v[132:135], v255, s[28:31], s92 offen offset:1024 sc1
buffer_load_dwordx4 v[164:167], v224, s[28:31], s94 offen offset:128 sc1
buffer_load_dwordx4 v[136:139], v255, s[28:31], s92 offen offset:2048 sc1
buffer_load_dwordx4 v[140:143], v255, s[28:31], s92 offen offset:3072 sc1
buffer_load_dwordx4 v[168:171], v224, s[28:31], s94 offen offset:256 sc1
buffer_load_dwordx4 v[144:147], v255, s[28:31], s93 offen offset:0 sc1
buffer_load_dwordx4 v[148:151], v255, s[28:31], s93 offen offset:1024 sc1
buffer_load_dwordx4 v[172:175], v224, s[28:31], s94 offen offset:384 sc1
buffer_load_dwordx4 v[152:155], v255, s[28:31], s93 offen offset:2048 sc1
buffer_load_dwordx4 v[156:159], v255, s[28:31], s93 offen offset:3072 sc1
s_add_u32 m0, s95, 0
s_add_u32 s47, s58, 0
buffer_load_dwordx4 v232, s[20:23], s47 offen offset:0 lds
buffer_load_dwordx4 v233, s[20:23], s47 offen offset:1024 lds
buffer_load_dwordx4 v234, s[20:23], s47 offen offset:2048 lds
buffer_load_dwordx4 v235, s[20:23], s47 offen offset:3072 lds
s_add_u32 m0, s95, 65536
s_add_u32 s47, s58, 128
buffer_load_dwordx4 v232, s[20:23], s47 offen offset:0 lds
buffer_load_dwordx4 v233, s[20:23], s47 offen offset:1024 lds
buffer_load_dwordx4 v234, s[20:23], s47 offen offset:2048 lds
buffer_load_dwordx4 v235, s[20:23], s47 offen offset:3072 lds
s_add_u32 m0, s95, 16384
s_add_u32 s47, s58, 458752
buffer_load_dwordx4 v232, s[20:23], s47 offen offset:0 lds
buffer_load_dwordx4 v233, s[20:23], s47 offen offset:1024 lds
buffer_load_dwordx4 v234, s[20:23], s47 offen offset:2048 lds
buffer_load_dwordx4 v235, s[20:23], s47 offen offset:3072 lds
v_mov_b32 v224, s61
v_mov_b32 v225, s61
v_mov_b32 v226, s61
v_mov_b32 v227, s61
s_waitcnt vmcnt(21)
v_cvt_pk_bf16_f32 v192, v128, v129
v_cvt_pk_bf16_f32 v193, v130, v131
v_cvt_pk_bf16_f32 v194, v132, v133
v_cvt_pk_bf16_f32 v195, v134, v135
v_cvt_pk_bf16_f32 v176, v160, v161
v_cndmask_b32_e64 v208, 0, v176, s[90:91]
v_cndmask_b32_e64 v210, v176, 0, s[90:91]
v_cvt_pk_bf16_f32 v177, v162, v163
v_cndmask_b32_e64 v209, 0, v177, s[90:91]
v_cndmask_b32_e64 v211, v177, 0, s[90:91]
s_waitcnt vmcnt(18)
v_cvt_pk_bf16_f32 v196, v136, v137
v_cvt_pk_bf16_f32 v197, v138, v139
v_cvt_pk_bf16_f32 v198, v140, v141
v_cvt_pk_bf16_f32 v199, v142, v143
v_cvt_pk_bf16_f32 v178, v164, v165
v_cndmask_b32_e64 v212, 0, v178, s[90:91]
v_cndmask_b32_e64 v214, v178, 0, s[90:91]
v_cvt_pk_bf16_f32 v179, v166, v167
v_cndmask_b32_e64 v213, 0, v179, s[90:91]
v_cndmask_b32_e64 v215, v179, 0, s[90:91]
s_waitcnt vmcnt(15)
v_cvt_pk_bf16_f32 v200, v144, v145
v_cvt_pk_bf16_f32 v201, v146, v147
v_cvt_pk_bf16_f32 v202, v148, v149
v_cvt_pk_bf16_f32 v203, v150, v151
v_cvt_pk_bf16_f32 v180, v168, v169
v_cndmask_b32_e64 v216, 0, v180, s[90:91]
v_cndmask_b32_e64 v218, v180, 0, s[90:91]
v_cvt_pk_bf16_f32 v181, v170, v171
v_cndmask_b32_e64 v217, 0, v181, s[90:91]
v_cndmask_b32_e64 v219, v181, 0, s[90:91]
s_waitcnt vmcnt(12)
v_cvt_pk_bf16_f32 v204, v152, v153
v_cvt_pk_bf16_f32 v205, v154, v155
v_cvt_pk_bf16_f32 v206, v156, v157
v_cvt_pk_bf16_f32 v207, v158, v159
v_cvt_pk_bf16_f32 v182, v172, v173
v_cndmask_b32_e64 v220, 0, v182, s[90:91]
v_cndmask_b32_e64 v222, v182, 0, s[90:91]
v_cvt_pk_bf16_f32 v183, v174, v175
v_cndmask_b32_e64 v221, 0, v183, s[90:91]
v_cndmask_b32_e64 v223, v183, 0, s[90:91]
v_mfma_f32_16x16x32_bf16 v[240:243], v[208:211], v[0:3], v[224:227]
v_mfma_f32_16x16x16_bf16 v[228:231], v[192:193], v[0:1], 0
v_mfma_f32_16x16x16_bf16 v[236:239], v[194:195], v[2:3], 0
v_mfma_f32_16x16x32_bf16 v[120:123], v[208:211], v[16:19], v[224:227]
s_nop 4
v_rcp_f32 v240, v240
v_rcp_f32 v241, v241
v_mfma_f32_16x16x16_bf16 v[112:115], v[192:193], v[16:17], 0
v_mul_f32 v228, v228, v240
v_mul_f32 v229, v229, v240
v_mfma_f32_16x16x16_bf16 v[116:119], v[194:195], v[18:19], 0
v_mul_f32 v230, v230, v240
v_mul_f32 v231, v231, v240
v_mfma_f32_16x16x16_bf16 v[128:131], v[126:127], v[244:245], 0
v_mul_f32 v236, v236, v241
v_mul_f32 v237, v237, v241
v_mfma_f32_16x16x16_bf16 v[132:135], v[126:127], v[246:247], 0
v_mul_f32 v238, v238, v241
v_mul_f32 v239, v239, v241
v_mfma_f32_16x16x16_bf16 v[136:139], v[126:127], v[248:249], 0
v_cvt_pk_bf16_f32 v0, v228, v229
v_cvt_pk_bf16_f32 v1, v230, v231
v_mfma_f32_16x16x16_bf16 v[140:143], v[126:127], v[250:251], 0
v_cvt_pk_bf16_f32 v2, v236, v237
v_cvt_pk_bf16_f32 v3, v238, v239
s_add_u32 m0, s95, 81920
s_add_u32 s47, s58, 458880
buffer_load_dwordx4 v232, s[20:23], s47 offen offset:0 lds
v_mfma_f32_16x16x32_bf16 v[240:243], v[208:211], v[32:35], v[224:227]
v_rcp_f32 v120, v120
v_rcp_f32 v121, v121
v_mfma_f32_16x16x16_bf16 v[228:231], v[192:193], v[32:33], 0
v_mul_f32 v112, v112, v120
v_mul_f32 v113, v113, v120
v_mfma_f32_16x16x16_bf16 v[236:239], v[194:195], v[34:35], 0
v_mul_f32 v114, v114, v120
v_mul_f32 v115, v115, v120
v_mfma_f32_16x16x32_bf16 v[128:131], v[64:67], v[0:3], v[128:131]
v_mul_f32 v116, v116, v121
v_mul_f32 v117, v117, v121
v_mfma_f32_16x16x32_bf16 v[132:135], v[68:71], v[0:3], v[132:135]
v_mul_f32 v118, v118, v121
v_mul_f32 v119, v119, v121
v_mfma_f32_16x16x32_bf16 v[136:139], v[72:75], v[0:3], v[136:139]
v_cvt_pk_bf16_f32 v16, v112, v113
v_cvt_pk_bf16_f32 v17, v114, v115
v_mfma_f32_16x16x32_bf16 v[140:143], v[76:79], v[0:3], v[140:143]
v_cvt_pk_bf16_f32 v18, v116, v117
v_cvt_pk_bf16_f32 v19, v118, v119
buffer_load_dwordx4 v233, s[20:23], s47 offen offset:1024 lds
buffer_load_dwordx4 v234, s[20:23], s47 offen offset:2048 lds
buffer_load_dwordx4 v235, s[20:23], s47 offen offset:3072 lds
v_mfma_f32_16x16x32_bf16 v[120:123], v[208:211], v[48:51], v[224:227]
v_rcp_f32 v240, v240
v_rcp_f32 v241, v241
v_mfma_f32_16x16x16_bf16 v[112:115], v[192:193], v[48:49], 0
v_mul_f32 v228, v228, v240
v_mul_f32 v229, v229, v240
v_mfma_f32_16x16x16_bf16 v[116:119], v[194:195], v[50:51], 0
v_mul_f32 v230, v230, v240
v_mul_f32 v231, v231, v240
v_mfma_f32_16x16x32_bf16 v[144:147], v[64:67], v[16:19], 0
v_mul_f32 v236, v236, v241
v_mul_f32 v237, v237, v241
v_mfma_f32_16x16x32_bf16 v[148:151], v[68:71], v[16:19], 0
v_mul_f32 v238, v238, v241
v_mul_f32 v239, v239, v241
v_mfma_f32_16x16x32_bf16 v[152:155], v[72:75], v[16:19], 0
v_cvt_pk_bf16_f32 v32, v228, v229
v_cvt_pk_bf16_f32 v33, v230, v231
v_mfma_f32_16x16x32_bf16 v[156:159], v[76:79], v[16:19], 0
v_cvt_pk_bf16_f32 v34, v236, v237
v_cvt_pk_bf16_f32 v35, v238, v239
s_add_u32 m0, s95, 32768
s_add_u32 s47, s58, 917504
buffer_load_dwordx4 v232, s[20:23], s47 offen offset:0 lds
v_mfma_f32_16x16x32_bf16 v[240:243], v[212:215], v[4:7], v[224:227]
v_rcp_f32 v120, v120
v_rcp_f32 v121, v121
v_mfma_f32_16x16x16_bf16 v[228:231], v[196:197], v[4:5], 0
v_mul_f32 v112, v112, v120
v_mul_f32 v113, v113, v120
v_mfma_f32_16x16x16_bf16 v[236:239], v[198:199], v[6:7], 0
v_mul_f32 v114, v114, v120
v_mul_f32 v115, v115, v120
v_mfma_f32_16x16x32_bf16 v[160:163], v[64:67], v[32:35], 0
v_mul_f32 v116, v116, v121
v_mul_f32 v117, v117, v121
v_mfma_f32_16x16x32_bf16 v[164:167], v[68:71], v[32:35], 0
v_mul_f32 v118, v118, v121
v_mul_f32 v119, v119, v121
v_mfma_f32_16x16x32_bf16 v[168:171], v[72:75], v[32:35], 0
v_cvt_pk_bf16_f32 v48, v112, v113
v_cvt_pk_bf16_f32 v49, v114, v115
v_mfma_f32_16x16x32_bf16 v[172:175], v[76:79], v[32:35], 0
v_cvt_pk_bf16_f32 v50, v116, v117
v_cvt_pk_bf16_f32 v51, v118, v119
buffer_load_dwordx4 v233, s[20:23], s47 offen offset:1024 lds
buffer_load_dwordx4 v234, s[20:23], s47 offen offset:2048 lds
buffer_load_dwordx4 v235, s[20:23], s47 offen offset:3072 lds
v_mfma_f32_16x16x32_bf16 v[120:123], v[212:215], v[20:23], v[224:227]
v_rcp_f32 v240, v240
v_rcp_f32 v241, v241
v_mfma_f32_16x16x16_bf16 v[112:115], v[196:197], v[20:21], 0
v_mul_f32 v228, v228, v240
v_mul_f32 v229, v229, v240
v_mfma_f32_16x16x16_bf16 v[116:119], v[198:199], v[22:23], 0
v_mul_f32 v230, v230, v240
v_mul_f32 v231, v231, v240
v_mfma_f32_16x16x32_bf16 v[176:179], v[64:67], v[48:51], 0
v_mul_f32 v236, v236, v241
v_mul_f32 v237, v237, v241
v_mfma_f32_16x16x32_bf16 v[180:183], v[68:71], v[48:51], 0
v_mul_f32 v238, v238, v241
v_mul_f32 v239, v239, v241
v_mfma_f32_16x16x32_bf16 v[184:187], v[72:75], v[48:51], 0
v_cvt_pk_bf16_f32 v4, v228, v229
v_cvt_pk_bf16_f32 v5, v230, v231
v_mfma_f32_16x16x32_bf16 v[188:191], v[76:79], v[48:51], 0
v_cvt_pk_bf16_f32 v6, v236, v237
v_cvt_pk_bf16_f32 v7, v238, v239
s_add_u32 m0, s95, 98304
s_add_u32 s47, s58, 917632
buffer_load_dwordx4 v232, s[20:23], s47 offen offset:0 lds
v_mfma_f32_16x16x32_bf16 v[240:243], v[212:215], v[36:39], v[224:227]
v_rcp_f32 v120, v120
v_rcp_f32 v121, v121
v_mfma_f32_16x16x16_bf16 v[228:231], v[196:197], v[36:37], 0
v_mul_f32 v112, v112, v120
v_mul_f32 v113, v113, v120
v_mfma_f32_16x16x16_bf16 v[236:239], v[198:199], v[38:39], 0
v_mul_f32 v114, v114, v120
v_mul_f32 v115, v115, v120
v_mfma_f32_16x16x32_bf16 v[128:131], v[80:83], v[4:7], v[128:131]
v_mul_f32 v116, v116, v121
v_mul_f32 v117, v117, v121
v_mfma_f32_16x16x32_bf16 v[132:135], v[84:87], v[4:7], v[132:135]
v_mul_f32 v118, v118, v121
v_mul_f32 v119, v119, v121
v_mfma_f32_16x16x32_bf16 v[136:139], v[88:91], v[4:7], v[136:139]
v_cvt_pk_bf16_f32 v20, v112, v113
v_cvt_pk_bf16_f32 v21, v114, v115
v_mfma_f32_16x16x32_bf16 v[140:143], v[92:95], v[4:7], v[140:143]
v_cvt_pk_bf16_f32 v22, v116, v117
v_cvt_pk_bf16_f32 v23, v118, v119
buffer_load_dwordx4 v233, s[20:23], s47 offen offset:1024 lds
buffer_load_dwordx4 v234, s[20:23], s47 offen offset:2048 lds
buffer_load_dwordx4 v235, s[20:23], s47 offen offset:3072 lds
v_mfma_f32_16x16x32_bf16 v[120:123], v[212:215], v[52:55], v[224:227]
v_rcp_f32 v240, v240
v_rcp_f32 v241, v241
v_mfma_f32_16x16x16_bf16 v[112:115], v[196:197], v[52:53], 0
v_mul_f32 v228, v228, v240
v_mul_f32 v229, v229, v240
v_mfma_f32_16x16x16_bf16 v[116:119], v[198:199], v[54:55], 0
v_mul_f32 v230, v230, v240
v_mul_f32 v231, v231, v240
v_mfma_f32_16x16x32_bf16 v[144:147], v[80:83], v[20:23], v[144:147]
v_mul_f32 v236, v236, v241
v_mul_f32 v237, v237, v241
v_mfma_f32_16x16x32_bf16 v[148:151], v[84:87], v[20:23], v[148:151]
v_mul_f32 v238, v238, v241
v_mul_f32 v239, v239, v241
v_mfma_f32_16x16x32_bf16 v[152:155], v[88:91], v[20:23], v[152:155]
v_cvt_pk_bf16_f32 v36, v228, v229
v_cvt_pk_bf16_f32 v37, v230, v231
v_mfma_f32_16x16x32_bf16 v[156:159], v[92:95], v[20:23], v[156:159]
v_cvt_pk_bf16_f32 v38, v236, v237
v_cvt_pk_bf16_f32 v39, v238, v239
s_add_u32 m0, s95, 49152
s_add_u32 s47, s58, 1376256
buffer_load_dwordx4 v232, s[20:23], s47 offen offset:0 lds
v_mfma_f32_16x16x32_bf16 v[240:243], v[216:219], v[8:11], v[224:227]
v_rcp_f32 v120, v120
v_rcp_f32 v121, v121
v_mfma_f32_16x16x16_bf16 v[228:231], v[200:201], v[8:9], 0
v_mul_f32 v112, v112, v120
v_mul_f32 v113, v113, v120
v_mfma_f32_16x16x16_bf16 v[236:239], v[202:203], v[10:11], 0
v_mul_f32 v114, v114, v120
v_mul_f32 v115, v115, v120
v_mfma_f32_16x16x32_bf16 v[160:163], v[80:83], v[36:39], v[160:163]
v_mul_f32 v116, v116, v121
v_mul_f32 v117, v117, v121
v_mfma_f32_16x16x32_bf16 v[164:167], v[84:87], v[36:39], v[164:167]
v_mul_f32 v118, v118, v121
v_mul_f32 v119, v119, v121
v_mfma_f32_16x16x32_bf16 v[168:171], v[88:91], v[36:39], v[168:171]
v_cvt_pk_bf16_f32 v52, v112, v113
v_cvt_pk_bf16_f32 v53, v114, v115
v_mfma_f32_16x16x32_bf16 v[172:175], v[92:95], v[36:39], v[172:175]
v_cvt_pk_bf16_f32 v54, v116, v117
v_cvt_pk_bf16_f32 v55, v118, v119
buffer_load_dwordx4 v233, s[20:23], s47 offen offset:1024 lds
buffer_load_dwordx4 v234, s[20:23], s47 offen offset:2048 lds
buffer_load_dwordx4 v235, s[20:23], s47 offen offset:3072 lds
v_mfma_f32_16x16x32_bf16 v[120:123], v[216:219], v[24:27], v[224:227]
v_rcp_f32 v240, v240
v_rcp_f32 v241, v241
v_mfma_f32_16x16x16_bf16 v[112:115], v[200:201], v[24:25], 0
v_mul_f32 v228, v228, v240
v_mul_f32 v229, v229, v240
v_mfma_f32_16x16x16_bf16 v[116:119], v[202:203], v[26:27], 0
v_mul_f32 v230, v230, v240
v_mul_f32 v231, v231, v240
v_mfma_f32_16x16x32_bf16 v[176:179], v[80:83], v[52:55], v[176:179]
v_mul_f32 v236, v236, v241
v_mul_f32 v237, v237, v241
v_mfma_f32_16x16x32_bf16 v[180:183], v[84:87], v[52:55], v[180:183]
v_mul_f32 v238, v238, v241
v_mul_f32 v239, v239, v241
v_mfma_f32_16x16x32_bf16 v[184:187], v[88:91], v[52:55], v[184:187]
v_cvt_pk_bf16_f32 v8, v228, v229
v_cvt_pk_bf16_f32 v9, v230, v231
v_mfma_f32_16x16x32_bf16 v[188:191], v[92:95], v[52:55], v[188:191]
v_cvt_pk_bf16_f32 v10, v236, v237
v_cvt_pk_bf16_f32 v11, v238, v239
s_add_u32 m0, s95, 114688
s_add_u32 s47, s58, 1376384
buffer_load_dwordx4 v232, s[20:23], s47 offen offset:0 lds
v_mfma_f32_16x16x32_bf16 v[240:243], v[216:219], v[40:43], v[224:227]
v_rcp_f32 v120, v120
v_rcp_f32 v121, v121
v_mfma_f32_16x16x16_bf16 v[228:231], v[200:201], v[40:41], 0
v_mul_f32 v112, v112, v120
v_mul_f32 v113, v113, v120
v_mfma_f32_16x16x16_bf16 v[236:239], v[202:203], v[42:43], 0
v_mul_f32 v114, v114, v120
v_mul_f32 v115, v115, v120
v_mfma_f32_16x16x32_bf16 v[128:131], v[96:99], v[8:11], v[128:131]
v_mul_f32 v116, v116, v121
v_mul_f32 v117, v117, v121
v_mfma_f32_16x16x32_bf16 v[132:135], v[100:103], v[8:11], v[132:135]
v_mul_f32 v118, v118, v121
v_mul_f32 v119, v119, v121
v_mfma_f32_16x16x32_bf16 v[136:139], v[104:107], v[8:11], v[136:139]
v_cvt_pk_bf16_f32 v24, v112, v113
v_cvt_pk_bf16_f32 v25, v114, v115
v_mfma_f32_16x16x32_bf16 v[140:143], v[108:111], v[8:11], v[140:143]
v_cvt_pk_bf16_f32 v26, v116, v117
v_cvt_pk_bf16_f32 v27, v118, v119
buffer_load_dwordx4 v233, s[20:23], s47 offen offset:1024 lds
buffer_load_dwordx4 v234, s[20:23], s47 offen offset:2048 lds
buffer_load_dwordx4 v235, s[20:23], s47 offen offset:3072 lds
v_mfma_f32_16x16x32_bf16 v[120:123], v[216:219], v[56:59], v[224:227]
v_rcp_f32 v240, v240
v_rcp_f32 v241, v241
v_mfma_f32_16x16x16_bf16 v[112:115], v[200:201], v[56:57], 0
v_mul_f32 v228, v228, v240
v_mul_f32 v229, v229, v240
v_mfma_f32_16x16x16_bf16 v[116:119], v[202:203], v[58:59], 0
v_mul_f32 v230, v230, v240
v_mul_f32 v231, v231, v240
v_mfma_f32_16x16x32_bf16 v[144:147], v[96:99], v[24:27], v[144:147]
v_mul_f32 v236, v236, v241
v_mul_f32 v237, v237, v241
v_mfma_f32_16x16x32_bf16 v[148:151], v[100:103], v[24:27], v[148:151]
v_mul_f32 v238, v238, v241
v_mul_f32 v239, v239, v241
v_mfma_f32_16x16x32_bf16 v[152:155], v[104:107], v[24:27], v[152:155]
v_cvt_pk_bf16_f32 v40, v228, v229
v_cvt_pk_bf16_f32 v41, v230, v231
v_mfma_f32_16x16x32_bf16 v[156:159], v[108:111], v[24:27], v[156:159]
v_cvt_pk_bf16_f32 v42, v236, v237
v_cvt_pk_bf16_f32 v43, v238, v239
v_lshlrev_b32 v124, 3, v255
s_lshr_b32 s47, s53, 3
s_lshl_b32 s47, s47, 2
v_mfma_f32_16x16x32_bf16 v[240:243], v[220:223], v[12:15], v[224:227]
v_rcp_f32 v120, v120
v_rcp_f32 v121, v121
v_mfma_f32_16x16x16_bf16 v[228:231], v[204:205], v[12:13], 0
v_mul_f32 v112, v112, v120
v_mul_f32 v113, v113, v120
v_mfma_f32_16x16x16_bf16 v[236:239], v[206:207], v[14:15], 0
v_mul_f32 v114, v114, v120
v_mul_f32 v115, v115, v120
v_mfma_f32_16x16x32_bf16 v[160:163], v[96:99], v[40:43], v[160:163]
v_mul_f32 v116, v116, v121
v_mul_f32 v117, v117, v121
v_mfma_f32_16x16x32_bf16 v[164:167], v[100:103], v[40:43], v[164:167]
v_mul_f32 v118, v118, v121
v_mul_f32 v119, v119, v121
v_mfma_f32_16x16x32_bf16 v[168:171], v[104:107], v[40:43], v[168:171]
v_cvt_pk_bf16_f32 v56, v112, v113
v_cvt_pk_bf16_f32 v57, v114, v115
v_mfma_f32_16x16x32_bf16 v[172:175], v[108:111], v[40:43], v[172:175]
v_cvt_pk_bf16_f32 v58, v116, v117
v_cvt_pk_bf16_f32 v59, v118, v119
s_add_u32 s47, s47, s48
s_mul_i32 s47, s47, 14336
buffer_load_dword a5, v124, s[24:27], s47 offen
v_mfma_f32_16x16x32_bf16 v[120:123], v[220:223], v[28:31], v[224:227]
v_rcp_f32 v240, v240
v_rcp_f32 v241, v241
v_mfma_f32_16x16x16_bf16 v[112:115], v[204:205], v[28:29], 0
v_mul_f32 v228, v228, v240
v_mul_f32 v229, v229, v240
v_mfma_f32_16x16x16_bf16 v[116:119], v[206:207], v[30:31], 0
v_mul_f32 v230, v230, v240
v_mul_f32 v231, v231, v240
v_mfma_f32_16x16x32_bf16 v[176:179], v[96:99], v[56:59], v[176:179]
v_mul_f32 v236, v236, v241
v_mul_f32 v237, v237, v241
v_mfma_f32_16x16x32_bf16 v[180:183], v[100:103], v[56:59], v[180:183]
v_mul_f32 v238, v238, v241
v_mul_f32 v239, v239, v241
v_mfma_f32_16x16x32_bf16 v[184:187], v[104:107], v[56:59], v[184:187]
v_cvt_pk_bf16_f32 v12, v228, v229
v_cvt_pk_bf16_f32 v13, v230, v231
v_mfma_f32_16x16x32_bf16 v[188:191], v[108:111], v[56:59], v[188:191]
v_cvt_pk_bf16_f32 v14, v236, v237
v_cvt_pk_bf16_f32 v15, v238, v239
s_add_u32 s47, s47, 6144
buffer_load_dword a6, v124, s[24:27], s47 offen
v_mfma_f32_16x16x32_bf16 v[240:243], v[220:223], v[44:47], v[224:227]
v_rcp_f32 v120, v120
v_rcp_f32 v121, v121
v_mfma_f32_16x16x16_bf16 v[228:231], v[204:205], v[44:45], 0
v_mul_f32 v112, v112, v120
v_mul_f32 v113, v113, v120
v_mfma_f32_16x16x16_bf16 v[236:239], v[206:207], v[46:47], 0
v_mul_f32 v114, v114, v120
v_mul_f32 v115, v115, v120
v_mfma_f32_16x16x32_bf16 v[128:131], a[240:243], v[12:15], v[128:131]
v_mul_f32 v116, v116, v121
v_mul_f32 v117, v117, v121
v_mfma_f32_16x16x32_bf16 v[132:135], a[244:247], v[12:15], v[132:135]
v_mul_f32 v118, v118, v121
v_mul_f32 v119, v119, v121
v_mfma_f32_16x16x32_bf16 v[136:139], a[248:251], v[12:15], v[136:139]
v_cvt_pk_bf16_f32 v28, v112, v113
v_cvt_pk_bf16_f32 v29, v114, v115
v_mfma_f32_16x16x32_bf16 v[140:143], a[252:255], v[12:15], v[140:143]
v_cvt_pk_bf16_f32 v30, v116, v117
v_cvt_pk_bf16_f32 v31, v118, v119
v_mfma_f32_16x16x32_bf16 v[120:123], v[220:223], v[60:63], v[224:227]
v_rcp_f32 v240, v240
v_rcp_f32 v241, v241
v_mfma_f32_16x16x16_bf16 v[112:115], v[204:205], v[60:61], 0
v_mul_f32 v228, v228, v240
v_mul_f32 v229, v229, v240
v_mfma_f32_16x16x16_bf16 v[116:119], v[206:207], v[62:63], 0
v_mul_f32 v230, v230, v240
v_mul_f32 v231, v231, v240
v_mfma_f32_16x16x32_bf16 v[144:147], a[240:243], v[28:31], v[144:147]
v_mul_f32 v236, v236, v241
v_mul_f32 v237, v237, v241
v_mfma_f32_16x16x32_bf16 v[148:151], a[244:247], v[28:31], v[148:151]
v_mul_f32 v238, v238, v241
v_mul_f32 v239, v239, v241
v_mfma_f32_16x16x32_bf16 v[152:155], a[248:251], v[28:31], v[152:155]
v_cvt_pk_bf16_f32 v44, v228, v229
v_cvt_pk_bf16_f32 v45, v230, v231
v_mfma_f32_16x16x32_bf16 v[156:159], a[252:255], v[28:31], v[156:159]
v_cvt_pk_bf16_f32 v46, v236, v237
v_cvt_pk_bf16_f32 v47, v238, v239
s_nop 1
v_mfma_f32_16x16x32_bf16 v[160:163], a[240:243], v[44:47], v[160:163]
v_rcp_f32 v120, v120
v_rcp_f32 v121, v121
v_mfma_f32_16x16x32_bf16 v[164:167], a[244:247], v[44:47], v[164:167]
v_mul_f32 v112, v112, v120
v_mul_f32 v113, v113, v120
v_mfma_f32_16x16x32_bf16 v[168:171], a[248:251], v[44:47], v[168:171]
v_mul_f32 v114, v114, v120
v_mul_f32 v115, v115, v120
v_mfma_f32_16x16x32_bf16 v[172:175], a[252:255], v[44:47], v[172:175]
v_mul_f32 v116, v116, v121
v_mul_f32 v117, v117, v121
v_mul_f32 v118, v118, v121
v_mul_f32 v119, v119, v121
v_cvt_pk_bf16_f32 v60, v112, v113
v_cvt_pk_bf16_f32 v61, v114, v115
v_cvt_pk_bf16_f32 v62, v116, v117
v_cvt_pk_bf16_f32 v63, v118, v119
s_nop 1
v_mfma_f32_16x16x32_bf16 v[176:179], a[240:243], v[60:63], v[176:179]
s_add_u32 s54, s48, 1
s_and_b32 s54, s54, 3
v_mfma_f32_16x16x32_bf16 v[180:183], a[244:247], v[60:63], v[180:183]
s_mul_i32 s54, s54, 6144
s_add_u32 s54, s54, 131072
v_mfma_f32_16x16x32_bf16 v[184:187], a[248:251], v[60:63], v[184:187]
v_add_u32 v225, s54, v255
s_add_u32 s54, s48, 2
v_mfma_f32_16x16x32_bf16 v[188:191], a[252:255], v[60:63], v[188:191]
s_and_b32 s54, s54, 3
s_mul_i32 s54, s54, 6144
s_add_u32 s54, s54, 133120
v_add_u32 v226, s54, v255
s_add_u32 s54, s48, 3
s_and_b32 s54, s54, 3
s_mul_i32 s54, s54, 6144
s_add_u32 s54, s54, 135168
v_add_u32 v227, s54, v255
s_mul_i32 s54, s48, 6144
s_add_u32 s54, s54, 131072
v_add_u32 v224, s54, v255
v_cvt_pk_bf16_f32 v144, v144, v145
v_cvt_pk_bf16_f32 v145, v146, v147
v_cvt_pk_bf16_f32 v146, v148, v149
v_cvt_pk_bf16_f32 v147, v150, v151
ds_write_b128 v225, v[144:147] offset:0
v_cvt_pk_bf16_f32 v152, v152, v153
v_cvt_pk_bf16_f32 v153, v154, v155
v_cvt_pk_bf16_f32 v154, v156, v157
v_cvt_pk_bf16_f32 v155, v158, v159
ds_write_b128 v225, v[152:155] offset:1024
v_cvt_pk_bf16_f32 v160, v160, v161
v_cvt_pk_bf16_f32 v161, v162, v163
v_cvt_pk_bf16_f32 v162, v164, v165
v_cvt_pk_bf16_f32 v163, v166, v167
ds_write_b128 v226, v[160:163] offset:0
v_cvt_pk_bf16_f32 v168, v168, v169
v_cvt_pk_bf16_f32 v169, v170, v171
v_cvt_pk_bf16_f32 v170, v172, v173
v_cvt_pk_bf16_f32 v171, v174, v175
ds_write_b128 v226, v[168:171] offset:1024
v_cvt_pk_bf16_f32 v176, v176, v177
v_cvt_pk_bf16_f32 v177, v178, v179
v_cvt_pk_bf16_f32 v178, v180, v181
v_cvt_pk_bf16_f32 v179, v182, v183
ds_write_b128 v227, v[176:179] offset:0
v_cvt_pk_bf16_f32 v184, v184, v185
v_cvt_pk_bf16_f32 v185, v186, v187
v_cvt_pk_bf16_f32 v186, v188, v189
v_cvt_pk_bf16_f32 v187, v190, v191
ds_write_b128 v227, v[184:187] offset:1024
s_lshl_b32 s54, s49, 2
s_add_u32 s54, s54, s48
s_mul_i32 s92, s54, 16384
s_lshl_b32 s56, s50, 11
s_add_u32 s92, s92, s56
s_add_u32 s92, s92, 5242880
s_lshl_b32 s54, s54, 10
s_lshr_b32 s55, s50, 1
s_lshl_b32 s55, s55, 8
s_add_u32 s54, s54, s55
s_and_b32 s55, s50, 1
s_lshl_b32 s55, s55, 3
s_add_u32 s54, s54, s55
s_add_u32 s93, s54, 262144
s_mov_b32 s88, 0xaaaaaaaa
s_mov_b32 s89, s88
s_mov_b32 s90, 0xcccccccc
s_mov_b32 s91, s90
v_and_b32 v228, 0xff, v255
s_lshl_b32 s59, s49, 7
s_add_u32 s59, s59, 4096
s_lshl_b32 s56, s50, 2
s_add_u32 s56, s56, s48
s_lshl_b32 s56, s56, 2
s_add_u32 s56, s56, s59
s_waitcnt lgkmcnt(0)
s_barrier
ds_read_b128 v[144:147], v224 offset:0
ds_read_b128 v[148:151], v224 offset:1024
ds_read_b128 v[152:155], v224 offset:2048
ds_read_b128 v[156:159], v224 offset:3072
ds_read_b128 v[160:163], v224 offset:4096
ds_read_b128 v[164:167], v224 offset:5120
s_waitcnt lgkmcnt(5)
v_mfma_f32_16x16x16_bf16 v[128:131], v[126:127], v[144:145], v[128:131]
v_mfma_f32_16x16x16_bf16 v[132:135], v[126:127], v[146:147], v[132:135]
s_waitcnt lgkmcnt(4)
v_mfma_f32_16x16x16_bf16 v[136:139], v[126:127], v[148:149], v[136:139]
v_mfma_f32_16x16x16_bf16 v[140:143], v[126:127], v[150:151], v[140:143]
s_waitcnt lgkmcnt(3)
v_mfma_f32_16x16x16_bf16 v[128:131], v[126:127], v[152:153], v[128:131]
v_mfma_f32_16x16x16_bf16 v[132:135], v[126:127], v[154:155], v[132:135]
s_waitcnt lgkmcnt(2)
v_mfma_f32_16x16x16_bf16 v[136:139], v[126:127], v[156:157], v[136:139]
v_mfma_f32_16x16x16_bf16 v[140:143], v[126:127], v[158:159], v[140:143]
s_waitcnt lgkmcnt(1)
v_mfma_f32_16x16x16_bf16 v[128:131], v[126:127], v[160:161], v[128:131]
v_mfma_f32_16x16x16_bf16 v[132:135], v[126:127], v[162:163], v[132:135]
s_waitcnt lgkmcnt(0)
v_mfma_f32_16x16x16_bf16 v[136:139], v[126:127], v[164:165], v[136:139]
v_mfma_f32_16x16x16_bf16 v[140:143], v[126:127], v[166:167], v[140:143]
s_nop 3
v_cvt_pk_bf16_f32 v244, v128, v129
v_cvt_pk_bf16_f32 v245, v130, v131
v_cvt_pk_bf16_f32 v246, v132, v133
v_cvt_pk_bf16_f32 v247, v134, v135
buffer_store_dwordx4 v[244:247], v255, s[28:31], s92 offen offset:0
s_nop 0
v_mfma_f32_16x16x32_bf16 v[180:183], v[244:247], v[244:247], 0
v_mfma_f32_16x16x32_bf16 v[176:179], a[236:239], v[244:247], 0
v_cvt_pk_bf16_f32 v248, v136, v137
v_cvt_pk_bf16_f32 v249, v138, v139
v_cvt_pk_bf16_f32 v250, v140, v141
v_cvt_pk_bf16_f32 v251, v142, v143
buffer_store_dwordx4 v[248:251], v255, s[28:31], s92 offen offset:1024
s_nop 0
v_mfma_f32_16x16x32_bf16 v[180:183], v[248:251], v[248:251], v[180:183]
v_mfma_f32_16x16x32_bf16 v[176:179], a[236:239], v[248:251], v[176:179]
s_nop 6
v_cndmask_b32_e64 v180, v180, v181, s[88:89]
v_cndmask_b32_e64 v182, v182, v183, s[88:89]
v_cndmask_b32_e64 v177, v180, v182, s[90:91]
s_mov_b32 exec_lo, 0x00f0000f
s_mov_b32 exec_hi, 0xf0000f00
buffer_store_dwordx2 v[176:177], v228, s[28:31], s93 offen
s_mov_b64 exec, -1
s_waitcnt vmcnt(0)
s_mov_b64 exec, 1
v_mov_b32 v243, 1
s_cmp_lg_u32 s46, 0
s_cbranch_scc1 SG12
buffer_store_dword v243, off, s[28:31], s56
s_branch SG11
SG12:
buffer_wbl2 sc1
s_waitcnt vmcnt(0)
buffer_store_dword v243, off, s[28:31], s56 sc1
SG11:
s_mov_b64 exec, -1
s_barrier
s_cmp_lt_u32 s52, 14
s_cbranch_scc1 HI13
s_lshl_b32 s54, s51, 1
s_add_u32 s54, s54, s52
s_sub_u32 s54, s54, 14
s_lshl_b32 s54, s54, 2
s_add_u32 s54, s54, s48
s_mul_i32 s54, s54, 57344
s_add_u32 s54, s54, 11558912
v_lshlrev_b32 v0, 3, v255
buffer_load_dword v1, v0, s[28:31], s54 offen
s_add_u32 s54, s54, 8192
buffer_load_dword v2, v0, s[28:31], s54 offen
s_add_u32 s54, s54, 8192
buffer_load_dword v3, v0, s[28:31], s54 offen
s_add_u32 s54, s54, 8192
buffer_load_dword v4, v0, s[28:31], s54 offen
s_add_u32 s54, s54, 8192
HI13:
s_lshr_b32 s54, s48, 1
s_lshl_b32 s54, s54, 16
s_and_b32 s55, s48, 1
s_lshl_b32 s55, s55, 6
v_xor_b32 v224, s55, v254
v_add_u32 v224, s54, v224
v_xor_b32 v225, 32, v224
ds_read_b64_tr_b16 v[192:193], v224 offset:0
ds_read_b64_tr_b16 v[194:195], v224 offset:2048
ds_read_b64_tr_b16 v[196:197], v225 offset:0
ds_read_b64_tr_b16 v[198:199], v225 offset:2048
ds_read_b64_tr_b16 v[200:201], v224 offset:4096
ds_read_b64_tr_b16 v[202:203], v224 offset:6144
ds_read_b64_tr_b16 v[204:205], v225 offset:4096
ds_read_b64_tr_b16 v[206:207], v225 offset:6144
ds_read_b64_tr_b16 v[208:209], v224 offset:8192
ds_read_b64_tr_b16 v[210:211], v224 offset:10240
ds_read_b64_tr_b16 v[212:213], v225 offset:8192
ds_read_b64_tr_b16 v[214:215], v225 offset:10240
s_waitcnt lgkmcnt(10)
v_mfma_f32_16x16x32_bf16 v[128:131], v[192:195], a[236:239], 0
ds_read_b64_tr_b16 v[216:217], v224 offset:12288
ds_read_b64_tr_b16 v[218:219], v224 offset:14336
s_waitcnt lgkmcnt(10)
v_mfma_f32_16x16x32_bf16 v[132:135], v[196:199], a[236:239], 0
ds_read_b64_tr_b16 v[220:221], v225 offset:12288
ds_read_b64_tr_b16 v[222:223], v225 offset:14336
s_waitcnt lgkmcnt(10)
v_mfma_f32_16x16x32_bf16 v[128:131], v[200:203], a[236:239], v[128:131]
ds_read_b64_tr_b16 v[192:193], v224 offset:16384
ds_read_b64_tr_b16 v[194:195], v224 offset:18432
s_waitcnt lgkmcnt(10)
v_mfma_f32_16x16x32_bf16 v[132:135], v[204:207], a[236:239], v[132:135]
ds_read_b64_tr_b16 v[196:197], v225 offset:16384
ds_read_b64_tr_b16 v[198:199], v225 offset:18432
s_waitcnt lgkmcnt(10)
v_mfma_f32_16x16x32_bf16 v[128:131], v[208:211], a[236:239], v[128:131]
ds_read_b64_tr_b16 v[200:201], v224 offset:20480
ds_read_b64_tr_b16 v[202:203], v224 offset:22528
s_waitcnt lgkmcnt(10)
v_mfma_f32_16x16x32_bf16 v[132:135], v[212:215], a[236:239], v[132:135]
ds_read_b64_tr_b16 v[204:205], v225 offset:20480
ds_read_b64_tr_b16 v[206:207], v225 offset:22528
s_waitcnt lgkmcnt(10)
v_mfma_f32_16x16x32_bf16 v[128:131], v[216:219], a[236:239], v[128:131]
ds_read_b64_tr_b16 v[208:209], v224 offset:24576
ds_read_b64_tr_b16 v[210:211], v224 offset:26624
s_waitcnt lgkmcnt(10)
v_mfma_f32_16x16x32_bf16 v[132:135], v[220:223], a[236:239], v[132:135]
ds_read_b64_tr_b16 v[212:213], v225 offset:24576
ds_read_b64_tr_b16 v[214:215], v225 offset:26624
s_waitcnt lgkmcnt(10)
v_mfma_f32_16x16x32_bf16 v[128:131], v[192:195], a[236:239], v[128:131]
ds_read_b64_tr_b16 v[216:217], v224 offset:28672
ds_read_b64_tr_b16 v[218:219], v224 offset:30720
s_waitcnt lgkmcnt(10)
v_mfma_f32_16x16x32_bf16 v[132:135], v[196:199], a[236:239], v[132:135]
ds_read_b64_tr_b16 v[220:221], v225 offset:28672
ds_read_b64_tr_b16 v[222:223], v225 offset:30720
s_waitcnt lgkmcnt(10)
v_mfma_f32_16x16x32_bf16 v[128:131], v[200:203], a[236:239], v[128:131]
ds_read_b64_tr_b16 v[192:193], v224 offset:32768
ds_read_b64_tr_b16 v[194:195], v224 offset:34816
s_waitcnt lgkmcnt(10)
v_mfma_f32_16x16x32_bf16 v[132:135], v[204:207], a[236:239], v[132:135]
ds_read_b64_tr_b16 v[196:197], v225 offset:32768
ds_read_b64_tr_b16 v[198:199], v225 offset:34816
s_waitcnt lgkmcnt(10)
v_mfma_f32_16x16x32_bf16 v[128:131], v[208:211], a[236:239], v[128:131]
ds_read_b64_tr_b16 v[200:201], v224 offset:36864
ds_read_b64_tr_b16 v[202:203], v224 offset:38912
s_waitcnt lgkmcnt(10)
v_mfma_f32_16x16x32_bf16 v[132:135], v[212:215], a[236:239], v[132:135]
ds_read_b64_tr_b16 v[204:205], v225 offset:36864
ds_read_b64_tr_b16 v[206:207], v225 offset:38912
s_waitcnt lgkmcnt(10)
v_mfma_f32_16x16x32_bf16 v[128:131], v[216:219], a[236:239], v[128:131]
ds_read_b64_tr_b16 v[208:209], v224 offset:40960
ds_read_b64_tr_b16 v[210:211], v224 offset:43008
s_waitcnt lgkmcnt(10)
v_mfma_f32_16x16x32_bf16 v[132:135], v[220:223], a[236:239], v[132:135]
ds_read_b64_tr_b16 v[212:213], v225 offset:40960
ds_read_b64_tr_b16 v[214:215], v225 offset:43008
s_waitcnt lgkmcnt(10)
v_mfma_f32_16x16x32_bf16 v[128:131], v[192:195], a[236:239], v[128:131]
ds_read_b64_tr_b16 v[216:217], v224 offset:45056
ds_read_b64_tr_b16 v[218:219], v224 offset:47104
s_waitcnt lgkmcnt(10)
v_mfma_f32_16x16x32_bf16 v[132:135], v[196:199], a[236:239], v[132:135]
ds_read_b64_tr_b16 v[220:221], v225 offset:45056
ds_read_b64_tr_b16 v[222:223], v225 offset:47104
s_waitcnt lgkmcnt(10)
v_mfma_f32_16x16x32_bf16 v[128:131], v[200:203], a[236:239], v[128:131]
ds_read_b64_tr_b16 v[192:193], v224 offset:49152
ds_read_b64_tr_b16 v[194:195], v224 offset:51200
s_waitcnt lgkmcnt(10)
v_mfma_f32_16x16x32_bf16 v[132:135], v[204:207], a[236:239], v[132:135]
ds_read_b64_tr_b16 v[196:197], v225 offset:49152
ds_read_b64_tr_b16 v[198:199], v225 offset:51200
s_waitcnt lgkmcnt(10)
v_mfma_f32_16x16x32_bf16 v[128:131], v[208:211], a[236:239], v[128:131]
ds_read_b64_tr_b16 v[200:201], v224 offset:53248
ds_read_b64_tr_b16 v[202:203], v224 offset:55296
s_waitcnt lgkmcnt(10)
v_mfma_f32_16x16x32_bf16 v[132:135], v[212:215], a[236:239], v[132:135]
ds_read_b64_tr_b16 v[204:205], v225 offset:53248
ds_read_b64_tr_b16 v[206:207], v225 offset:55296
s_waitcnt lgkmcnt(10)
v_mfma_f32_16x16x32_bf16 v[128:131], v[216:219], a[236:239], v[128:131]
ds_read_b64_tr_b16 v[208:209], v224 offset:57344
ds_read_b64_tr_b16 v[210:211], v224 offset:59392
s_waitcnt lgkmcnt(10)
v_mfma_f32_16x16x32_bf16 v[132:135], v[220:223], a[236:239], v[132:135]
ds_read_b64_tr_b16 v[212:213], v225 offset:57344
ds_read_b64_tr_b16 v[214:215], v225 offset:59392
s_waitcnt lgkmcnt(10)
v_mfma_f32_16x16x32_bf16 v[128:131], v[192:195], a[236:239], v[128:131]
ds_read_b64_tr_b16 v[216:217], v224 offset:61440
ds_read_b64_tr_b16 v[218:219], v224 offset:63488
s_waitcnt lgkmcnt(10)
v_mfma_f32_16x16x32_bf16 v[132:135], v[196:199], a[236:239], v[132:135]
ds_read_b64_tr_b16 v[220:221], v225 offset:61440
ds_read_b64_tr_b16 v[222:223], v225 offset:63488
s_waitcnt lgkmcnt(10)
v_mfma_f32_16x16x32_bf16 v[128:131], v[200:203], a[236:239], v[128:131]
s_waitcnt lgkmcnt(8)
v_mfma_f32_16x16x32_bf16 v[132:135], v[204:207], a[236:239], v[132:135]
s_waitcnt lgkmcnt(6)
v_mfma_f32_16x16x32_bf16 v[128:131], v[208:211], a[236:239], v[128:131]
s_waitcnt lgkmcnt(4)
v_mfma_f32_16x16x32_bf16 v[132:135], v[212:215], a[236:239], v[132:135]
s_waitcnt lgkmcnt(2)
v_mfma_f32_16x16x32_bf16 v[128:131], v[216:219], a[236:239], v[128:131]
s_waitcnt lgkmcnt(0)
v_mfma_f32_16x16x32_bf16 v[132:135], v[220:223], a[236:239], v[132:135]
s_lshl_b32 s54, s48, 7
s_add_u32 s54, s54, 160768
v_lshrrev_b32 v224, 8, v255
v_lshl_add_u32 v224, v224, 4, s54
s_nop 1
ds_write_b128 v224, v[128:131] offset:0
s_nop 0
ds_write_b128 v224, v[132:135] offset:64
s_waitcnt lgkmcnt(0)
s_lshl_b32 s54, s48, 1
s_lshl_b32 s55, s51, 3
s_add_u32 s56, s54, s55
s_lshl_b32 s63, s56, 10
s_add_u32 s63, s63, 262144
s_mul_i32 s62, s56, 16384
s_add_u32 s62, s62, 5242880
v_add_u32 v240, 16384, v255
s_mul_i32 s56, s56, 57344
s_lshl_b32 s55, s52, 12
s_add_u32 s56, s56, s55
s_add_u32 s64, s56, 11534336
s_add_u32 s65, s64, 57344
s_mov_b32 s90, 0x409d30fc
s_mov_b32 s91, s90
s_mov_b32 s92, 0x3eeff558
s_mov_b32 s93, s92
v_lshrrev_b32 v232, 8, v255
v_lshlrev_b32 v232, 4, v232
v_add_u32 v232, 160768, v232
v_xor_b32 v224, 0, v254
v_xor_b32 v225, 32, v254
v_xor_b32 v226, 64, v254
v_xor_b32 v227, 96, v254
s_mul_i32 s94, s48, 458752
s_lshl_b32 s54, s50, 7
s_add_u32 s94, s94, s54
s_mul_i32 s95, s48, 6144
s_add_u32 s95, s95, 131072
s_cmp_ge_u32 s52, 14
s_cbranch_scc1 ID14
s_lshl_b32 s54, s51, 1
s_lshr_b32 s55, s48, 1
s_add_u32 s54, s54, s55
s_lshl_b32 s54, s54, 7
s_and_b32 s55, s48, 1
s_lshl_b32 s55, s55, 3
s_add_u32 s54, s54, s55
s_add_u32 s54, s54, 4096
v_bfe_u32 v231, v255, 5, 3
v_lshlrev_b32 v231, 4, v231
v_bfe_u32 v230, v255, 4, 1
v_lshl_add_u32 v231, v230, 2, v231
s_mov_b32 s57, 100000
PL16:
buffer_load_dword v230, v231, s[28:31], s54 offen sc1
s_waitcnt vmcnt(0)
v_cmp_ne_u32 vcc, 1, v230
s_sub_u32 s57, s57, 1
s_nop 3
s_cbranch_vccz PL17
s_cmp_lg_u32 s57, 0
s_cbranch_scc1 PL16
PL17:
buffer_load_dwordx4 v[0:3], v255, s[28:31], s62 offen offset:0 sc1
buffer_load_dwordx4 v[64:67], v240, s[28:31], s62 offen offset:0 sc1
buffer_load_dwordx4 v[4:7], v255, s[28:31], s62 offen offset:1024 sc1
buffer_load_dwordx4 v[68:71], v240, s[28:31], s62 offen offset:1024 sc1
buffer_load_dwordx4 v[8:11], v255, s[28:31], s62 offen offset:2048 sc1
buffer_load_dwordx4 v[72:75], v240, s[28:31], s62 offen offset:2048 sc1
buffer_load_dwordx4 v[208:211], v255, s[28:31], s63 offen offset:0 sc1
buffer_load_dwordx4 v[212:215], v255, s[28:31], s63 offen offset:1024 sc1
v_add_u32 v228, 65536, v224
v_add_u32 v229, 65536, v225
v_add_u32 v230, 65536, v226
v_add_u32 v231, 65536, v227
s_lshl_b32 s88, s48, 13
v_lshl_add_u32 v233, v253, 10, v252
v_add_u32 v234, 7168, v233
v_add_u32 v235, s95, v254
v_xor_b32 v241, 32, v235
v_xor_b32 v242, 64, v235
v_xor_b32 v243, 96, v235
ds_read_b64_tr_b16 v[192:193], v224 offset:0
ds_read_b64_tr_b16 v[194:195], v224 offset:2048
ds_read_b64_tr_b16 v[196:197], v225 offset:0
ds_read_b64_tr_b16 v[198:199], v225 offset:2048
ds_read_b64_tr_b16 v[200:201], v226 offset:0
ds_read_b64_tr_b16 v[202:203], v226 offset:2048
ds_read_b64_tr_b16 v[204:205], v227 offset:0
ds_read_b64_tr_b16 v[206:207], v227 offset:2048
ds_read_b64_tr_b16 a[240:241], v228 offset:0
ds_read_b64_tr_b16 a[242:243], v228 offset:2048
ds_read_b64_tr_b16 a[244:245], v229 offset:0
ds_read_b64_tr_b16 a[246:247], v229 offset:2048
s_waitcnt vmcnt(6)
s_waitcnt lgkmcnt(10)
v_mfma_f32_16x16x32_bf16 v[128:131], v[192:195], v[0:3], 0
ds_read_b64_tr_b16 a[248:249], v230 offset:0
v_mfma_f32_16x16x32_bf16 v[160:163], v[192:195], v[64:67], 0
ds_read_b64_tr_b16 a[250:251], v230 offset:2048
s_waitcnt lgkmcnt(10)
v_mfma_f32_16x16x32_bf16 v[132:135], v[196:199], v[0:3], 0
ds_read_b64_tr_b16 a[252:253], v231 offset:0
s_add_u32 m0, s95, 0
v_mfma_f32_16x16x32_bf16 v[164:167], v[196:199], v[64:67], 0
ds_read_b64_tr_b16 a[254:255], v231 offset:2048
s_waitcnt lgkmcnt(10)
v_mfma_f32_16x16x32_bf16 v[136:139], v[200:203], v[0:3], 0
ds_read_b64_tr_b16 v[192:193], v224 offset:4096
buffer_load_dwordx4 v[12:15], v255, s[28:31], s62 offen offset:3072 sc1
v_mfma_f32_16x16x32_bf16 v[168:171], v[200:203], v[64:67], 0
ds_read_b64_tr_b16 v[194:195], v224 offset:6144
s_add_u32 s47, s94, 294912
s_waitcnt lgkmcnt(10)
v_mfma_f32_16x16x32_bf16 v[140:143], v[204:207], v[0:3], 0
ds_read_b64_tr_b16 v[196:197], v225 offset:4096
buffer_load_dwordx4 v233, s[24:27], s47 offen offset:0 lds
v_mfma_f32_16x16x32_bf16 v[172:175], v[204:207], v[64:67], 0
ds_read_b64_tr_b16 v[198:199], v225 offset:6144
s_waitcnt lgkmcnt(10)
v_mfma_f32_16x16x32_bf16 v[144:147], a[240:243], v[0:3], 0
ds_read_b64_tr_b16 v[200:201], v226 offset:4096
buffer_load_dwordx4 v[76:79], v240, s[28:31], s62 offen offset:3072 sc1
v_mfma_f32_16x16x32_bf16 v[176:179], a[240:243], v[64:67], 0
ds_read_b64_tr_b16 v[202:203], v226 offset:6144
buffer_load_dwordx4 v234, s[24:27], s47 offen offset:1024 lds
s_waitcnt lgkmcnt(10)
v_mfma_f32_16x16x32_bf16 v[148:151], a[244:247], v[0:3], 0
ds_read_b64_tr_b16 v[204:205], v227 offset:4096
v_mfma_f32_16x16x32_bf16 v[180:183], a[244:247], v[64:67], 0
ds_read_b64_tr_b16 v[206:207], v227 offset:6144
s_waitcnt lgkmcnt(10)
v_mfma_f32_16x16x32_bf16 v[152:155], a[248:251], v[0:3], 0
ds_read_b64_tr_b16 a[240:241], v228 offset:4096
v_mfma_f32_16x16x32_bf16 v[184:187], a[248:251], v[64:67], 0
ds_read_b64_tr_b16 a[242:243], v228 offset:6144
s_waitcnt lgkmcnt(10)
v_mfma_f32_16x16x32_bf16 v[156:159], a[252:255], v[0:3], 0
ds_read_b64_tr_b16 a[244:245], v229 offset:4096
s_add_u32 s62, s62, 4096
v_mfma_f32_16x16x32_bf16 v[188:191], a[252:255], v[64:67], 0
ds_read_b64_tr_b16 a[246:247], v229 offset:6144
s_waitcnt vmcnt(8)
s_waitcnt lgkmcnt(10)
v_mfma_f32_16x16x32_bf16 v[128:131], v[192:195], v[4:7], v[128:131]
ds_read_b64_tr_b16 a[248:249], v230 offset:4096
v_mfma_f32_16x16x32_bf16 v[160:163], v[192:195], v[68:71], v[160:163]
ds_read_b64_tr_b16 a[250:251], v230 offset:6144
s_waitcnt lgkmcnt(10)
v_mfma_f32_16x16x32_bf16 v[132:135], v[196:199], v[4:7], v[132:135]
ds_read_b64_tr_b16 a[252:253], v231 offset:4096
buffer_load_dwordx4 v[16:19], v255, s[28:31], s62 offen offset:0 sc1
v_mfma_f32_16x16x32_bf16 v[164:167], v[196:199], v[68:71], v[164:167]
ds_read_b64_tr_b16 a[254:255], v231 offset:6144
s_waitcnt lgkmcnt(10)
v_mfma_f32_16x16x32_bf16 v[136:139], v[200:203], v[4:7], v[136:139]
ds_read_b64_tr_b16 v[192:193], v224 offset:8192
v_mfma_f32_16x16x32_bf16 v[168:171], v[200:203], v[68:71], v[168:171]
ds_read_b64_tr_b16 v[194:195], v224 offset:10240
s_waitcnt lgkmcnt(10)
v_mfma_f32_16x16x32_bf16 v[140:143], v[204:207], v[4:7], v[140:143]
ds_read_b64_tr_b16 v[196:197], v225 offset:8192
v_mfma_f32_16x16x32_bf16 v[172:175], v[204:207], v[68:71], v[172:175]
ds_read_b64_tr_b16 v[198:199], v225 offset:10240
s_waitcnt lgkmcnt(10)
v_mfma_f32_16x16x32_bf16 v[144:147], a[240:243], v[4:7], v[144:147]
ds_read_b64_tr_b16 v[200:201], v226 offset:8192
buffer_load_dwordx4 v[80:83], v240, s[28:31], s62 offen offset:0 sc1
v_mfma_f32_16x16x32_bf16 v[176:179], a[240:243], v[68:71], v[176:179]
ds_read_b64_tr_b16 v[202:203], v226 offset:10240
s_add_u32 m0, s95, 2048
s_waitcnt lgkmcnt(10)
v_mfma_f32_16x16x32_bf16 v[148:151], a[244:247], v[4:7], v[148:151]
ds_read_b64_tr_b16 v[204:205], v227 offset:8192
s_add_u32 s47, s94, 311296
v_mfma_f32_16x16x32_bf16 v[180:183], a[244:247], v[68:71], v[180:183]
ds_read_b64_tr_b16 v[206:207], v227 offset:10240
s_waitcnt lgkmcnt(10)
v_mfma_f32_16x16x32_bf16 v[152:155], a[248:251], v[4:7], v[152:155]
ds_read_b64_tr_b16 a[240:241], v228 offset:8192
buffer_load_dwordx4 v[20:23], v255, s[28:31], s62 offen offset:1024 sc1
v_mfma_f32_16x16x32_bf16 v[184:187], a[248:251], v[68:71], v[184:187]
ds_read_b64_tr_b16 a[242:243], v228 offset:10240
buffer_load_dwordx4 v233, s[24:27], s47 offen offset:0 lds
s_waitcnt lgkmcnt(10)
v_mfma_f32_16x16x32_bf16 v[156:159], a[252:255], v[4:7], v[156:159]
ds_read_b64_tr_b16 a[244:245], v229 offset:8192
buffer_load_dwordx4 v234, s[24:27], s47 offen offset:1024 lds
v_mfma_f32_16x16x32_bf16 v[188:191], a[252:255], v[68:71], v[188:191]
ds_read_b64_tr_b16 a[246:247], v229 offset:10240
s_waitcnt vmcnt(11)
s_waitcnt lgkmcnt(10)
v_mfma_f32_16x16x32_bf16 v[128:131], v[192:195], v[8:11], v[128:131]
ds_read_b64_tr_b16 a[248:249], v230 offset:8192
v_mfma_f32_16x16x32_bf16 v[160:163], v[192:195], v[72:75], v[160:163]
ds_read_b64_tr_b16 a[250:251], v230 offset:10240
s_waitcnt lgkmcnt(10)
v_mfma_f32_16x16x32_bf16 v[132:135], v[196:199], v[8:11], v[132:135]
ds_read_b64_tr_b16 a[252:253], v231 offset:8192
buffer_load_dwordx4 v[84:87], v240, s[28:31], s62 offen offset:1024 sc1
v_mfma_f32_16x16x32_bf16 v[164:167], v[196:199], v[72:75], v[164:167]
ds_read_b64_tr_b16 a[254:255], v231 offset:10240
s_waitcnt lgkmcnt(10)
v_mfma_f32_16x16x32_bf16 v[136:139], v[200:203], v[8:11], v[136:139]
ds_read_b64_tr_b16 v[192:193], v224 offset:12288
v_mfma_f32_16x16x32_bf16 v[168:171], v[200:203], v[72:75], v[168:171]
ds_read_b64_tr_b16 v[194:195], v224 offset:14336
s_waitcnt lgkmcnt(10)
v_mfma_f32_16x16x32_bf16 v[140:143], v[204:207], v[8:11], v[140:143]
ds_read_b64_tr_b16 v[196:197], v225 offset:12288
buffer_load_dwordx4 v[24:27], v255, s[28:31], s62 offen offset:2048 sc1
v_mfma_f32_16x16x32_bf16 v[172:175], v[204:207], v[72:75], v[172:175]
ds_read_b64_tr_b16 v[198:199], v225 offset:14336
s_waitcnt lgkmcnt(10)
v_mfma_f32_16x16x32_bf16 v[144:147], a[240:243], v[8:11], v[144:147]
ds_read_b64_tr_b16 v[200:201], v226 offset:12288
v_mfma_f32_16x16x32_bf16 v[176:179], a[240:243], v[72:75], v[176:179]
ds_read_b64_tr_b16 v[202:203], v226 offset:14336
s_waitcnt lgkmcnt(10)
v_mfma_f32_16x16x32_bf16 v[148:151], a[244:247], v[8:11], v[148:151]
ds_read_b64_tr_b16 v[204:205], v227 offset:12288
v_mfma_f32_16x16x32_bf16 v[180:183], a[244:247], v[72:75], v[180:183]
ds_read_b64_tr_b16 v[206:207], v227 offset:14336
s_waitcnt lgkmcnt(10)
v_mfma_f32_16x16x32_bf16 v[152:155], a[248:251], v[8:11], v[152:155]
ds_read_b64_tr_b16 a[240:241], v228 offset:12288
buffer_load_dwordx4 v[88:91], v240, s[28:31], s62 offen offset:2048 sc1
v_mfma_f32_16x16x32_bf16 v[184:187], a[248:251], v[72:75], v[184:187]
ds_read_b64_tr_b16 a[242:243], v228 offset:14336
s_waitcnt vmcnt(8)
s_waitcnt lgkmcnt(10)
v_mfma_f32_16x16x32_bf16 v[156:159], a[252:255], v[8:11], v[156:159]
ds_read_b64_tr_b16 a[244:245], v229 offset:12288
ds_read_b64_tr_b16 a[144:145], v235 offset:0
v_mfma_f32_16x16x32_bf16 v[188:191], a[252:255], v[72:75], v[188:191]
ds_read_b64_tr_b16 a[246:247], v229 offset:14336
s_add_u32 m0, s95, 4096
s_waitcnt vmcnt(9)
s_waitcnt lgkmcnt(10)
v_mfma_f32_16x16x32_bf16 v[128:131], v[192:195], v[12:15], v[128:131]
ds_read_b64_tr_b16 a[248:249], v230 offset:12288
buffer_load_dwordx4 v[28:31], v255, s[28:31], s62 offen offset:3072 sc1
ds_read_b64_tr_b16 a[148:149], v241 offset:0
v_mfma_f32_16x16x32_bf16 v[160:163], v[192:195], v[76:79], v[160:163]
ds_read_b64_tr_b16 a[250:251], v230 offset:14336
s_add_u32 s47, s94, 327680
s_waitcnt lgkmcnt(10)
v_mfma_f32_16x16x32_bf16 v[132:135], v[196:199], v[12:15], v[132:135]
ds_read_b64_tr_b16 a[252:253], v231 offset:12288
ds_read_b64_tr_b16 a[152:153], v242 offset:0
v_mfma_f32_16x16x32_bf16 v[164:167], v[196:199], v[76:79], v[164:167]
ds_read_b64_tr_b16 a[254:255], v231 offset:14336
buffer_load_dwordx4 v233, s[24:27], s47 offen offset:0 lds
s_waitcnt lgkmcnt(10)
v_mfma_f32_16x16x32_bf16 v[136:139], v[200:203], v[12:15], v[136:139]
ds_read_b64_tr_b16 v[192:193], v224 offset:16384
ds_read_b64_tr_b16 a[156:157], v243 offset:0
v_mfma_f32_16x16x32_bf16 v[168:171], v[200:203], v[76:79], v[168:171]
ds_read_b64_tr_b16 v[194:195], v224 offset:18432
buffer_load_dwordx4 v234, s[24:27], s47 offen offset:1024 lds
s_waitcnt lgkmcnt(10)
v_mfma_f32_16x16x32_bf16 v[140:143], v[204:207], v[12:15], v[140:143]
ds_read_b64_tr_b16 v[196:197], v225 offset:16384
buffer_load_dwordx4 v[92:95], v240, s[28:31], s62 offen offset:3072 sc1
v_mfma_f32_16x16x32_bf16 v[172:175], v[204:207], v[76:79], v[172:175]
ds_read_b64_tr_b16 v[198:199], v225 offset:18432
s_waitcnt lgkmcnt(10)
v_mfma_f32_16x16x32_bf16 v[144:147], a[240:243], v[12:15], v[144:147]
ds_read_b64_tr_b16 v[200:201], v226 offset:16384
v_mfma_f32_16x16x32_bf16 v[176:179], a[240:243], v[76:79], v[176:179]
ds_read_b64_tr_b16 v[202:203], v226 offset:18432
s_waitcnt lgkmcnt(10)
v_mfma_f32_16x16x32_bf16 v[148:151], a[244:247], v[12:15], v[148:151]
ds_read_b64_tr_b16 v[204:205], v227 offset:16384
s_add_u32 s62, s62, 4096
v_mfma_f32_16x16x32_bf16 v[180:183], a[244:247], v[76:79], v[180:183]
ds_read_b64_tr_b16 v[206:207], v227 offset:18432
s_waitcnt lgkmcnt(10)
v_mfma_f32_16x16x32_bf16 v[152:155], a[248:251], v[12:15], v[152:155]
ds_read_b64_tr_b16 a[240:241], v228 offset:16384
v_mfma_f32_16x16x32_bf16 v[184:187], a[248:251], v[76:79], v[184:187]
ds_read_b64_tr_b16 a[242:243], v228 offset:18432
s_waitcnt lgkmcnt(10)
v_mfma_f32_16x16x32_bf16 v[156:159], a[252:255], v[12:15], v[156:159]
ds_read_b64_tr_b16 a[244:245], v229 offset:16384
v_mfma_f32_16x16x32_bf16 v[188:191], a[252:255], v[76:79], v[188:191]
ds_read_b64_tr_b16 a[246:247], v229 offset:18432
s_waitcnt vmcnt(10)
s_waitcnt lgkmcnt(10)
v_mfma_f32_16x16x32_bf16 v[128:131], v[192:195], v[16:19], v[128:131]
ds_read_b64_tr_b16 a[248:249], v230 offset:16384
buffer_load_dwordx4 v[32:35], v255, s[28:31], s62 offen offset:0 sc1
v_mfma_f32_16x16x32_bf16 v[160:163], v[192:195], v[80:83], v[160:163]
ds_read_b64_tr_b16 a[250:251], v230 offset:18432
s_waitcnt lgkmcnt(10)
v_mfma_f32_16x16x32_bf16 v[132:135], v[196:199], v[16:19], v[132:135]
ds_read_b64_tr_b16 a[252:253], v231 offset:16384
v_mfma_f32_16x16x32_bf16 v[164:167], v[196:199], v[80:83], v[164:167]
ds_read_b64_tr_b16 a[254:255], v231 offset:18432
s_waitcnt vmcnt(8)
s_waitcnt lgkmcnt(10)
v_mfma_f32_16x16x32_bf16 v[136:139], v[200:203], v[16:19], v[136:139]
ds_read_b64_tr_b16 v[192:193], v224 offset:20480
buffer_load_dwordx4 v[96:99], v240, s[28:31], s62 offen offset:0 sc1
ds_read_b64_tr_b16 a[146:147], v235 offset:2048
v_mfma_f32_16x16x32_bf16 v[168:171], v[200:203], v[80:83], v[168:171]
ds_read_b64_tr_b16 v[194:195], v224 offset:22528
s_add_u32 m0, s95, 0
s_waitcnt lgkmcnt(10)
v_mfma_f32_16x16x32_bf16 v[140:143], v[204:207], v[16:19], v[140:143]
ds_read_b64_tr_b16 v[196:197], v225 offset:20480
ds_read_b64_tr_b16 a[150:151], v241 offset:2048
v_mfma_f32_16x16x32_bf16 v[172:175], v[204:207], v[80:83], v[172:175]
ds_read_b64_tr_b16 v[198:199], v225 offset:22528
s_add_u32 s47, s94, 344064
s_waitcnt lgkmcnt(10)
v_mfma_f32_16x16x32_bf16 v[144:147], a[240:243], v[16:19], v[144:147]
ds_read_b64_tr_b16 v[200:201], v226 offset:20480
ds_read_b64_tr_b16 a[154:155], v242 offset:2048
v_mfma_f32_16x16x32_bf16 v[176:179], a[240:243], v[80:83], v[176:179]
ds_read_b64_tr_b16 v[202:203], v226 offset:22528
buffer_load_dwordx4 v233, s[24:27], s47 offen offset:0 lds
s_waitcnt lgkmcnt(10)
v_mfma_f32_16x16x32_bf16 v[148:151], a[244:247], v[16:19], v[148:151]
ds_read_b64_tr_b16 v[204:205], v227 offset:20480
buffer_load_dwordx4 v[36:39], v255, s[28:31], s62 offen offset:1024 sc1
ds_read_b64_tr_b16 a[158:159], v243 offset:2048
v_mfma_f32_16x16x32_bf16 v[180:183], a[244:247], v[80:83], v[180:183]
ds_read_b64_tr_b16 v[206:207], v227 offset:22528
buffer_load_dwordx4 v234, s[24:27], s47 offen offset:1024 lds
s_waitcnt lgkmcnt(10)
v_mfma_f32_16x16x32_bf16 v[152:155], a[248:251], v[16:19], v[152:155]
ds_read_b64_tr_b16 a[240:241], v228 offset:20480
v_mfma_f32_16x16x32_bf16 v[184:187], a[248:251], v[80:83], v[184:187]
ds_read_b64_tr_b16 a[242:243], v228 offset:22528
s_waitcnt lgkmcnt(10)
v_mfma_f32_16x16x32_bf16 v[156:159], a[252:255], v[16:19], v[156:159]
ds_read_b64_tr_b16 a[244:245], v229 offset:20480
buffer_load_dwordx4 v[100:103], v240, s[28:31], s62 offen offset:1024 sc1
v_mfma_f32_16x16x32_bf16 v[188:191], a[252:255], v[80:83], v[188:191]
ds_read_b64_tr_b16 a[246:247], v229 offset:22528
s_waitcnt vmcnt(12)
s_waitcnt lgkmcnt(10)
v_mfma_f32_16x16x32_bf16 v[128:131], v[192:195], v[20:23], v[128:131]
ds_read_b64_tr_b16 a[248:249], v230 offset:20480
v_mfma_f32_16x16x32_bf16 v[160:163], v[192:195], v[84:87], v[160:163]
ds_read_b64_tr_b16 a[250:251], v230 offset:22528
s_waitcnt lgkmcnt(10)
v_mfma_f32_16x16x32_bf16 v[132:135], v[196:199], v[20:23], v[132:135]
ds_read_b64_tr_b16 a[252:253], v231 offset:20480
v_mfma_f32_16x16x32_bf16 v[164:167], v[196:199], v[84:87], v[164:167]
ds_read_b64_tr_b16 a[254:255], v231 offset:22528
s_waitcnt lgkmcnt(10)
v_mfma_f32_16x16x32_bf16 v[136:139], v[200:203], v[20:23], v[136:139]
ds_read_b64_tr_b16 v[192:193], v224 offset:24576
buffer_load_dwordx4 v[40:43], v255, s[28:31], s62 offen offset:2048 sc1
v_mfma_f32_16x16x32_bf16 v[168:171], v[200:203], v[84:87], v[168:171]
ds_read_b64_tr_b16 v[194:195], v224 offset:26624
s_waitcnt lgkmcnt(10)
v_mfma_f32_16x16x32_bf16 v[140:143], v[204:207], v[20:23], v[140:143]
ds_read_b64_tr_b16 v[196:197], v225 offset:24576
v_mfma_f32_16x16x32_bf16 v[172:175], v[204:207], v[84:87], v[172:175]
ds_read_b64_tr_b16 v[198:199], v225 offset:26624
s_waitcnt lgkmcnt(10)
v_mfma_f32_16x16x32_bf16 v[144:147], a[240:243], v[20:23], v[144:147]
ds_read_b64_tr_b16 v[200:201], v226 offset:24576
buffer_load_dwordx4 v[104:107], v240, s[28:31], s62 offen offset:2048 sc1
v_mfma_f32_16x16x32_bf16 v[176:179], a[240:243], v[84:87], v[176:179]
ds_read_b64_tr_b16 v[202:203], v226 offset:26624
s_waitcnt vmcnt(9)
s_waitcnt lgkmcnt(10)
v_mfma_f32_16x16x32_bf16 v[148:151], a[244:247], v[20:23], v[148:151]
ds_read_b64_tr_b16 v[204:205], v227 offset:24576
ds_read_b64_tr_b16 a[160:161], v235 offset:4096
v_mfma_f32_16x16x32_bf16 v[180:183], a[244:247], v[84:87], v[180:183]
ds_read_b64_tr_b16 v[206:207], v227 offset:26624
s_add_u32 m0, s95, 2048
s_waitcnt lgkmcnt(10)
v_mfma_f32_16x16x32_bf16 v[152:155], a[248:251], v[20:23], v[152:155]
ds_read_b64_tr_b16 a[240:241], v228 offset:24576
ds_read_b64_tr_b16 a[164:165], v241 offset:4096
v_mfma_f32_16x16x32_bf16 v[184:187], a[248:251], v[84:87], v[184:187]
ds_read_b64_tr_b16 a[242:243], v228 offset:26624
s_add_u32 s47, s94, 360448
s_waitcnt lgkmcnt(10)
v_mfma_f32_16x16x32_bf16 v[156:159], a[252:255], v[20:23], v[156:159]
ds_read_b64_tr_b16 a[244:245], v229 offset:24576
buffer_load_dwordx4 v[44:47], v255, s[28:31], s62 offen offset:3072 sc1
ds_read_b64_tr_b16 a[168:169], v242 offset:4096
v_mfma_f32_16x16x32_bf16 v[188:191], a[252:255], v[84:87], v[188:191]
ds_read_b64_tr_b16 a[246:247], v229 offset:26624
buffer_load_dwordx4 v233, s[24:27], s47 offen offset:0 lds
s_waitcnt vmcnt(14)
s_waitcnt lgkmcnt(10)
v_mfma_f32_16x16x32_bf16 v[128:131], v[192:195], v[24:27], v[128:131]
ds_read_b64_tr_b16 a[248:249], v230 offset:24576
ds_read_b64_tr_b16 a[172:173], v243 offset:4096
v_mfma_f32_16x16x32_bf16 v[160:163], v[192:195], v[88:91], v[160:163]
ds_read_b64_tr_b16 a[250:251], v230 offset:26624
buffer_load_dwordx4 v234, s[24:27], s47 offen offset:1024 lds
s_waitcnt lgkmcnt(10)
v_mfma_f32_16x16x32_bf16 v[132:135], v[196:199], v[24:27], v[132:135]
ds_read_b64_tr_b16 a[252:253], v231 offset:24576
buffer_load_dwordx4 v[108:111], v240, s[28:31], s62 offen offset:3072 sc1
v_mfma_f32_16x16x32_bf16 v[164:167], v[196:199], v[88:91], v[164:167]
ds_read_b64_tr_b16 a[254:255], v231 offset:26624
s_waitcnt lgkmcnt(10)
v_mfma_f32_16x16x32_bf16 v[136:139], v[200:203], v[24:27], v[136:139]
ds_read_b64_tr_b16 v[192:193], v224 offset:28672
v_mfma_f32_16x16x32_bf16 v[168:171], v[200:203], v[88:91], v[168:171]
ds_read_b64_tr_b16 v[194:195], v224 offset:30720
s_waitcnt lgkmcnt(10)
v_mfma_f32_16x16x32_bf16 v[140:143], v[204:207], v[24:27], v[140:143]
ds_read_b64_tr_b16 v[196:197], v225 offset:28672
v_mfma_f32_16x16x32_bf16 v[172:175], v[204:207], v[88:91], v[172:175]
ds_read_b64_tr_b16 v[198:199], v225 offset:30720
s_waitcnt lgkmcnt(10)
v_mfma_f32_16x16x32_bf16 v[144:147], a[240:243], v[24:27], v[144:147]
ds_read_b64_tr_b16 v[200:201], v226 offset:28672
s_add_u32 s62, s62, 4096
v_mfma_f32_16x16x32_bf16 v[176:179], a[240:243], v[88:91], v[176:179]
ds_read_b64_tr_b16 v[202:203], v226 offset:30720
s_waitcnt lgkmcnt(10)
v_mfma_f32_16x16x32_bf16 v[148:151], a[244:247], v[24:27], v[148:151]
ds_read_b64_tr_b16 v[204:205], v227 offset:28672
v_mfma_f32_16x16x32_bf16 v[180:183], a[244:247], v[88:91], v[180:183]
ds_read_b64_tr_b16 v[206:207], v227 offset:30720
s_waitcnt lgkmcnt(10)
v_mfma_f32_16x16x32_bf16 v[152:155], a[248:251], v[24:27], v[152:155]
ds_read_b64_tr_b16 a[240:241], v228 offset:28672
buffer_load_dwordx4 v[48:51], v255, s[28:31], s62 offen offset:0 sc1
v_mfma_f32_16x16x32_bf16 v[184:187], a[248:251], v[88:91], v[184:187]
ds_read_b64_tr_b16 a[242:243], v228 offset:30720
s_waitcnt lgkmcnt(10)
v_mfma_f32_16x16x32_bf16 v[156:159], a[252:255], v[24:27], v[156:159]
ds_read_b64_tr_b16 a[244:245], v229 offset:28672
v_mfma_f32_16x16x32_bf16 v[188:191], a[252:255], v[88:91], v[188:191]
ds_read_b64_tr_b16 a[246:247], v229 offset:30720
s_waitcnt vmcnt(13)
s_waitcnt vmcnt(8)
s_waitcnt lgkmcnt(10)
v_mfma_f32_16x16x32_bf16 v[128:131], v[192:195], v[28:31], v[128:131]
ds_read_b64_tr_b16 a[248:249], v230 offset:28672
ds_read_b64_tr_b16 a[162:163], v235 offset:0
v_mfma_f32_16x16x32_bf16 v[160:163], v[192:195], v[92:95], v[160:163]
ds_read_b64_tr_b16 a[250:251], v230 offset:30720
s_add_u32 m0, s95, 4096
s_waitcnt lgkmcnt(10)
v_mfma_f32_16x16x32_bf16 v[132:135], v[196:199], v[28:31], v[132:135]
ds_read_b64_tr_b16 a[252:253], v231 offset:28672
buffer_load_dwordx4 v[112:115], v240, s[28:31], s62 offen offset:0 sc1
ds_read_b64_tr_b16 a[166:167], v241 offset:0
v_mfma_f32_16x16x32_bf16 v[164:167], v[196:199], v[92:95], v[164:167]
ds_read_b64_tr_b16 a[254:255], v231 offset:30720
s_add_u32 s47, s94, 376832
s_waitcnt lgkmcnt(10)
v_mfma_f32_16x16x32_bf16 v[136:139], v[200:203], v[28:31], v[136:139]
ds_read_b64_tr_b16 v[192:193], v224 offset:32768
ds_read_b64_tr_b16 a[170:171], v242 offset:0
v_mfma_f32_16x16x32_bf16 v[168:171], v[200:203], v[92:95], v[168:171]
ds_read_b64_tr_b16 v[194:195], v224 offset:34816
buffer_load_dwordx4 v233, s[24:27], s47 offen offset:0 lds
s_waitcnt lgkmcnt(10)
v_mfma_f32_16x16x32_bf16 v[140:143], v[204:207], v[28:31], v[140:143]
ds_read_b64_tr_b16 v[196:197], v225 offset:32768
buffer_load_dwordx4 v[52:55], v255, s[28:31], s62 offen offset:1024 sc1
ds_read_b64_tr_b16 a[174:175], v243 offset:0
v_mfma_f32_16x16x32_bf16 v[172:175], v[204:207], v[92:95], v[172:175]
ds_read_b64_tr_b16 v[198:199], v225 offset:34816
buffer_load_dwordx4 v234, s[24:27], s47 offen offset:1024 lds
s_waitcnt lgkmcnt(10)
v_mfma_f32_16x16x32_bf16 v[144:147], a[240:243], v[28:31], v[144:147]
ds_read_b64_tr_b16 v[200:201], v226 offset:32768
v_mfma_f32_16x16x32_bf16 v[176:179], a[240:243], v[92:95], v[176:179]
ds_read_b64_tr_b16 v[202:203], v226 offset:34816
s_waitcnt lgkmcnt(10)
v_mfma_f32_16x16x32_bf16 v[148:151], a[244:247], v[28:31], v[148:151]
ds_read_b64_tr_b16 v[204:205], v227 offset:32768
v_mfma_f32_16x16x32_bf16 v[180:183], a[244:247], v[92:95], v[180:183]
ds_read_b64_tr_b16 v[206:207], v227 offset:34816
s_waitcnt lgkmcnt(10)
v_mfma_f32_16x16x32_bf16 v[152:155], a[248:251], v[28:31], v[152:155]
ds_read_b64_tr_b16 a[240:241], v228 offset:32768
buffer_load_dwordx4 v[116:119], v240, s[28:31], s62 offen offset:1024 sc1
v_mfma_f32_16x16x32_bf16 v[184:187], a[248:251], v[92:95], v[184:187]
ds_read_b64_tr_b16 a[242:243], v228 offset:34816
s_waitcnt lgkmcnt(10)
v_mfma_f32_16x16x32_bf16 v[156:159], a[252:255], v[28:31], v[156:159]
ds_read_b64_tr_b16 a[244:245], v229 offset:32768
v_mfma_f32_16x16x32_bf16 v[188:191], a[252:255], v[92:95], v[188:191]
ds_read_b64_tr_b16 a[246:247], v229 offset:34816
s_waitcnt vmcnt(16)
s_waitcnt lgkmcnt(10)
v_mfma_f32_16x16x32_bf16 v[128:131], v[192:195], v[32:35], v[128:131]
ds_read_b64_tr_b16 a[248:249], v230 offset:32768
buffer_load_dwordx4 v[56:59], v255, s[28:31], s62 offen offset:2048 sc1
v_mfma_f32_16x16x32_bf16 v[160:163], v[192:195], v[96:99], v[160:163]
ds_read_b64_tr_b16 a[250:251], v230 offset:34816
s_waitcnt lgkmcnt(10)
v_mfma_f32_16x16x32_bf16 v[132:135], v[196:199], v[32:35], v[132:135]
ds_read_b64_tr_b16 a[252:253], v231 offset:32768
v_mfma_f32_16x16x32_bf16 v[164:167], v[196:199], v[96:99], v[164:167]
ds_read_b64_tr_b16 a[254:255], v231 offset:34816
s_waitcnt lgkmcnt(10)
v_mfma_f32_16x16x32_bf16 v[136:139], v[200:203], v[32:35], v[136:139]
ds_read_b64_tr_b16 v[192:193], v224 offset:36864
v_mfma_f32_16x16x32_bf16 v[168:171], v[200:203], v[96:99], v[168:171]
ds_read_b64_tr_b16 v[194:195], v224 offset:38912
s_waitcnt vmcnt(8)
s_waitcnt lgkmcnt(10)
v_mfma_f32_16x16x32_bf16 v[140:143], v[204:207], v[32:35], v[140:143]
ds_read_b64_tr_b16 v[196:197], v225 offset:36864
buffer_load_dwordx4 v[120:123], v240, s[28:31], s62 offen offset:2048 sc1
ds_read_b64_tr_b16 a[176:177], v235 offset:2048
v_mfma_f32_16x16x32_bf16 v[172:175], v[204:207], v[96:99], v[172:175]
ds_read_b64_tr_b16 v[198:199], v225 offset:38912
s_add_u32 m0, s95, 0
s_waitcnt lgkmcnt(10)
v_mfma_f32_16x16x32_bf16 v[144:147], a[240:243], v[32:35], v[144:147]
ds_read_b64_tr_b16 v[200:201], v226 offset:36864
ds_read_b64_tr_b16 a[180:181], v241 offset:2048
v_mfma_f32_16x16x32_bf16 v[176:179], a[240:243], v[96:99], v[176:179]
ds_read_b64_tr_b16 v[202:203], v226 offset:38912
s_add_u32 s47, s94, 393216
s_waitcnt lgkmcnt(10)
v_mfma_f32_16x16x32_bf16 v[148:151], a[244:247], v[32:35], v[148:151]
ds_read_b64_tr_b16 v[204:205], v227 offset:36864
buffer_load_dwordx4 v[60:63], v255, s[28:31], s62 offen offset:3072 sc1
ds_read_b64_tr_b16 a[184:185], v242 offset:2048
v_mfma_f32_16x16x32_bf16 v[180:183], a[244:247], v[96:99], v[180:183]
ds_read_b64_tr_b16 v[206:207], v227 offset:38912
buffer_load_dwordx4 v233, s[24:27], s47 offen offset:0 lds
s_barrier
s_waitcnt lgkmcnt(10)
v_mfma_f32_16x16x32_bf16 v[152:155], a[248:251], v[32:35], v[152:155]
ds_read_b64_tr_b16 a[240:241], v228 offset:36864
ds_read_b64_tr_b16 a[188:189], v243 offset:2048
v_mfma_f32_16x16x32_bf16 v[184:187], a[248:251], v[96:99], v[184:187]
ds_read_b64_tr_b16 a[242:243], v228 offset:38912
buffer_load_dwordx4 v234, s[24:27], s47 offen offset:1024 lds
s_waitcnt lgkmcnt(10)
v_mfma_f32_16x16x32_bf16 v[156:159], a[252:255], v[32:35], v[156:159]
ds_read_b64_tr_b16 a[244:245], v229 offset:36864
buffer_load_dwordx4 v[124:127], v240, s[28:31], s62 offen offset:3072 sc1
v_mfma_f32_16x16x32_bf16 v[188:191], a[252:255], v[96:99], v[188:191]
ds_read_b64_tr_b16 a[246:247], v229 offset:38912
s_waitcnt vmcnt(18)
s_waitcnt lgkmcnt(10)
v_mfma_f32_16x16x32_bf16 v[128:131], v[192:195], v[36:39], v[128:131]
ds_read_b64_tr_b16 a[248:249], v230 offset:36864
v_add_f32 v236, v208, v210
v_mfma_f32_16x16x32_bf16 v[160:163], v[192:195], v[100:103], v[160:163]
ds_read_b64_tr_b16 a[250:251], v230 offset:38912
s_add_u32 m0, s88, 0
s_add_u32 s47, s94, 0
s_waitcnt lgkmcnt(10)
v_mfma_f32_16x16x32_bf16 v[132:135], v[196:199], v[36:39], v[132:135]
ds_read_b64_tr_b16 a[252:253], v231 offset:36864
v_add_f32 v237, v209, v211
v_mfma_f32_16x16x32_bf16 v[164:167], v[196:199], v[100:103], v[164:167]
ds_read_b64_tr_b16 a[254:255], v231 offset:38912
buffer_load_dwordx4 v233, s[24:27], s47 offen offset:0 lds
s_waitcnt lgkmcnt(10)
v_mfma_f32_16x16x32_bf16 v[136:139], v[200:203], v[36:39], v[136:139]
ds_read_b64_tr_b16 v[192:193], v224 offset:40960
v_add_f32 v238, v212, v214
v_mfma_f32_16x16x32_bf16 v[168:171], v[200:203], v[100:103], v[168:171]
ds_read_b64_tr_b16 v[194:195], v224 offset:43008
buffer_load_dwordx4 v234, s[24:27], s47 offen offset:1024 lds
s_waitcnt lgkmcnt(10)
v_mfma_f32_16x16x32_bf16 v[140:143], v[204:207], v[36:39], v[140:143]
ds_read_b64_tr_b16 v[196:197], v225 offset:40960
v_add_f32 v239, v213, v215
v_mfma_f32_16x16x32_bf16 v[172:175], v[204:207], v[100:103], v[172:175]
ds_read_b64_tr_b16 v[198:199], v225 offset:43008
s_add_u32 m0, s88, 2048
s_add_u32 s47, s94, 16384
s_waitcnt lgkmcnt(10)
v_mfma_f32_16x16x32_bf16 v[144:147], a[240:243], v[36:39], v[144:147]
ds_read_b64_tr_b16 v[200:201], v226 offset:40960
v_mov_b32 v216, v236
v_mov_b32 v217, v237
v_mfma_f32_16x16x32_bf16 v[176:179], a[240:243], v[100:103], v[176:179]
ds_read_b64_tr_b16 v[202:203], v226 offset:43008
buffer_load_dwordx4 v233, s[24:27], s47 offen offset:0 lds
s_waitcnt lgkmcnt(10)
v_mfma_f32_16x16x32_bf16 v[148:151], a[244:247], v[36:39], v[148:151]
ds_read_b64_tr_b16 v[204:205], v227 offset:40960
v_mov_b32 v218, v238
v_mfma_f32_16x16x32_bf16 v[180:183], a[244:247], v[100:103], v[180:183]
ds_read_b64_tr_b16 v[206:207], v227 offset:43008
buffer_load_dwordx4 v234, s[24:27], s47 offen offset:1024 lds
s_waitcnt vmcnt(11)
s_waitcnt lgkmcnt(10)
v_mfma_f32_16x16x32_bf16 v[152:155], a[248:251], v[36:39], v[152:155]
ds_read_b64_tr_b16 a[240:241], v228 offset:40960
v_mov_b32 v219, v239
ds_read_b64_tr_b16 a[178:179], v235 offset:4096
v_mfma_f32_16x16x32_bf16 v[184:187], a[248:251], v[100:103], v[184:187]
ds_read_b64_tr_b16 a[242:243], v228 offset:43008
s_add_u32 m0, s95, 2048
s_waitcnt lgkmcnt(10)
v_mfma_f32_16x16x32_bf16 v[156:159], a[252:255], v[36:39], v[156:159]
ds_read_b64_tr_b16 a[244:245], v229 offset:40960
v_permlane16_swap_b32 v216, v236
ds_read_b64_tr_b16 a[182:183], v241 offset:4096
v_mfma_f32_16x16x32_bf16 v[188:191], a[252:255], v[100:103], v[188:191]
ds_read_b64_tr_b16 a[246:247], v229 offset:43008
s_add_u32 s47, s94, 409600
s_waitcnt vmcnt(20)
s_waitcnt lgkmcnt(10)
v_mfma_f32_16x16x32_bf16 v[128:131], v[192:195], v[40:43], v[128:131]
ds_read_b64_tr_b16 a[248:249], v230 offset:40960
v_permlane16_swap_b32 v217, v237
ds_read_b64_tr_b16 a[186:187], v242 offset:4096
v_mfma_f32_16x16x32_bf16 v[160:163], v[192:195], v[104:107], v[160:163]
ds_read_b64_tr_b16 a[250:251], v230 offset:43008
buffer_load_dwordx4 v233, s[24:27], s47 offen offset:0 lds
s_waitcnt lgkmcnt(10)
v_mfma_f32_16x16x32_bf16 v[132:135], v[196:199], v[40:43], v[132:135]
ds_read_b64_tr_b16 a[252:253], v231 offset:40960
v_permlane16_swap_b32 v218, v238
v_permlane16_swap_b32 v219, v239
v_mfma_f32_16x16x32_bf16 v[164:167], v[196:199], v[104:107], v[164:167]
ds_read_b64_tr_b16 a[254:255], v231 offset:43008
ds_read_b64_tr_b16 a[190:191], v243 offset:4096
buffer_load_dwordx4 v234, s[24:27], s47 offen offset:1024 lds
s_waitcnt lgkmcnt(10)
v_mfma_f32_16x16x32_bf16 v[136:139], v[200:203], v[40:43], v[136:139]
ds_read_b64_tr_b16 v[192:193], v224 offset:45056
v_add_f32 v236, v236, v216
v_mfma_f32_16x16x32_bf16 v[168:171], v[200:203], v[104:107], v[168:171]
ds_read_b64_tr_b16 v[194:195], v224 offset:47104
s_waitcnt lgkmcnt(10)
v_mfma_f32_16x16x32_bf16 v[140:143], v[204:207], v[40:43], v[140:143]
ds_read_b64_tr_b16 v[196:197], v225 offset:45056
v_add_f32 v237, v237, v217
v_mfma_f32_16x16x32_bf16 v[172:175], v[204:207], v[104:107], v[172:175]
ds_read_b64_tr_b16 v[198:199], v225 offset:47104
s_add_u32 m0, s88, 4096
s_add_u32 s47, s94, 32768
s_waitcnt lgkmcnt(10)
v_mfma_f32_16x16x32_bf16 v[144:147], a[240:243], v[40:43], v[144:147]
ds_read_b64_tr_b16 v[200:201], v226 offset:45056
v_add_f32 v238, v238, v218
v_mfma_f32_16x16x32_bf16 v[176:179], a[240:243], v[104:107], v[176:179]
ds_read_b64_tr_b16 v[202:203], v226 offset:47104
buffer_load_dwordx4 v233, s[24:27], s47 offen offset:0 lds
s_waitcnt lgkmcnt(10)
v_mfma_f32_16x16x32_bf16 v[148:151], a[244:247], v[40:43], v[148:151]
ds_read_b64_tr_b16 v[204:205], v227 offset:45056
v_add_f32 v239, v239, v219
v_mfma_f32_16x16x32_bf16 v[180:183], a[244:247], v[104:107], v[180:183]
ds_read_b64_tr_b16 v[206:207], v227 offset:47104
buffer_load_dwordx4 v234, s[24:27], s47 offen offset:1024 lds
s_waitcnt lgkmcnt(10)
v_mfma_f32_16x16x32_bf16 v[152:155], a[248:251], v[40:43], v[152:155]
ds_read_b64_tr_b16 a[240:241], v228 offset:45056
v_mov_b32 v216, v236
v_mov_b32 v217, v237
v_mfma_f32_16x16x32_bf16 v[184:187], a[248:251], v[104:107], v[184:187]
ds_read_b64_tr_b16 a[242:243], v228 offset:47104
s_add_u32 m0, s88, 6144
s_add_u32 s47, s94, 49152
s_waitcnt lgkmcnt(10)
v_mfma_f32_16x16x32_bf16 v[156:159], a[252:255], v[40:43], v[156:159]
ds_read_b64_tr_b16 a[244:245], v229 offset:45056
v_mov_b32 v218, v238
v_mfma_f32_16x16x32_bf16 v[188:191], a[252:255], v[104:107], v[188:191]
ds_read_b64_tr_b16 a[246:247], v229 offset:47104
buffer_load_dwordx4 v233, s[24:27], s47 offen offset:0 lds
s_waitcnt vmcnt(21)
s_waitcnt lgkmcnt(10)
v_mfma_f32_16x16x32_bf16 v[128:131], v[192:195], v[44:47], v[128:131]
ds_read_b64_tr_b16 a[248:249], v230 offset:45056
v_mov_b32 v219, v239
v_mfma_f32_16x16x32_bf16 v[160:163], v[192:195], v[108:111], v[160:163]
ds_read_b64_tr_b16 a[250:251], v230 offset:47104
buffer_load_dwordx4 v234, s[24:27], s47 offen offset:1024 lds
s_waitcnt vmcnt(11)
s_waitcnt lgkmcnt(10)
v_mfma_f32_16x16x32_bf16 v[132:135], v[196:199], v[44:47], v[132:135]
ds_read_b64_tr_b16 a[252:253], v231 offset:45056
v_permlane32_swap_b32 v216, v236
ds_read_b64_tr_b16 a[192:193], v235 offset:0
v_mfma_f32_16x16x32_bf16 v[164:167], v[196:199], v[108:111], v[164:167]
ds_read_b64_tr_b16 a[254:255], v231 offset:47104
s_add_u32 m0, s95, 4096
s_waitcnt lgkmcnt(10)
v_mfma_f32_16x16x32_bf16 v[136:139], v[200:203], v[44:47], v[136:139]
ds_read_b64_tr_b16 v[192:193], v224 offset:49152
v_permlane32_swap_b32 v217, v237
ds_read_b64_tr_b16 a[196:197], v241 offset:0
v_mfma_f32_16x16x32_bf16 v[168:171], v[200:203], v[108:111], v[168:171]
ds_read_b64_tr_b16 v[194:195], v224 offset:51200
s_add_u32 s47, s94, 425984
s_waitcnt lgkmcnt(10)
v_mfma_f32_16x16x32_bf16 v[140:143], v[204:207], v[44:47], v[140:143]
ds_read_b64_tr_b16 v[196:197], v225 offset:49152
v_permlane32_swap_b32 v218, v238
v_permlane32_swap_b32 v219, v239
v_mfma_f32_16x16x32_bf16 v[172:175], v[204:207], v[108:111], v[172:175]
ds_read_b64_tr_b16 v[198:199], v225 offset:51200
ds_read_b64_tr_b16 a[200:201], v242 offset:0
buffer_load_dwordx4 v233, s[24:27], s47 offen offset:0 lds
s_waitcnt lgkmcnt(10)
v_mfma_f32_16x16x32_bf16 v[144:147], a[240:243], v[44:47], v[144:147]
ds_read_b64_tr_b16 v[200:201], v226 offset:49152
v_add_f32 v236, v236, v216
ds_read_b64_tr_b16 a[204:205], v243 offset:0
v_mfma_f32_16x16x32_bf16 v[176:179], a[240:243], v[108:111], v[176:179]
ds_read_b64_tr_b16 v[202:203], v226 offset:51200
buffer_load_dwordx4 v234, s[24:27], s47 offen offset:1024 lds
s_waitcnt lgkmcnt(10)
v_mfma_f32_16x16x32_bf16 v[148:151], a[244:247], v[44:47], v[148:151]
ds_read_b64_tr_b16 v[204:205], v227 offset:49152
v_add_f32 v237, v237, v217
v_mfma_f32_16x16x32_bf16 v[180:183], a[244:247], v[108:111], v[180:183]
ds_read_b64_tr_b16 v[206:207], v227 offset:51200
s_waitcnt lgkmcnt(10)
v_mfma_f32_16x16x32_bf16 v[152:155], a[248:251], v[44:47], v[152:155]
ds_read_b64_tr_b16 a[240:241], v228 offset:49152
v_add_f32 v238, v238, v218
v_mfma_f32_16x16x32_bf16 v[184:187], a[248:251], v[108:111], v[184:187]
ds_read_b64_tr_b16 a[242:243], v228 offset:51200
s_add_u32 m0, s88, 65536
s_add_u32 s47, s94, 65536
s_waitcnt lgkmcnt(10)
v_mfma_f32_16x16x32_bf16 v[156:159], a[252:255], v[44:47], v[156:159]
ds_read_b64_tr_b16 a[244:245], v229 offset:49152
v_add_f32 v239, v239, v219
v_mfma_f32_16x16x32_bf16 v[188:191], a[252:255], v[108:111], v[188:191]
ds_read_b64_tr_b16 a[246:247], v229 offset:51200
buffer_load_dwordx4 v233, s[24:27], s47 offen offset:0 lds
s_waitcnt vmcnt(23)
s_waitcnt lgkmcnt(10)
v_mfma_f32_16x16x32_bf16 v[128:131], v[192:195], v[48:51], v[128:131]
ds_read_b64_tr_b16 a[248:249], v230 offset:49152
v_mul_f32 v236, 0x3b000000, v236
v_mul_f32 v216, v236, v236
v_mfma_f32_16x16x32_bf16 v[160:163], v[192:195], v[112:115], v[160:163]
ds_read_b64_tr_b16 a[250:251], v230 offset:51200
buffer_load_dwordx4 v234, s[24:27], s47 offen offset:1024 lds
s_waitcnt lgkmcnt(10)
v_mfma_f32_16x16x32_bf16 v[132:135], v[196:199], v[48:51], v[132:135]
ds_read_b64_tr_b16 a[252:253], v231 offset:49152
v_fma_f32 v237, v237, s60, -v216
v_mfma_f32_16x16x32_bf16 v[164:167], v[196:199], v[112:115], v[164:167]
ds_read_b64_tr_b16 a[254:255], v231 offset:51200
s_add_u32 m0, s88, 67584
s_add_u32 s47, s94, 81920
s_waitcnt lgkmcnt(10)
v_mfma_f32_16x16x32_bf16 v[136:139], v[200:203], v[48:51], v[136:139]
ds_read_b64_tr_b16 v[192:193], v224 offset:53248
v_max_f32 v237, 0, v237
v_mfma_f32_16x16x32_bf16 v[168:171], v[200:203], v[112:115], v[168:171]
ds_read_b64_tr_b16 v[194:195], v224 offset:55296
buffer_load_dwordx4 v233, s[24:27], s47 offen offset:0 lds
s_waitcnt lgkmcnt(10)
v_mfma_f32_16x16x32_bf16 v[140:143], v[204:207], v[48:51], v[140:143]
ds_read_b64_tr_b16 v[196:197], v225 offset:53248
v_mul_f32 v237, 0x3f800054, v237
v_mfma_f32_16x16x32_bf16 v[172:175], v[204:207], v[112:115], v[172:175]
ds_read_b64_tr_b16 v[198:199], v225 offset:55296
buffer_load_dwordx4 v234, s[24:27], s47 offen offset:1024 lds
s_waitcnt vmcnt(10)
s_waitcnt lgkmcnt(10)
v_mfma_f32_16x16x32_bf16 v[144:147], a[240:243], v[48:51], v[144:147]
ds_read_b64_tr_b16 v[200:201], v226 offset:53248
v_add_f32 v237, 0x2edbe6ff, v237
ds_read_b64_tr_b16 a[194:195], v235 offset:2048
v_mfma_f32_16x16x32_bf16 v[176:179], a[240:243], v[112:115], v[176:179]
ds_read_b64_tr_b16 v[202:203], v226 offset:55296
s_add_u32 m0, s95, 0
s_waitcnt lgkmcnt(10)
v_mfma_f32_16x16x32_bf16 v[148:151], a[244:247], v[48:51], v[148:151]
ds_read_b64_tr_b16 v[204:205], v227 offset:53248
v_rsq_f32 v216, v237
s_nop 0
v_mul_f32 v216, 0x3eeff558, v216
v_mfma_f32_16x16x32_bf16 v[180:183], a[244:247], v[112:115], v[180:183]
ds_read_b64_tr_b16 v[206:207], v227 offset:55296
ds_read_b64_tr_b16 a[198:199], v241 offset:2048
s_add_u32 s47, s94, 442368
s_waitcnt lgkmcnt(10)
v_mfma_f32_16x16x32_bf16 v[152:155], a[248:251], v[48:51], v[152:155]
ds_read_b64_tr_b16 a[240:241], v228 offset:53248
v_mul_f32 v237, -v236, v216
ds_read_b64_tr_b16 a[202:203], v242 offset:2048
v_mfma_f32_16x16x32_bf16 v[184:187], a[248:251], v[112:115], v[184:187]
ds_read_b64_tr_b16 a[242:243], v228 offset:55296
buffer_load_dwordx4 v233, s[24:27], s47 offen offset:0 lds
s_waitcnt lgkmcnt(10)
v_mfma_f32_16x16x32_bf16 v[156:159], a[252:255], v[48:51], v[156:159]
ds_read_b64_tr_b16 a[244:245], v229 offset:53248
v_mov_b32 v236, v216
ds_read_b64_tr_b16 a[206:207], v243 offset:2048
v_mfma_f32_16x16x32_bf16 v[188:191], a[252:255], v[112:115], v[188:191]
ds_read_b64_tr_b16 a[246:247], v229 offset:55296
buffer_load_dwordx4 v234, s[24:27], s47 offen offset:1024 lds
s_waitcnt vmcnt(24)
s_waitcnt lgkmcnt(10)
v_mfma_f32_16x16x32_bf16 v[128:131], v[192:195], v[52:55], v[128:131]
ds_read_b64_tr_b16 a[248:249], v230 offset:53248
v_mul_f32 v238, 0x3b000000, v238
v_mfma_f32_16x16x32_bf16 v[160:163], v[192:195], v[116:119], v[160:163]
ds_read_b64_tr_b16 a[250:251], v230 offset:55296
s_waitcnt lgkmcnt(10)
v_mfma_f32_16x16x32_bf16 v[132:135], v[196:199], v[52:55], v[132:135]
ds_read_b64_tr_b16 a[252:253], v231 offset:53248
v_mul_f32 v217, v238, v238
v_mfma_f32_16x16x32_bf16 v[164:167], v[196:199], v[116:119], v[164:167]
ds_read_b64_tr_b16 a[254:255], v231 offset:55296
s_add_u32 m0, s88, 69632
s_add_u32 s47, s94, 98304
s_waitcnt lgkmcnt(10)
v_mfma_f32_16x16x32_bf16 v[136:139], v[200:203], v[52:55], v[136:139]
ds_read_b64_tr_b16 v[192:193], v224 offset:57344
v_fma_f32 v239, v239, s60, -v217
v_max_f32 v239, 0, v239
v_mfma_f32_16x16x32_bf16 v[168:171], v[200:203], v[116:119], v[168:171]
ds_read_b64_tr_b16 v[194:195], v224 offset:59392
buffer_load_dwordx4 v233, s[24:27], s47 offen offset:0 lds
s_waitcnt lgkmcnt(10)
v_mfma_f32_16x16x32_bf16 v[140:143], v[204:207], v[52:55], v[140:143]
ds_read_b64_tr_b16 v[196:197], v225 offset:57344
v_mul_f32 v239, 0x3f800054, v239
v_mfma_f32_16x16x32_bf16 v[172:175], v[204:207], v[116:119], v[172:175]
ds_read_b64_tr_b16 v[198:199], v225 offset:59392
buffer_load_dwordx4 v234, s[24:27], s47 offen offset:1024 lds
s_waitcnt lgkmcnt(10)
v_mfma_f32_16x16x32_bf16 v[144:147], a[240:243], v[52:55], v[144:147]
ds_read_b64_tr_b16 v[200:201], v226 offset:57344
v_add_f32 v239, 0x2edbe6ff, v239
v_mfma_f32_16x16x32_bf16 v[176:179], a[240:243], v[116:119], v[176:179]
ds_read_b64_tr_b16 v[202:203], v226 offset:59392
s_waitcnt lgkmcnt(10)
v_mfma_f32_16x16x32_bf16 v[148:151], a[244:247], v[52:55], v[148:151]
ds_read_b64_tr_b16 v[204:205], v227 offset:57344
v_rsq_f32 v217, v239
v_mfma_f32_16x16x32_bf16 v[180:183], a[244:247], v[116:119], v[180:183]
ds_read_b64_tr_b16 v[206:207], v227 offset:59392
s_add_u32 m0, s88, 71680
s_add_u32 s47, s94, 114688
s_waitcnt lgkmcnt(10)
v_mfma_f32_16x16x32_bf16 v[152:155], a[248:251], v[52:55], v[152:155]
ds_read_b64_tr_b16 a[240:241], v228 offset:57344
v_mul_f32 v217, 0x3eeff558, v217
v_mfma_f32_16x16x32_bf16 v[184:187], a[248:251], v[116:119], v[184:187]
ds_read_b64_tr_b16 a[242:243], v228 offset:59392
buffer_load_dwordx4 v233, s[24:27], s47 offen offset:0 lds
s_waitcnt vmcnt(9)
s_waitcnt lgkmcnt(10)
v_mfma_f32_16x16x32_bf16 v[156:159], a[252:255], v[52:55], v[156:159]
ds_read_b64_tr_b16 a[244:245], v229 offset:57344
v_mul_f32 v239, -v238, v217
v_mov_b32 v238, v217
v_mfma_f32_16x16x32_bf16 v[188:191], a[252:255], v[116:119], v[188:191]
ds_read_b64_tr_b16 a[246:247], v229 offset:59392
buffer_load_dwordx4 v234, s[24:27], s47 offen offset:1024 lds
ds_read_b64_tr_b16 a[208:209], v235 offset:4096
s_waitcnt vmcnt(26)
s_barrier
s_waitcnt lgkmcnt(10)
v_mfma_f32_16x16x32_bf16 v[128:131], v[192:195], v[56:59], v[128:131]
ds_read_b64_tr_b16 a[248:249], v230 offset:57344
ds_read_b64_tr_b16 a[212:213], v241 offset:4096
v_mfma_f32_16x16x32_bf16 v[160:163], v[192:195], v[120:123], v[160:163]
ds_read_b64_tr_b16 a[250:251], v230 offset:59392
ds_read_b128 v[0:3], v232 offset:0
s_waitcnt lgkmcnt(10)
v_mfma_f32_16x16x32_bf16 v[132:135], v[196:199], v[56:59], v[132:135]
ds_read_b64_tr_b16 a[252:253], v231 offset:57344
ds_read_b64_tr_b16 a[216:217], v242 offset:4096
v_mfma_f32_16x16x32_bf16 v[164:167], v[196:199], v[120:123], v[164:167]
ds_read_b64_tr_b16 a[254:255], v231 offset:59392
ds_read_b128 v[4:7], v232 offset:64
s_waitcnt lgkmcnt(10)
v_mfma_f32_16x16x32_bf16 v[136:139], v[200:203], v[56:59], v[136:139]
ds_read_b64_tr_b16 v[192:193], v224 offset:61440
ds_read_b64_tr_b16 a[220:221], v243 offset:4096
v_mfma_f32_16x16x32_bf16 v[168:171], v[200:203], v[120:123], v[168:171]
ds_read_b64_tr_b16 v[194:195], v224 offset:63488
ds_read_b128 v[8:11], v232 offset:512
s_waitcnt lgkmcnt(10)
v_mfma_f32_16x16x32_bf16 v[140:143], v[204:207], v[56:59], v[140:143]
ds_read_b64_tr_b16 v[196:197], v225 offset:61440
ds_read_b128 v[12:15], v232 offset:576
v_mfma_f32_16x16x32_bf16 v[172:175], v[204:207], v[120:123], v[172:175]
ds_read_b64_tr_b16 v[198:199], v225 offset:63488
s_waitcnt lgkmcnt(10)
v_mfma_f32_16x16x32_bf16 v[144:147], a[240:243], v[56:59], v[144:147]
ds_read_b64_tr_b16 v[200:201], v226 offset:61440
ds_read_b128 v[16:19], v232 offset:128
v_mfma_f32_16x16x32_bf16 v[176:179], a[240:243], v[120:123], v[176:179]
ds_read_b64_tr_b16 v[202:203], v226 offset:63488
s_waitcnt lgkmcnt(10)
v_mfma_f32_16x16x32_bf16 v[148:151], a[244:247], v[56:59], v[148:151]
ds_read_b64_tr_b16 v[204:205], v227 offset:61440
ds_read_b128 v[20:23], v232 offset:192
v_mfma_f32_16x16x32_bf16 v[180:183], a[244:247], v[120:123], v[180:183]
ds_read_b64_tr_b16 v[206:207], v227 offset:63488
s_waitcnt lgkmcnt(10)
v_mfma_f32_16x16x32_bf16 v[152:155], a[248:251], v[56:59], v[152:155]
ds_read_b64_tr_b16 a[240:241], v228 offset:61440
ds_read_b128 v[24:27], v232 offset:640
v_mfma_f32_16x16x32_bf16 v[184:187], a[248:251], v[120:123], v[184:187]
ds_read_b64_tr_b16 a[242:243], v228 offset:63488
s_waitcnt lgkmcnt(10)
v_mfma_f32_16x16x32_bf16 v[156:159], a[252:255], v[56:59], v[156:159]
ds_read_b64_tr_b16 a[244:245], v229 offset:61440
ds_read_b128 v[28:31], v232 offset:704
v_mfma_f32_16x16x32_bf16 v[188:191], a[252:255], v[120:123], v[188:191]
ds_read_b64_tr_b16 a[246:247], v229 offset:63488
s_waitcnt vmcnt(22)
s_waitcnt lgkmcnt(10)
v_mfma_f32_16x16x32_bf16 v[128:131], v[192:195], v[60:63], v[128:131]
ds_read_b64_tr_b16 a[248:249], v230 offset:61440
ds_read_b128 v[64:67], v232 offset:256
v_mfma_f32_16x16x32_bf16 v[160:163], v[192:195], v[124:127], v[160:163]
ds_read_b64_tr_b16 a[250:251], v230 offset:63488
s_waitcnt lgkmcnt(10)
v_mfma_f32_16x16x32_bf16 v[132:135], v[196:199], v[60:63], v[132:135]
ds_read_b64_tr_b16 a[252:253], v231 offset:61440
ds_read_b128 v[68:71], v232 offset:320
v_mfma_f32_16x16x32_bf16 v[164:167], v[196:199], v[124:127], v[164:167]
ds_read_b64_tr_b16 a[254:255], v231 offset:63488
s_waitcnt vmcnt(4)
s_waitcnt lgkmcnt(10)
v_mfma_f32_16x16x32_bf16 v[136:139], v[200:203], v[60:63], v[136:139]
ds_read_b64_tr_b16 a[210:211], v235 offset:0
v_mfma_f32_16x16x32_bf16 v[168:171], v[200:203], v[124:127], v[168:171]
ds_read_b128 v[72:75], v232 offset:768
s_waitcnt lgkmcnt(8)
v_mfma_f32_16x16x32_bf16 v[140:143], v[204:207], v[60:63], v[140:143]
ds_read_b64_tr_b16 a[214:215], v241 offset:0
v_mfma_f32_16x16x32_bf16 v[172:175], v[204:207], v[124:127], v[172:175]
ds_read_b128 v[76:79], v232 offset:832
s_waitcnt lgkmcnt(6)
v_mfma_f32_16x16x32_bf16 v[144:147], a[240:243], v[60:63], v[144:147]
ds_read_b64_tr_b16 a[218:219], v242 offset:0
v_mfma_f32_16x16x32_bf16 v[176:179], a[240:243], v[124:127], v[176:179]
ds_read_b128 v[80:83], v232 offset:384
s_waitcnt lgkmcnt(4)
v_mfma_f32_16x16x32_bf16 v[148:151], a[244:247], v[60:63], v[148:151]
ds_read_b64_tr_b16 a[222:223], v243 offset:0
v_mfma_f32_16x16x32_bf16 v[180:183], a[244:247], v[124:127], v[180:183]
ds_read_b128 v[84:87], v232 offset:448
s_waitcnt lgkmcnt(2)
v_mfma_f32_16x16x32_bf16 v[152:155], a[248:251], v[60:63], v[152:155]
ds_read_b128 v[88:91], v232 offset:896
v_mfma_f32_16x16x32_bf16 v[184:187], a[248:251], v[124:127], v[184:187]
s_waitcnt lgkmcnt(0)
v_mfma_f32_16x16x32_bf16 v[156:159], a[252:255], v[60:63], v[156:159]
ds_read_b128 v[92:95], v232 offset:960
v_mfma_f32_16x16x32_bf16 v[188:191], a[252:255], v[124:127], v[188:191]
s_waitcnt lgkmcnt(0)
s_waitcnt vmcnt(0)
s_barrier
s_lshl_b32 s95, s48, 12
v_mul_u32_u24 v232, 1024, v253
v_add_u32 v232, v232, v252
v_add_u32 v233, 7168, v232
v_add_u32 v234, 14336, v232
v_add_u32 v235, 21504, v232
v_add_u32 v224, s88, v224
v_add_u32 v225, s88, v225
v_add_u32 v226, s88, v226
v_add_u32 v227, s88, v227
v_add_u32 v228, s88, v228
v_add_u32 v229, s88, v229
v_add_u32 v230, s88, v230
v_add_u32 v231, s88, v231
.p2align 3
v_pk_fma_f32 v[208:209], v[0:1], v[236:237], v[8:9] op_sel:[0,1,0] op_sel_hi:[1,1,1]
v_pk_fma_f32 v[210:211], v[2:3], v[236:237], v[10:11] op_sel:[0,1,0] op_sel_hi:[1,1,1]
v_pk_fma_f32 v[212:213], v[4:5], v[236:237], v[12:13] op_sel:[0,1,0] op_sel_hi:[1,1,1]
v_pk_fma_f32 v[214:215], v[6:7], v[236:237], v[14:15] op_sel:[0,1,0] op_sel_hi:[1,1,1]
v_pk_fma_f32 v[128:129], v[128:129], v[236:237], v[208:209] op_sel:[0,0,0] op_sel_hi:[1,0,1]
v_pk_fma_f32 v[130:131], v[130:131], v[236:237], v[210:211] op_sel:[0,0,0] op_sel_hi:[1,0,1]
s_add_u32 m0, s88, 32768
s_add_u32 s47, s94, 131072
buffer_load_dwordx4 v232, s[24:27], s47 offen offset:0 lds
v_pk_fma_f32 v[132:133], v[132:133], v[236:237], v[212:213] op_sel:[0,0,0] op_sel_hi:[1,0,1]
v_pk_fma_f32 v[134:135], v[134:135], v[236:237], v[214:215] op_sel:[0,0,0] op_sel_hi:[1,0,1]
v_pk_fma_f32 v[208:209], v[128:129], v[128:129], s[90:91]
v_pk_fma_f32 v[210:211], v[130:131], v[130:131], s[90:91]
v_pk_fma_f32 v[212:213], v[132:133], v[132:133], s[90:91]
v_pk_fma_f32 v[214:215], v[134:135], v[134:135], s[90:91]
buffer_load_dwordx4 v233, s[24:27], s47 offen offset:1024 lds
v_pk_mul_f32 v[208:209], v[208:209], v[128:129]
v_pk_mul_f32 v[210:211], v[210:211], v[130:131]
v_pk_mul_f32 v[212:213], v[212:213], v[132:133]
v_pk_mul_f32 v[214:215], v[214:215], v[134:135]
ds_read_b64_tr_b16 a[0:1], v224 offset:0
v_exp_f32_e64 v208, -v208
buffer_load_dwordx4 v234, s[24:27], s47 offen offset:2048 lds
v_exp_f32_e64 v210, -v210
v_exp_f32_e64 v212, -v212
v_exp_f32_e64 v214, -v214
v_exp_f32_e64 v209, -v209
v_exp_f32_e64 v211, -v211
v_exp_f32_e64 v213, -v213
buffer_load_dwordx4 v235, s[24:27], s47 offen offset:3072 lds
v_exp_f32_e64 v215, -v215
v_pk_fma_f32 v[208:209], v[208:209], s[92:93], s[92:93]
v_pk_fma_f32 v[210:211], v[210:211], s[92:93], s[92:93]
v_pk_fma_f32 v[212:213], v[212:213], s[92:93], s[92:93]
ds_read_b64_tr_b16 a[2:3], v224 offset:2048
v_pk_fma_f32 v[214:215], v[214:215], s[92:93], s[92:93]
s_add_u32 m0, s88, 36864
s_add_u32 s47, s94, 163840
buffer_load_dwordx4 v232, s[24:27], s47 offen offset:0 lds
v_rcp_f32_e64 v208, v208
v_rcp_f32_e64 v210, v210
v_rcp_f32_e64 v212, v212
v_rcp_f32_e64 v214, v214
v_rcp_f32_e64 v209, v209
v_rcp_f32_e64 v211, v211
buffer_load_dwordx4 v233, s[24:27], s47 offen offset:1024 lds
v_rcp_f32_e64 v213, v213
v_rcp_f32_e64 v215, v215
v_pk_mul_f32 v[128:129], v[128:129], v[208:209]
v_pk_mul_f32 v[130:131], v[130:131], v[210:211]
ds_read_b64_tr_b16 a[4:5], v225 offset:0
v_pk_mul_f32 v[132:133], v[132:133], v[212:213]
buffer_load_dwordx4 v234, s[24:27], s47 offen offset:2048 lds
v_pk_mul_f32 v[134:135], v[134:135], v[214:215]
v_cvt_pk_bf16_f32 v128, v128, v129
v_cvt_pk_bf16_f32 v129, v130, v131
v_cvt_pk_bf16_f32 v130, v132, v133
v_cvt_pk_bf16_f32 v131, v134, v135
ds_read_b64_tr_b16 a[6:7], v225 offset:2048
buffer_load_dwordx4 v235, s[24:27], s47 offen offset:3072 lds
buffer_store_dwordx4 v[128:131], v255, s[28:31], s64 offen offset:0
v_pk_fma_f32 v[208:209], v[0:1], v[238:239], v[8:9] op_sel:[0,1,0] op_sel_hi:[1,1,1]
v_pk_fma_f32 v[210:211], v[2:3], v[238:239], v[10:11] op_sel:[0,1,0] op_sel_hi:[1,1,1]
v_pk_fma_f32 v[212:213], v[4:5], v[238:239], v[12:13] op_sel:[0,1,0] op_sel_hi:[1,1,1]
v_pk_fma_f32 v[214:215], v[6:7], v[238:239], v[14:15] op_sel:[0,1,0] op_sel_hi:[1,1,1]
v_pk_fma_f32 v[160:161], v[160:161], v[238:239], v[208:209] op_sel:[0,0,0] op_sel_hi:[1,0,1]
v_pk_fma_f32 v[162:163], v[162:163], v[238:239], v[210:211] op_sel:[0,0,0] op_sel_hi:[1,0,1]
s_add_u32 m0, s88, 98304
s_add_u32 s47, s94, 196608
buffer_load_dwordx4 v232, s[24:27], s47 offen offset:0 lds
v_pk_fma_f32 v[164:165], v[164:165], v[238:239], v[212:213] op_sel:[0,0,0] op_sel_hi:[1,0,1]
v_pk_fma_f32 v[166:167], v[166:167], v[238:239], v[214:215] op_sel:[0,0,0] op_sel_hi:[1,0,1]
v_pk_fma_f32 v[208:209], v[160:161], v[160:161], s[90:91]
v_pk_fma_f32 v[210:211], v[162:163], v[162:163], s[90:91]
v_pk_fma_f32 v[212:213], v[164:165], v[164:165], s[90:91]
v_pk_fma_f32 v[214:215], v[166:167], v[166:167], s[90:91]
buffer_load_dwordx4 v233, s[24:27], s47 offen offset:1024 lds
v_pk_mul_f32 v[208:209], v[208:209], v[160:161]
v_pk_mul_f32 v[210:211], v[210:211], v[162:163]
v_pk_mul_f32 v[212:213], v[212:213], v[164:165]
v_pk_mul_f32 v[214:215], v[214:215], v[166:167]
ds_read_b64_tr_b16 a[8:9], v226 offset:0
v_exp_f32_e64 v208, -v208
buffer_load_dwordx4 v234, s[24:27], s47 offen offset:2048 lds
v_exp_f32_e64 v210, -v210
v_exp_f32_e64 v212, -v212
v_exp_f32_e64 v214, -v214
v_exp_f32_e64 v209, -v209
v_exp_f32_e64 v211, -v211
v_exp_f32_e64 v213, -v213
buffer_load_dwordx4 v235, s[24:27], s47 offen offset:3072 lds
v_exp_f32_e64 v215, -v215
v_pk_fma_f32 v[208:209], v[208:209], s[92:93], s[92:93]
v_pk_fma_f32 v[210:211], v[210:211], s[92:93], s[92:93]
v_pk_fma_f32 v[212:213], v[212:213], s[92:93], s[92:93]
ds_read_b64_tr_b16 a[10:11], v226 offset:2048
v_pk_fma_f32 v[214:215], v[214:215], s[92:93], s[92:93]
s_add_u32 m0, s88, 102400
s_add_u32 s47, s94, 229376
buffer_load_dwordx4 v232, s[24:27], s47 offen offset:0 lds
v_rcp_f32_e64 v208, v208
v_rcp_f32_e64 v210, v210
v_rcp_f32_e64 v212, v212
v_rcp_f32_e64 v214, v214
v_rcp_f32_e64 v209, v209
v_rcp_f32_e64 v211, v211
buffer_load_dwordx4 v233, s[24:27], s47 offen offset:1024 lds
v_rcp_f32_e64 v213, v213
v_rcp_f32_e64 v215, v215
v_pk_mul_f32 v[160:161], v[160:161], v[208:209]
v_pk_mul_f32 v[162:163], v[162:163], v[210:211]
ds_read_b64_tr_b16 a[12:13], v227 offset:0
v_pk_mul_f32 v[164:165], v[164:165], v[212:213]
buffer_load_dwordx4 v234, s[24:27], s47 offen offset:2048 lds
v_pk_mul_f32 v[166:167], v[166:167], v[214:215]
v_cvt_pk_bf16_f32 v160, v160, v161
v_cvt_pk_bf16_f32 v161, v162, v163
v_cvt_pk_bf16_f32 v162, v164, v165
v_cvt_pk_bf16_f32 v163, v166, v167
ds_read_b64_tr_b16 a[14:15], v227 offset:2048
buffer_load_dwordx4 v235, s[24:27], s47 offen offset:3072 lds
buffer_store_dwordx4 v[160:163], v255, s[28:31], s65 offen offset:0
v_pk_fma_f32 v[208:209], v[16:17], v[236:237], v[24:25] op_sel:[0,1,0] op_sel_hi:[1,1,1]
v_pk_fma_f32 v[210:211], v[18:19], v[236:237], v[26:27] op_sel:[0,1,0] op_sel_hi:[1,1,1]
v_pk_fma_f32 v[212:213], v[20:21], v[236:237], v[28:29] op_sel:[0,1,0] op_sel_hi:[1,1,1]
v_pk_fma_f32 v[214:215], v[22:23], v[236:237], v[30:31] op_sel:[0,1,0] op_sel_hi:[1,1,1]
v_pk_fma_f32 v[136:137], v[136:137], v[236:237], v[208:209] op_sel:[0,0,0] op_sel_hi:[1,0,1]
v_pk_fma_f32 v[138:139], v[138:139], v[236:237], v[210:211] op_sel:[0,0,0] op_sel_hi:[1,0,1]
s_add_u32 m0, s95, 131072
s_add_u32 s47, s94, 262144
buffer_load_dwordx4 v232, s[24:27], s47 offen offset:0 lds
v_pk_fma_f32 v[140:141], v[140:141], v[236:237], v[212:213] op_sel:[0,0,0] op_sel_hi:[1,0,1]
v_pk_fma_f32 v[142:143], v[142:143], v[236:237], v[214:215] op_sel:[0,0,0] op_sel_hi:[1,0,1]
v_pk_fma_f32 v[208:209], v[136:137], v[136:137], s[90:91]
v_pk_fma_f32 v[210:211], v[138:139], v[138:139], s[90:91]
v_pk_fma_f32 v[212:213], v[140:141], v[140:141], s[90:91]
v_pk_fma_f32 v[214:215], v[142:143], v[142:143], s[90:91]
buffer_load_dwordx4 v233, s[24:27], s47 offen offset:1024 lds
v_pk_mul_f32 v[208:209], v[208:209], v[136:137]
v_pk_mul_f32 v[210:211], v[210:211], v[138:139]
v_pk_mul_f32 v[212:213], v[212:213], v[140:141]
v_pk_mul_f32 v[214:215], v[214:215], v[142:143]
ds_read_b64_tr_b16 a[16:17], v224 offset:4096
v_exp_f32_e64 v208, -v208
buffer_load_dwordx4 v234, s[24:27], s47 offen offset:2048 lds
v_exp_f32_e64 v210, -v210
v_exp_f32_e64 v212, -v212
v_exp_f32_e64 v214, -v214
v_exp_f32_e64 v209, -v209
v_exp_f32_e64 v211, -v211
v_exp_f32_e64 v213, -v213
buffer_load_dwordx4 v235, s[24:27], s47 offen offset:3072 lds
v_exp_f32_e64 v215, -v215
v_pk_fma_f32 v[208:209], v[208:209], s[92:93], s[92:93]
v_pk_fma_f32 v[210:211], v[210:211], s[92:93], s[92:93]
v_pk_fma_f32 v[212:213], v[212:213], s[92:93], s[92:93]
ds_read_b64_tr_b16 a[18:19], v224 offset:6144
v_pk_fma_f32 v[214:215], v[214:215], s[92:93], s[92:93]
v_rcp_f32_e64 v208, v208
v_rcp_f32_e64 v210, v210
v_rcp_f32_e64 v212, v212
v_rcp_f32_e64 v214, v214
v_rcp_f32_e64 v209, v209
v_rcp_f32_e64 v211, v211
v_rcp_f32_e64 v213, v213
v_rcp_f32_e64 v215, v215
v_pk_mul_f32 v[136:137], v[136:137], v[208:209]
v_pk_mul_f32 v[138:139], v[138:139], v[210:211]
ds_read_b64_tr_b16 a[20:21], v225 offset:4096
v_pk_mul_f32 v[140:141], v[140:141], v[212:213]
v_pk_mul_f32 v[142:143], v[142:143], v[214:215]
v_cvt_pk_bf16_f32 v136, v136, v137
v_cvt_pk_bf16_f32 v137, v138, v139
v_cvt_pk_bf16_f32 v138, v140, v141
v_cvt_pk_bf16_f32 v139, v142, v143
ds_read_b64_tr_b16 a[22:23], v225 offset:6144
buffer_store_dwordx4 v[136:139], v255, s[28:31], s64 offen offset:1024
v_pk_fma_f32 v[208:209], v[16:17], v[238:239], v[24:25] op_sel:[0,1,0] op_sel_hi:[1,1,1]
v_pk_fma_f32 v[210:211], v[18:19], v[238:239], v[26:27] op_sel:[0,1,0] op_sel_hi:[1,1,1]
v_pk_fma_f32 v[212:213], v[20:21], v[238:239], v[28:29] op_sel:[0,1,0] op_sel_hi:[1,1,1]
v_pk_fma_f32 v[214:215], v[22:23], v[238:239], v[30:31] op_sel:[0,1,0] op_sel_hi:[1,1,1]
v_pk_fma_f32 v[168:169], v[168:169], v[238:239], v[208:209] op_sel:[0,0,0] op_sel_hi:[1,0,1]
v_pk_fma_f32 v[170:171], v[170:171], v[238:239], v[210:211] op_sel:[0,0,0] op_sel_hi:[1,0,1]
v_pk_fma_f32 v[172:173], v[172:173], v[238:239], v[212:213] op_sel:[0,0,0] op_sel_hi:[1,0,1]
v_pk_fma_f32 v[174:175], v[174:175], v[238:239], v[214:215] op_sel:[0,0,0] op_sel_hi:[1,0,1]
v_pk_fma_f32 v[208:209], v[168:169], v[168:169], s[90:91]
v_pk_fma_f32 v[210:211], v[170:171], v[170:171], s[90:91]
v_pk_fma_f32 v[212:213], v[172:173], v[172:173], s[90:91]
v_pk_fma_f32 v[214:215], v[174:175], v[174:175], s[90:91]
v_pk_mul_f32 v[208:209], v[208:209], v[168:169]
v_pk_mul_f32 v[210:211], v[210:211], v[170:171]
v_pk_mul_f32 v[212:213], v[212:213], v[172:173]
v_pk_mul_f32 v[214:215], v[214:215], v[174:175]
ds_read_b64_tr_b16 a[24:25], v226 offset:4096
v_exp_f32_e64 v208, -v208
v_exp_f32_e64 v210, -v210
v_exp_f32_e64 v212, -v212
v_exp_f32_e64 v214, -v214
v_exp_f32_e64 v209, -v209
v_exp_f32_e64 v211, -v211
v_exp_f32_e64 v213, -v213
v_exp_f32_e64 v215, -v215
v_pk_fma_f32 v[208:209], v[208:209], s[92:93], s[92:93]
v_pk_fma_f32 v[210:211], v[210:211], s[92:93], s[92:93]
v_pk_fma_f32 v[212:213], v[212:213], s[92:93], s[92:93]
ds_read_b64_tr_b16 a[26:27], v226 offset:6144
v_pk_fma_f32 v[214:215], v[214:215], s[92:93], s[92:93]
v_rcp_f32_e64 v208, v208
v_rcp_f32_e64 v210, v210
v_rcp_f32_e64 v212, v212
v_rcp_f32_e64 v214, v214
v_rcp_f32_e64 v209, v209
v_rcp_f32_e64 v211, v211
v_rcp_f32_e64 v213, v213
v_rcp_f32_e64 v215, v215
v_pk_mul_f32 v[168:169], v[168:169], v[208:209]
v_pk_mul_f32 v[170:171], v[170:171], v[210:211]
ds_read_b64_tr_b16 a[28:29], v227 offset:4096
v_pk_mul_f32 v[172:173], v[172:173], v[212:213]
v_pk_mul_f32 v[174:175], v[174:175], v[214:215]
v_cvt_pk_bf16_f32 v168, v168, v169
v_cvt_pk_bf16_f32 v169, v170, v171
v_cvt_pk_bf16_f32 v170, v172, v173
v_cvt_pk_bf16_f32 v171, v174, v175
ds_read_b64_tr_b16 a[30:31], v227 offset:6144
buffer_store_dwordx4 v[168:171], v255, s[28:31], s65 offen offset:1024
v_pk_fma_f32 v[208:209], v[64:65], v[236:237], v[72:73] op_sel:[0,1,0] op_sel_hi:[1,1,1]
v_pk_fma_f32 v[210:211], v[66:67], v[236:237], v[74:75] op_sel:[0,1,0] op_sel_hi:[1,1,1]
v_pk_fma_f32 v[212:213], v[68:69], v[236:237], v[76:77] op_sel:[0,1,0] op_sel_hi:[1,1,1]
v_pk_fma_f32 v[214:215], v[70:71], v[236:237], v[78:79] op_sel:[0,1,0] op_sel_hi:[1,1,1]
v_pk_fma_f32 v[144:145], v[144:145], v[236:237], v[208:209] op_sel:[0,0,0] op_sel_hi:[1,0,1]
v_pk_fma_f32 v[146:147], v[146:147], v[236:237], v[210:211] op_sel:[0,0,0] op_sel_hi:[1,0,1]
v_pk_fma_f32 v[148:149], v[148:149], v[236:237], v[212:213] op_sel:[0,0,0] op_sel_hi:[1,0,1]
v_pk_fma_f32 v[150:151], v[150:151], v[236:237], v[214:215] op_sel:[0,0,0] op_sel_hi:[1,0,1]
v_pk_fma_f32 v[208:209], v[144:145], v[144:145], s[90:91]
v_pk_fma_f32 v[210:211], v[146:147], v[146:147], s[90:91]
v_pk_fma_f32 v[212:213], v[148:149], v[148:149], s[90:91]
v_pk_fma_f32 v[214:215], v[150:151], v[150:151], s[90:91]
v_pk_mul_f32 v[208:209], v[208:209], v[144:145]
v_pk_mul_f32 v[210:211], v[210:211], v[146:147]
v_pk_mul_f32 v[212:213], v[212:213], v[148:149]
v_pk_mul_f32 v[214:215], v[214:215], v[150:151]
ds_read_b64_tr_b16 a[32:33], v228 offset:0
v_exp_f32_e64 v208, -v208
v_exp_f32_e64 v210, -v210
v_exp_f32_e64 v212, -v212
v_exp_f32_e64 v214, -v214
v_exp_f32_e64 v209, -v209
v_exp_f32_e64 v211, -v211
v_exp_f32_e64 v213, -v213
v_exp_f32_e64 v215, -v215
v_pk_fma_f32 v[208:209], v[208:209], s[92:93], s[92:93]
v_pk_fma_f32 v[210:211], v[210:211], s[92:93], s[92:93]
v_pk_fma_f32 v[212:213], v[212:213], s[92:93], s[92:93]
ds_read_b64_tr_b16 a[34:35], v228 offset:2048
v_pk_fma_f32 v[214:215], v[214:215], s[92:93], s[92:93]
v_rcp_f32_e64 v208, v208
v_rcp_f32_e64 v210, v210
v_rcp_f32_e64 v212, v212
v_rcp_f32_e64 v214, v214
v_rcp_f32_e64 v209, v209
v_rcp_f32_e64 v211, v211
v_rcp_f32_e64 v213, v213
v_rcp_f32_e64 v215, v215
v_pk_mul_f32 v[144:145], v[144:145], v[208:209]
v_pk_mul_f32 v[146:147], v[146:147], v[210:211]
ds_read_b64_tr_b16 a[36:37], v229 offset:0
v_pk_mul_f32 v[148:149], v[148:149], v[212:213]
v_pk_mul_f32 v[150:151], v[150:151], v[214:215]
v_cvt_pk_bf16_f32 v144, v144, v145
v_cvt_pk_bf16_f32 v145, v146, v147
v_cvt_pk_bf16_f32 v146, v148, v149
v_cvt_pk_bf16_f32 v147, v150, v151
ds_read_b64_tr_b16 a[38:39], v229 offset:2048
buffer_store_dwordx4 v[144:147], v255, s[28:31], s64 offen offset:2048
v_pk_fma_f32 v[208:209], v[64:65], v[238:239], v[72:73] op_sel:[0,1,0] op_sel_hi:[1,1,1]
v_pk_fma_f32 v[210:211], v[66:67], v[238:239], v[74:75] op_sel:[0,1,0] op_sel_hi:[1,1,1]
v_pk_fma_f32 v[212:213], v[68:69], v[238:239], v[76:77] op_sel:[0,1,0] op_sel_hi:[1,1,1]
v_pk_fma_f32 v[214:215], v[70:71], v[238:239], v[78:79] op_sel:[0,1,0] op_sel_hi:[1,1,1]
v_pk_fma_f32 v[176:177], v[176:177], v[238:239], v[208:209] op_sel:[0,0,0] op_sel_hi:[1,0,1]
v_pk_fma_f32 v[178:179], v[178:179], v[238:239], v[210:211] op_sel:[0,0,0] op_sel_hi:[1,0,1]
v_pk_fma_f32 v[180:181], v[180:181], v[238:239], v[212:213] op_sel:[0,0,0] op_sel_hi:[1,0,1]
v_pk_fma_f32 v[182:183], v[182:183], v[238:239], v[214:215] op_sel:[0,0,0] op_sel_hi:[1,0,1]
v_pk_fma_f32 v[208:209], v[176:177], v[176:177], s[90:91]
v_pk_fma_f32 v[210:211], v[178:179], v[178:179], s[90:91]
v_pk_fma_f32 v[212:213], v[180:181], v[180:181], s[90:91]
v_pk_fma_f32 v[214:215], v[182:183], v[182:183], s[90:91]
v_pk_mul_f32 v[208:209], v[208:209], v[176:177]
v_pk_mul_f32 v[210:211], v[210:211], v[178:179]
v_pk_mul_f32 v[212:213], v[212:213], v[180:181]
v_pk_mul_f32 v[214:215], v[214:215], v[182:183]
ds_read_b64_tr_b16 a[40:41], v230 offset:0
v_exp_f32_e64 v208, -v208
v_exp_f32_e64 v210, -v210
v_exp_f32_e64 v212, -v212
v_exp_f32_e64 v214, -v214
v_exp_f32_e64 v209, -v209
v_exp_f32_e64 v211, -v211
v_exp_f32_e64 v213, -v213
v_exp_f32_e64 v215, -v215
v_pk_fma_f32 v[208:209], v[208:209], s[92:93], s[92:93]
v_pk_fma_f32 v[210:211], v[210:211], s[92:93], s[92:93]
v_pk_fma_f32 v[212:213], v[212:213], s[92:93], s[92:93]
ds_read_b64_tr_b16 a[42:43], v230 offset:2048
v_pk_fma_f32 v[214:215], v[214:215], s[92:93], s[92:93]
v_rcp_f32_e64 v208, v208
v_rcp_f32_e64 v210, v210
v_rcp_f32_e64 v212, v212
v_rcp_f32_e64 v214, v214
v_rcp_f32_e64 v209, v209
v_rcp_f32_e64 v211, v211
v_rcp_f32_e64 v213, v213
v_rcp_f32_e64 v215, v215
v_pk_mul_f32 v[176:177], v[176:177], v[208:209]
v_pk_mul_f32 v[178:179], v[178:179], v[210:211]
ds_read_b64_tr_b16 a[44:45], v231 offset:0
v_pk_mul_f32 v[180:181], v[180:181], v[212:213]
v_pk_mul_f32 v[182:183], v[182:183], v[214:215]
v_cvt_pk_bf16_f32 v176, v176, v177
v_cvt_pk_bf16_f32 v177, v178, v179
v_cvt_pk_bf16_f32 v178, v180, v181
v_cvt_pk_bf16_f32 v179, v182, v183
ds_read_b64_tr_b16 a[46:47], v231 offset:2048
buffer_store_dwordx4 v[176:179], v255, s[28:31], s65 offen offset:2048
v_pk_fma_f32 v[208:209], v[80:81], v[236:237], v[88:89] op_sel:[0,1,0] op_sel_hi:[1,1,1]
v_pk_fma_f32 v[210:211], v[82:83], v[236:237], v[90:91] op_sel:[0,1,0] op_sel_hi:[1,1,1]
v_pk_fma_f32 v[212:213], v[84:85], v[236:237], v[92:93] op_sel:[0,1,0] op_sel_hi:[1,1,1]
v_pk_fma_f32 v[214:215], v[86:87], v[236:237], v[94:95] op_sel:[0,1,0] op_sel_hi:[1,1,1]
v_pk_fma_f32 v[152:153], v[152:153], v[236:237], v[208:209] op_sel:[0,0,0] op_sel_hi:[1,0,1]
v_pk_fma_f32 v[154:155], v[154:155], v[236:237], v[210:211] op_sel:[0,0,0] op_sel_hi:[1,0,1]
v_pk_fma_f32 v[156:157], v[156:157], v[236:237], v[212:213] op_sel:[0,0,0] op_sel_hi:[1,0,1]
v_pk_fma_f32 v[158:159], v[158:159], v[236:237], v[214:215] op_sel:[0,0,0] op_sel_hi:[1,0,1]
v_pk_fma_f32 v[208:209], v[152:153], v[152:153], s[90:91]
v_pk_fma_f32 v[210:211], v[154:155], v[154:155], s[90:91]
v_pk_fma_f32 v[212:213], v[156:157], v[156:157], s[90:91]
v_pk_fma_f32 v[214:215], v[158:159], v[158:159], s[90:91]
v_pk_mul_f32 v[208:209], v[208:209], v[152:153]
v_pk_mul_f32 v[210:211], v[210:211], v[154:155]
v_pk_mul_f32 v[212:213], v[212:213], v[156:157]
v_pk_mul_f32 v[214:215], v[214:215], v[158:159]
ds_read_b64_tr_b16 a[48:49], v228 offset:4096
v_exp_f32_e64 v208, -v208
v_exp_f32_e64 v210, -v210
v_exp_f32_e64 v212, -v212
v_exp_f32_e64 v214, -v214
v_exp_f32_e64 v209, -v209
v_exp_f32_e64 v211, -v211
v_exp_f32_e64 v213, -v213
v_exp_f32_e64 v215, -v215
v_pk_fma_f32 v[208:209], v[208:209], s[92:93], s[92:93]
v_pk_fma_f32 v[210:211], v[210:211], s[92:93], s[92:93]
v_pk_fma_f32 v[212:213], v[212:213], s[92:93], s[92:93]
ds_read_b64_tr_b16 a[50:51], v228 offset:6144
v_pk_fma_f32 v[214:215], v[214:215], s[92:93], s[92:93]
v_rcp_f32_e64 v208, v208
v_rcp_f32_e64 v210, v210
v_rcp_f32_e64 v212, v212
v_rcp_f32_e64 v214, v214
v_rcp_f32_e64 v209, v209
v_rcp_f32_e64 v211, v211
v_rcp_f32_e64 v213, v213
v_rcp_f32_e64 v215, v215
v_pk_mul_f32 v[152:153], v[152:153], v[208:209]
v_pk_mul_f32 v[154:155], v[154:155], v[210:211]
ds_read_b64_tr_b16 a[52:53], v229 offset:4096
v_pk_mul_f32 v[156:157], v[156:157], v[212:213]
v_pk_mul_f32 v[158:159], v[158:159], v[214:215]
v_cvt_pk_bf16_f32 v152, v152, v153
v_cvt_pk_bf16_f32 v153, v154, v155
v_cvt_pk_bf16_f32 v154, v156, v157
v_cvt_pk_bf16_f32 v155, v158, v159
ds_read_b64_tr_b16 a[54:55], v229 offset:6144
buffer_store_dwordx4 v[152:155], v255, s[28:31], s64 offen offset:3072
v_pk_fma_f32 v[208:209], v[80:81], v[238:239], v[88:89] op_sel:[0,1,0] op_sel_hi:[1,1,1]
v_pk_fma_f32 v[210:211], v[82:83], v[238:239], v[90:91] op_sel:[0,1,0] op_sel_hi:[1,1,1]
v_pk_fma_f32 v[212:213], v[84:85], v[238:239], v[92:93] op_sel:[0,1,0] op_sel_hi:[1,1,1]
v_pk_fma_f32 v[214:215], v[86:87], v[238:239], v[94:95] op_sel:[0,1,0] op_sel_hi:[1,1,1]
v_pk_fma_f32 v[184:185], v[184:185], v[238:239], v[208:209] op_sel:[0,0,0] op_sel_hi:[1,0,1]
v_pk_fma_f32 v[186:187], v[186:187], v[238:239], v[210:211] op_sel:[0,0,0] op_sel_hi:[1,0,1]
v_pk_fma_f32 v[188:189], v[188:189], v[238:239], v[212:213] op_sel:[0,0,0] op_sel_hi:[1,0,1]
v_pk_fma_f32 v[190:191], v[190:191], v[238:239], v[214:215] op_sel:[0,0,0] op_sel_hi:[1,0,1]
v_pk_fma_f32 v[208:209], v[184:185], v[184:185], s[90:91]
v_pk_fma_f32 v[210:211], v[186:187], v[186:187], s[90:91]
v_pk_fma_f32 v[212:213], v[188:189], v[188:189], s[90:91]
v_pk_fma_f32 v[214:215], v[190:191], v[190:191], s[90:91]
v_pk_mul_f32 v[208:209], v[208:209], v[184:185]
v_pk_mul_f32 v[210:211], v[210:211], v[186:187]
v_pk_mul_f32 v[212:213], v[212:213], v[188:189]
v_pk_mul_f32 v[214:215], v[214:215], v[190:191]
ds_read_b64_tr_b16 a[56:57], v230 offset:4096
v_exp_f32_e64 v208, -v208
v_exp_f32_e64 v210, -v210
v_exp_f32_e64 v212, -v212
v_exp_f32_e64 v214, -v214
v_exp_f32_e64 v209, -v209
v_exp_f32_e64 v211, -v211
v_exp_f32_e64 v213, -v213
v_exp_f32_e64 v215, -v215
v_pk_fma_f32 v[208:209], v[208:209], s[92:93], s[92:93]
v_pk_fma_f32 v[210:211], v[210:211], s[92:93], s[92:93]
v_pk_fma_f32 v[212:213], v[212:213], s[92:93], s[92:93]
ds_read_b64_tr_b16 a[58:59], v230 offset:6144
v_pk_fma_f32 v[214:215], v[214:215], s[92:93], s[92:93]
v_rcp_f32_e64 v208, v208
v_rcp_f32_e64 v210, v210
v_rcp_f32_e64 v212, v212
v_rcp_f32_e64 v214, v214
v_rcp_f32_e64 v209, v209
v_rcp_f32_e64 v211, v211
v_rcp_f32_e64 v213, v213
v_rcp_f32_e64 v215, v215
v_pk_mul_f32 v[184:185], v[184:185], v[208:209]
v_pk_mul_f32 v[186:187], v[186:187], v[210:211]
ds_read_b64_tr_b16 a[60:61], v231 offset:4096
v_pk_mul_f32 v[188:189], v[188:189], v[212:213]
v_pk_mul_f32 v[190:191], v[190:191], v[214:215]
v_cvt_pk_bf16_f32 v184, v184, v185
v_cvt_pk_bf16_f32 v185, v186, v187
v_cvt_pk_bf16_f32 v186, v188, v189
v_cvt_pk_bf16_f32 v187, v190, v191
ds_read_b64_tr_b16 a[62:63], v231 offset:6144
buffer_store_dwordx4 v[184:187], v255, s[28:31], s65 offen offset:3072
s_lshl_b32 s59, s51, 8
s_add_u32 s59, s59, 8192
s_lshl_b32 s56, s52, 2
s_add_u32 s56, s56, s48
s_lshl_b32 s56, s56, 2
s_add_u32 s56, s56, s59
s_waitcnt vmcnt(0)
s_mov_b64 exec, 1
v_mov_b32 v243, 1
s_cmp_lg_u32 s46, 0
s_cbranch_scc1 SG19
buffer_store_dword v243, off, s[28:31], s56
s_branch SG18
SG19:
buffer_wbl2 sc1
s_waitcnt vmcnt(0)
buffer_store_dword v243, off, s[28:31], s56 sc1
SG18:
s_mov_b64 exec, -1
ds_read_b64_tr_b16 a[64:65], v224 offset:32768
ds_read_b64_tr_b16 a[66:67], v224 offset:34816
ds_read_b64_tr_b16 a[68:69], v225 offset:32768
ds_read_b64_tr_b16 a[70:71], v225 offset:34816
ds_read_b64_tr_b16 a[72:73], v226 offset:32768
ds_read_b64_tr_b16 a[74:75], v226 offset:34816
ds_read_b64_tr_b16 a[76:77], v227 offset:32768
ds_read_b64_tr_b16 a[78:79], v227 offset:34816
ds_read_b64_tr_b16 a[80:81], v224 offset:36864
ds_read_b64_tr_b16 a[82:83], v224 offset:38912
ds_read_b64_tr_b16 a[84:85], v225 offset:36864
ds_read_b64_tr_b16 a[86:87], v225 offset:38912
ds_read_b64_tr_b16 a[88:89], v226 offset:36864
ds_read_b64_tr_b16 a[90:91], v226 offset:38912
ds_read_b64_tr_b16 a[92:93], v227 offset:36864
ds_read_b64_tr_b16 a[94:95], v227 offset:38912
ds_read_b64_tr_b16 a[96:97], v228 offset:32768
ds_read_b64_tr_b16 a[98:99], v228 offset:34816
ds_read_b64_tr_b16 a[100:101], v229 offset:32768
ds_read_b64_tr_b16 a[102:103], v229 offset:34816
ds_read_b64_tr_b16 a[104:105], v230 offset:32768
ds_read_b64_tr_b16 a[106:107], v230 offset:34816
ds_read_b64_tr_b16 a[108:109], v231 offset:32768
ds_read_b64_tr_b16 a[110:111], v231 offset:34816
ds_read_b64_tr_b16 a[112:113], v228 offset:36864
ds_read_b64_tr_b16 a[114:115], v228 offset:38912
ds_read_b64_tr_b16 a[116:117], v229 offset:36864
ds_read_b64_tr_b16 a[118:119], v229 offset:38912
ds_read_b64_tr_b16 a[120:121], v230 offset:36864
ds_read_b64_tr_b16 a[122:123], v230 offset:38912
ds_read_b64_tr_b16 a[124:125], v231 offset:36864
ds_read_b64_tr_b16 a[126:127], v231 offset:38912
s_add_u32 s95, s95, 131072
v_add_u32 v224, s95, v254
v_xor_b32 v225, 32, v224
v_xor_b32 v226, 64, v224
v_xor_b32 v227, 96, v224
ds_read_b64_tr_b16 a[128:129], v224 offset:0
ds_read_b64_tr_b16 a[130:131], v224 offset:2048
ds_read_b64_tr_b16 a[132:133], v225 offset:0
ds_read_b64_tr_b16 a[134:135], v225 offset:2048
ds_read_b64_tr_b16 a[136:137], v226 offset:0
ds_read_b64_tr_b16 a[138:139], v226 offset:2048
ds_read_b64_tr_b16 a[140:141], v227 offset:0
ds_read_b64_tr_b16 a[142:143], v227 offset:2048
s_branch ID15
ID14:
s_barrier
v_mul_u32_u24 v232, 1024, v253
v_add_u32 v232, v232, v252
v_add_u32 v233, 7168, v232
v_add_u32 v234, 14336, v232
v_add_u32 v235, 21504, v232
s_mul_i32 s58, s48, 458752
s_lshl_b32 s54, s50, 7
s_add_u32 s58, s58, s54
s_mul_i32 s55, s48, 36864
s_add_u32 m0, s55, 0
s_add_u32 s54, s58, 0
buffer_load_dwordx4 v232, s[24:27], s54 offen offset:0 lds
buffer_load_dwordx4 v233, s[24:27], s54 offen offset:1024 lds
buffer_load_dwordx4 v234, s[24:27], s54 offen offset:2048 lds
buffer_load_dwordx4 v235, s[24:27], s54 offen offset:3072 lds
s_add_u32 m0, s55, 4096
s_add_u32 s54, s58, 32768
buffer_load_dwordx4 v232, s[24:27], s54 offen offset:0 lds
buffer_load_dwordx4 v233, s[24:27], s54 offen offset:1024 lds
buffer_load_dwordx4 v234, s[24:27], s54 offen offset:2048 lds
buffer_load_dwordx4 v235, s[24:27], s54 offen offset:3072 lds
s_add_u32 m0, s55, 8192
s_add_u32 s54, s58, 65536
buffer_load_dwordx4 v232, s[24:27], s54 offen offset:0 lds
buffer_load_dwordx4 v233, s[24:27], s54 offen offset:1024 lds
buffer_load_dwordx4 v234, s[24:27], s54 offen offset:2048 lds
buffer_load_dwordx4 v235, s[24:27], s54 offen offset:3072 lds
s_add_u32 m0, s55, 12288
s_add_u32 s54, s58, 98304
buffer_load_dwordx4 v232, s[24:27], s54 offen offset:0 lds
buffer_load_dwordx4 v233, s[24:27], s54 offen offset:1024 lds
buffer_load_dwordx4 v234, s[24:27], s54 offen offset:2048 lds
buffer_load_dwordx4 v235, s[24:27], s54 offen offset:3072 lds
s_add_u32 m0, s55, 16384
s_add_u32 s54, s58, 131072
buffer_load_dwordx4 v232, s[24:27], s54 offen offset:0 lds
buffer_load_dwordx4 v233, s[24:27], s54 offen offset:1024 lds
buffer_load_dwordx4 v234, s[24:27], s54 offen offset:2048 lds
buffer_load_dwordx4 v235, s[24:27], s54 offen offset:3072 lds
s_add_u32 m0, s55, 20480
s_add_u32 s54, s58, 163840
buffer_load_dwordx4 v232, s[24:27], s54 offen offset:0 lds
buffer_load_dwordx4 v233, s[24:27], s54 offen offset:1024 lds
buffer_load_dwordx4 v234, s[24:27], s54 offen offset:2048 lds
buffer_load_dwordx4 v235, s[24:27], s54 offen offset:3072 lds
s_add_u32 m0, s55, 24576
s_add_u32 s54, s58, 196608
buffer_load_dwordx4 v232, s[24:27], s54 offen offset:0 lds
buffer_load_dwordx4 v233, s[24:27], s54 offen offset:1024 lds
buffer_load_dwordx4 v234, s[24:27], s54 offen offset:2048 lds
buffer_load_dwordx4 v235, s[24:27], s54 offen offset:3072 lds
s_add_u32 m0, s55, 28672
s_add_u32 s54, s58, 229376
buffer_load_dwordx4 v232, s[24:27], s54 offen offset:0 lds
buffer_load_dwordx4 v233, s[24:27], s54 offen offset:1024 lds
buffer_load_dwordx4 v234, s[24:27], s54 offen offset:2048 lds
buffer_load_dwordx4 v235, s[24:27], s54 offen offset:3072 lds
s_add_u32 m0, s55, 32768
s_add_u32 s54, s58, 262144
buffer_load_dwordx4 v232, s[24:27], s54 offen offset:0 lds
buffer_load_dwordx4 v233, s[24:27], s54 offen offset:1024 lds
buffer_load_dwordx4 v234, s[24:27], s54 offen offset:2048 lds
buffer_load_dwordx4 v235, s[24:27], s54 offen offset:3072 lds
s_waitcnt vmcnt(0)
s_mul_i32 s55, s48, 36864
v_add_u32 v224, s55, v254
v_xor_b32 v225, 32, v224
v_xor_b32 v226, 64, v224
v_xor_b32 v227, 96, v224
ds_read_b64_tr_b16 a[0:1], v224 offset:0
ds_read_b64_tr_b16 a[2:3], v224 offset:2048
ds_read_b64_tr_b16 a[4:5], v225 offset:0
ds_read_b64_tr_b16 a[6:7], v225 offset:2048
ds_read_b64_tr_b16 a[8:9], v226 offset:0
ds_read_b64_tr_b16 a[10:11], v226 offset:2048
ds_read_b64_tr_b16 a[12:13], v227 offset:0
ds_read_b64_tr_b16 a[14:15], v227 offset:2048
ds_read_b64_tr_b16 a[16:17], v224 offset:4096
ds_read_b64_tr_b16 a[18:19], v224 offset:6144
ds_read_b64_tr_b16 a[20:21], v225 offset:4096
ds_read_b64_tr_b16 a[22:23], v225 offset:6144
ds_read_b64_tr_b16 a[24:25], v226 offset:4096
ds_read_b64_tr_b16 a[26:27], v226 offset:6144
ds_read_b64_tr_b16 a[28:29], v227 offset:4096
ds_read_b64_tr_b16 a[30:31], v227 offset:6144
ds_read_b64_tr_b16 a[32:33], v224 offset:8192
ds_read_b64_tr_b16 a[34:35], v224 offset:10240
ds_read_b64_tr_b16 a[36:37], v225 offset:8192
ds_read_b64_tr_b16 a[38:39], v225 offset:10240
ds_read_b64_tr_b16 a[40:41], v226 offset:8192
ds_read_b64_tr_b16 a[42:43], v226 offset:10240
ds_read_b64_tr_b16 a[44:45], v227 offset:8192
ds_read_b64_tr_b16 a[46:47], v227 offset:10240
ds_read_b64_tr_b16 a[48:49], v224 offset:12288
ds_read_b64_tr_b16 a[50:51], v224 offset:14336
ds_read_b64_tr_b16 a[52:53], v225 offset:12288
ds_read_b64_tr_b16 a[54:55], v225 offset:14336
ds_read_b64_tr_b16 a[56:57], v226 offset:12288
ds_read_b64_tr_b16 a[58:59], v226 offset:14336
ds_read_b64_tr_b16 a[60:61], v227 offset:12288
ds_read_b64_tr_b16 a[62:63], v227 offset:14336
ds_read_b64_tr_b16 a[64:65], v224 offset:16384
ds_read_b64_tr_b16 a[66:67], v224 offset:18432
ds_read_b64_tr_b16 a[68:69], v225 offset:16384
ds_read_b64_tr_b16 a[70:71], v225 offset:18432
ds_read_b64_tr_b16 a[72:73], v226 offset:16384
ds_read_b64_tr_b16 a[74:75], v226 offset:18432
ds_read_b64_tr_b16 a[76:77], v227 offset:16384
ds_read_b64_tr_b16 a[78:79], v227 offset:18432
ds_read_b64_tr_b16 a[80:81], v224 offset:20480
ds_read_b64_tr_b16 a[82:83], v224 offset:22528
ds_read_b64_tr_b16 a[84:85], v225 offset:20480
ds_read_b64_tr_b16 a[86:87], v225 offset:22528
ds_read_b64_tr_b16 a[88:89], v226 offset:20480
ds_read_b64_tr_b16 a[90:91], v226 offset:22528
ds_read_b64_tr_b16 a[92:93], v227 offset:20480
ds_read_b64_tr_b16 a[94:95], v227 offset:22528
ds_read_b64_tr_b16 a[96:97], v224 offset:24576
ds_read_b64_tr_b16 a[98:99], v224 offset:26624
ds_read_b64_tr_b16 a[100:101], v225 offset:24576
ds_read_b64_tr_b16 a[102:103], v225 offset:26624
ds_read_b64_tr_b16 a[104:105], v226 offset:24576
ds_read_b64_tr_b16 a[106:107], v226 offset:26624
ds_read_b64_tr_b16 a[108:109], v227 offset:24576
ds_read_b64_tr_b16 a[110:111], v227 offset:26624
ds_read_b64_tr_b16 a[112:113], v224 offset:28672
ds_read_b64_tr_b16 a[114:115], v224 offset:30720
ds_read_b64_tr_b16 a[116:117], v225 offset:28672
ds_read_b64_tr_b16 a[118:119], v225 offset:30720
ds_read_b64_tr_b16 a[120:121], v226 offset:28672
ds_read_b64_tr_b16 a[122:123], v226 offset:30720
ds_read_b64_tr_b16 a[124:125], v227 offset:28672
ds_read_b64_tr_b16 a[126:127], v227 offset:30720
ds_read_b64_tr_b16 a[128:129], v224 offset:32768
ds_read_b64_tr_b16 a[130:131], v224 offset:34816
ds_read_b64_tr_b16 a[132:133], v225 offset:32768
ds_read_b64_tr_b16 a[134:135], v225 offset:34816
ds_read_b64_tr_b16 a[136:137], v226 offset:32768
ds_read_b64_tr_b16 a[138:139], v226 offset:34816
ds_read_b64_tr_b16 a[140:141], v227 offset:32768
ds_read_b64_tr_b16 a[142:143], v227 offset:34816
s_waitcnt lgkmcnt(0)
s_mul_i32 s58, s48, 458752
s_lshl_b32 s54, s50, 7
s_add_u32 s58, s58, s54
s_mul_i32 s55, s48, 36864
s_add_u32 m0, s55, 0
s_add_u32 s54, s58, 294912
buffer_load_dwordx4 v232, s[24:27], s54 offen offset:0 lds
buffer_load_dwordx4 v233, s[24:27], s54 offen offset:1024 lds
buffer_load_dwordx4 v234, s[24:27], s54 offen offset:2048 lds
buffer_load_dwordx4 v235, s[24:27], s54 offen offset:3072 lds
s_add_u32 m0, s55, 4096
s_add_u32 s54, s58, 327680
buffer_load_dwordx4 v232, s[24:27], s54 offen offset:0 lds
buffer_load_dwordx4 v233, s[24:27], s54 offen offset:1024 lds
buffer_load_dwordx4 v234, s[24:27], s54 offen offset:2048 lds
buffer_load_dwordx4 v235, s[24:27], s54 offen offset:3072 lds
s_add_u32 m0, s55, 8192
s_add_u32 s54, s58, 360448
buffer_load_dwordx4 v232, s[24:27], s54 offen offset:0 lds
buffer_load_dwordx4 v233, s[24:27], s54 offen offset:1024 lds
buffer_load_dwordx4 v234, s[24:27], s54 offen offset:2048 lds
buffer_load_dwordx4 v235, s[24:27], s54 offen offset:3072 lds
s_add_u32 m0, s55, 12288
s_add_u32 s54, s58, 393216
buffer_load_dwordx4 v232, s[24:27], s54 offen offset:0 lds
buffer_load_dwordx4 v233, s[24:27], s54 offen offset:1024 lds
buffer_load_dwordx4 v234, s[24:27], s54 offen offset:2048 lds
buffer_load_dwordx4 v235, s[24:27], s54 offen offset:3072 lds
s_add_u32 m0, s55, 16384
s_add_u32 s54, s58, 425984
buffer_load_dwordx4 v232, s[24:27], s54 offen offset:0 lds
buffer_load_dwordx4 v233, s[24:27], s54 offen offset:1024 lds
buffer_load_dwordx4 v234, s[24:27], s54 offen offset:2048 lds
buffer_load_dwordx4 v235, s[24:27], s54 offen offset:3072 lds
s_waitcnt vmcnt(0)
s_mul_i32 s55, s48, 36864
v_add_u32 v224, s55, v254
v_xor_b32 v225, 32, v224
v_xor_b32 v226, 64, v224
v_xor_b32 v227, 96, v224
ds_read_b64_tr_b16 a[144:145], v224 offset:0
ds_read_b64_tr_b16 a[146:147], v224 offset:2048
ds_read_b64_tr_b16 a[148:149], v225 offset:0
ds_read_b64_tr_b16 a[150:151], v225 offset:2048
ds_read_b64_tr_b16 a[152:153], v226 offset:0
ds_read_b64_tr_b16 a[154:155], v226 offset:2048
ds_read_b64_tr_b16 a[156:157], v227 offset:0
ds_read_b64_tr_b16 a[158:159], v227 offset:2048
ds_read_b64_tr_b16 a[160:161], v224 offset:4096
ds_read_b64_tr_b16 a[162:163], v224 offset:6144
ds_read_b64_tr_b16 a[164:165], v225 offset:4096
ds_read_b64_tr_b16 a[166:167], v225 offset:6144
ds_read_b64_tr_b16 a[168:169], v226 offset:4096
ds_read_b64_tr_b16 a[170:171], v226 offset:6144
ds_read_b64_tr_b16 a[172:173], v227 offset:4096
ds_read_b64_tr_b16 a[174:175], v227 offset:6144
ds_read_b64_tr_b16 a[176:177], v224 offset:8192
ds_read_b64_tr_b16 a[178:179], v224 offset:10240
ds_read_b64_tr_b16 a[180:181], v225 offset:8192
ds_read_b64_tr_b16 a[182:183], v225 offset:10240
ds_read_b64_tr_b16 a[184:185], v226 offset:8192
ds_read_b64_tr_b16 a[186:187], v226 offset:10240
ds_read_b64_tr_b16 a[188:189], v227 offset:8192
ds_read_b64_tr_b16 a[190:191], v227 offset:10240
ds_read_b64_tr_b16 a[192:193], v224 offset:12288
ds_read_b64_tr_b16 a[194:195], v224 offset:14336
ds_read_b64_tr_b16 a[196:197], v225 offset:12288
ds_read_b64_tr_b16 a[198:199], v225 offset:14336
ds_read_b64_tr_b16 a[200:201], v226 offset:12288
ds_read_b64_tr_b16 a[202:203], v226 offset:14336
ds_read_b64_tr_b16 a[204:205], v227 offset:12288
ds_read_b64_tr_b16 a[206:207], v227 offset:14336
ds_read_b64_tr_b16 a[208:209], v224 offset:16384
ds_read_b64_tr_b16 a[210:211], v224 offset:18432
ds_read_b64_tr_b16 a[212:213], v225 offset:16384
ds_read_b64_tr_b16 a[214:215], v225 offset:18432
ds_read_b64_tr_b16 a[216:217], v226 offset:16384
ds_read_b64_tr_b16 a[218:219], v226 offset:18432
ds_read_b64_tr_b16 a[220:221], v227 offset:16384
ds_read_b64_tr_b16 a[222:223], v227 offset:18432
s_waitcnt lgkmcnt(0)
ID15:
s_mul_i32 s54, s49, 229376
s_mul_i32 s55, s48, 14336
s_add_u32 s54, s54, s55
s_add_u32 s54, s54, 11534336
s_add_u32 s55, s48, 0
s_and_b32 s55, s55, 3
s_mul_i32 s55, s55, 57344
s_add_u32 s62, s54, s55
s_add_u32 s55, s48, 1
s_and_b32 s55, s55, 3
s_mul_i32 s55, s55, 57344
s_add_u32 s63, s54, s55
s_add_u32 s55, s48, 2
s_and_b32 s55, s55, 3
s_mul_i32 s55, s55, 57344
s_add_u32 s64, s54, s55
s_add_u32 s55, s48, 3
s_and_b32 s55, s55, 3
s_mul_i32 s55, s55, 57344
s_add_u32 s65, s54, s55
s_mul_i32 s54, s48, 14
s_lshr_b32 s54, s54, 2
s_lshl_b32 s54, s54, 4
s_and_b32 s55, s49, 1
s_lshl_b32 s55, s55, 3
s_add_u32 s54, s54, s55
s_lshl_b32 s55, s51, 8
s_add_u32 s54, s54, s55
s_add_u32 s54, s54, 8192
s_mov_b32 s88, s54
v_bfe_u32 v228, v255, 4, 4
v_lshrrev_b32 v229, 6, v255
v_and_b32 v229, 12, v229
v_sub_u32 v228, v228, v229
v_cmp_gt_u32 vcc, 4, v228
v_mov_b32 v222, 0x3f80
v_mov_b32 v223, 0
v_lshlrev_b32 v228, 4, v228
v_cndmask_b32 v222, 0, v222, vcc
v_lshlrev_b64 v[222:223], v228, v[222:223]
s_mov_b32 s89, 161792
v_lshl_add_u32 v229, v229, 2, s89
ds_read_b128 v[128:131], v229 offset:0
ds_read_b128 v[132:135], v229 offset:64
ds_read_b128 v[136:139], v229 offset:128
ds_read_b128 v[140:143], v229 offset:192
s_add_u32 s54, s48, 1
s_and_b32 s54, s54, 3
s_mul_i32 s54, s54, 6144
s_add_u32 s54, s54, 131072
v_add_u32 v225, s54, v255
s_add_u32 s54, s48, 2
s_and_b32 s54, s54, 3
s_mul_i32 s54, s54, 6144
s_add_u32 s54, s54, 133120
v_add_u32 v226, s54, v255
s_add_u32 s54, s48, 3
s_and_b32 s54, s54, 3
s_mul_i32 s54, s54, 6144
s_add_u32 s54, s54, 135168
v_add_u32 v227, s54, v255
s_mul_i32 s54, s48, 6144
s_add_u32 s54, s54, 131072
v_add_u32 v224, s54, v255
v_bfe_u32 v231, v255, 5, 2
v_lshlrev_b32 v231, 4, v231
v_bfe_u32 v230, v255, 4, 1
v_lshl_add_u32 v231, v230, 2, v231
s_waitcnt lgkmcnt(0)
v_mfma_f32_16x16x16_bf16 v[128:131], v[222:223], v[244:245], v[128:131]
v_mfma_f32_16x16x16_bf16 v[132:135], v[222:223], v[246:247], v[132:135]
v_mfma_f32_16x16x16_bf16 v[136:139], v[222:223], v[248:249], v[136:139]
v_mfma_f32_16x16x16_bf16 v[140:143], v[222:223], v[250:251], v[140:143]
s_mov_b32 s57, 100000
PL20:
buffer_load_dword v230, v231, s[28:31], s88 offen sc1
s_waitcnt vmcnt(0)
v_cmp_ne_u32 vcc, 1, v230
s_sub_u32 s57, s57, 1
s_nop 3
s_cbranch_vccz PL21
s_cmp_lg_u32 s57, 0
s_cbranch_scc1 PL20
PL21:
buffer_load_dwordx4 v[0:3], v255, s[28:31], s62 offen offset:0 sc1
buffer_load_dwordx4 v[4:7], v255, s[28:31], s63 offen offset:0 sc1
buffer_load_dwordx4 v[8:11], v255, s[28:31], s64 offen offset:0 sc1
buffer_load_dwordx4 v[12:15], v255, s[28:31], s65 offen offset:0 sc1
buffer_load_dwordx4 v[16:19], v255, s[28:31], s62 offen offset:1024 sc1
buffer_load_dwordx4 v[20:23], v255, s[28:31], s63 offen offset:1024 sc1
buffer_load_dwordx4 v[24:27], v255, s[28:31], s64 offen offset:1024 sc1
buffer_load_dwordx4 v[28:31], v255, s[28:31], s65 offen offset:1024 sc1
buffer_load_dwordx4 v[32:35], v255, s[28:31], s62 offen offset:2048 sc1
buffer_load_dwordx4 v[36:39], v255, s[28:31], s63 offen offset:2048 sc1
buffer_load_dwordx4 v[40:43], v255, s[28:31], s64 offen offset:2048 sc1
buffer_load_dwordx4 v[44:47], v255, s[28:31], s65 offen offset:2048 sc1
s_lshl_b32 s58, s50, 7
v_mul_u32_u24 v232, 3072, v253
v_add_u32 v232, v232, v252
v_add_u32 v233, 23552, v232
v_add_u32 v234, 47104, v232
v_add_u32 v235, 70656, v232
s_lshr_b32 s54, s48, 1
s_mul_i32 s54, s54, 98304
s_add_u32 s94, s58, s54
s_and_b32 s54, s48, 1
s_lshl_b32 s54, s54, 10
s_add_u32 s94, s94, s54
s_lshl_b32 s95, s48, 12
s_waitcnt vmcnt(11)
v_mfma_f32_16x16x32_bf16 v[128:131], a[0:3], v[0:3], v[128:131]
v_mfma_f32_16x16x32_bf16 v[132:135], a[4:7], v[0:3], v[132:135]
buffer_load_dwordx4 v[48:51], v255, s[28:31], s62 offen offset:3072 sc1
v_mfma_f32_16x16x32_bf16 v[136:139], a[8:11], v[0:3], v[136:139]
v_mfma_f32_16x16x32_bf16 v[140:143], a[12:15], v[0:3], v[140:143]
buffer_load_dwordx4 v[52:55], v255, s[28:31], s63 offen offset:3072 sc1
s_waitcnt vmcnt(12)
v_mfma_f32_16x16x32_bf16 v[144:147], a[0:3], v[4:7], 0
v_mfma_f32_16x16x32_bf16 v[148:151], a[4:7], v[4:7], 0
buffer_load_dwordx4 v[56:59], v255, s[28:31], s64 offen offset:3072 sc1
v_mfma_f32_16x16x32_bf16 v[152:155], a[8:11], v[4:7], 0
v_mfma_f32_16x16x32_bf16 v[156:159], a[12:15], v[4:7], 0
buffer_load_dwordx4 v[60:63], v255, s[28:31], s65 offen offset:3072 sc1
s_waitcnt vmcnt(13)
v_mfma_f32_16x16x32_bf16 v[160:163], a[0:3], v[8:11], 0
v_mfma_f32_16x16x32_bf16 v[164:167], a[4:7], v[8:11], 0
s_add_u32 s62, s62, 4096
s_add_u32 s63, s63, 4096
s_add_u32 s64, s64, 4096
s_add_u32 s65, s65, 4096
buffer_load_dwordx4 v[64:67], v255, s[28:31], s62 offen offset:0 sc1
v_mfma_f32_16x16x32_bf16 v[168:171], a[8:11], v[8:11], 0
v_mfma_f32_16x16x32_bf16 v[172:175], a[12:15], v[8:11], 0
buffer_load_dwordx4 v[68:71], v255, s[28:31], s63 offen offset:0 sc1
s_waitcnt vmcnt(14)
v_mfma_f32_16x16x32_bf16 v[176:179], a[0:3], v[12:15], 0
v_mfma_f32_16x16x32_bf16 v[180:183], a[4:7], v[12:15], 0
buffer_load_dwordx4 v[72:75], v255, s[28:31], s64 offen offset:0 sc1
v_mfma_f32_16x16x32_bf16 v[184:187], a[8:11], v[12:15], 0
v_mfma_f32_16x16x32_bf16 v[188:191], a[12:15], v[12:15], 0
buffer_load_dwordx4 v[76:79], v255, s[28:31], s65 offen offset:0 sc1
s_waitcnt vmcnt(15)
v_mfma_f32_16x16x32_bf16 v[128:131], a[16:19], v[16:19], v[128:131]
v_mfma_f32_16x16x32_bf16 v[132:135], a[20:23], v[16:19], v[132:135]
buffer_load_dwordx4 v[80:83], v255, s[28:31], s62 offen offset:1024 sc1
v_mfma_f32_16x16x32_bf16 v[136:139], a[24:27], v[16:19], v[136:139]
v_mfma_f32_16x16x32_bf16 v[140:143], a[28:31], v[16:19], v[140:143]
buffer_load_dwordx4 v[84:87], v255, s[28:31], s63 offen offset:1024 sc1
s_waitcnt vmcnt(16)
v_mfma_f32_16x16x32_bf16 v[144:147], a[16:19], v[20:23], v[144:147]
v_mfma_f32_16x16x32_bf16 v[148:151], a[20:23], v[20:23], v[148:151]
buffer_load_dwordx4 v[88:91], v255, s[28:31], s64 offen offset:1024 sc1
v_mfma_f32_16x16x32_bf16 v[152:155], a[24:27], v[20:23], v[152:155]
v_mfma_f32_16x16x32_bf16 v[156:159], a[28:31], v[20:23], v[156:159]
buffer_load_dwordx4 v[92:95], v255, s[28:31], s65 offen offset:1024 sc1
s_waitcnt vmcnt(17)
v_mfma_f32_16x16x32_bf16 v[160:163], a[16:19], v[24:27], v[160:163]
v_mfma_f32_16x16x32_bf16 v[164:167], a[20:23], v[24:27], v[164:167]
buffer_load_dwordx4 v[96:99], v255, s[28:31], s62 offen offset:2048 sc1
v_mfma_f32_16x16x32_bf16 v[168:171], a[24:27], v[24:27], v[168:171]
v_mfma_f32_16x16x32_bf16 v[172:175], a[28:31], v[24:27], v[172:175]
buffer_load_dwordx4 v[100:103], v255, s[28:31], s63 offen offset:2048 sc1
s_waitcnt vmcnt(18)
v_mfma_f32_16x16x32_bf16 v[176:179], a[16:19], v[28:31], v[176:179]
v_mfma_f32_16x16x32_bf16 v[180:183], a[20:23], v[28:31], v[180:183]
buffer_load_dwordx4 v[104:107], v255, s[28:31], s64 offen offset:2048 sc1
v_mfma_f32_16x16x32_bf16 v[184:187], a[24:27], v[28:31], v[184:187]
v_mfma_f32_16x16x32_bf16 v[188:191], a[28:31], v[28:31], v[188:191]
buffer_load_dwordx4 v[108:111], v255, s[28:31], s65 offen offset:2048 sc1
s_waitcnt vmcnt(19)
v_mfma_f32_16x16x32_bf16 v[128:131], a[32:35], v[32:35], v[128:131]
v_mfma_f32_16x16x32_bf16 v[132:135], a[36:39], v[32:35], v[132:135]
buffer_load_dwordx4 v[112:115], v255, s[28:31], s62 offen offset:3072 sc1
v_mfma_f32_16x16x32_bf16 v[136:139], a[40:43], v[32:35], v[136:139]
v_mfma_f32_16x16x32_bf16 v[140:143], a[44:47], v[32:35], v[140:143]
buffer_load_dwordx4 v[116:119], v255, s[28:31], s63 offen offset:3072 sc1
s_waitcnt vmcnt(20)
v_mfma_f32_16x16x32_bf16 v[144:147], a[32:35], v[36:39], v[144:147]
v_mfma_f32_16x16x32_bf16 v[148:151], a[36:39], v[36:39], v[148:151]
buffer_load_dwordx4 v[120:123], v255, s[28:31], s64 offen offset:3072 sc1
v_mfma_f32_16x16x32_bf16 v[152:155], a[40:43], v[36:39], v[152:155]
v_mfma_f32_16x16x32_bf16 v[156:159], a[44:47], v[36:39], v[156:159]
buffer_load_dwordx4 v[124:127], v255, s[28:31], s65 offen offset:3072 sc1
s_waitcnt vmcnt(21)
v_mfma_f32_16x16x32_bf16 v[160:163], a[32:35], v[40:43], v[160:163]
v_mfma_f32_16x16x32_bf16 v[164:167], a[36:39], v[40:43], v[164:167]
s_add_u32 s62, s62, 4096
s_add_u32 s63, s63, 4096
s_add_u32 s64, s64, 4096
s_add_u32 s65, s65, 4096
buffer_load_dwordx4 v[0:3], v255, s[28:31], s62 offen offset:0 sc1
v_mfma_f32_16x16x32_bf16 v[168:171], a[40:43], v[40:43], v[168:171]
v_mfma_f32_16x16x32_bf16 v[172:175], a[44:47], v[40:43], v[172:175]
buffer_load_dwordx4 v[4:7], v255, s[28:31], s63 offen offset:0 sc1
s_waitcnt vmcnt(22)
v_mfma_f32_16x16x32_bf16 v[176:179], a[32:35], v[44:47], v[176:179]
v_mfma_f32_16x16x32_bf16 v[180:183], a[36:39], v[44:47], v[180:183]
buffer_load_dwordx4 v[8:11], v255, s[28:31], s64 offen offset:0 sc1
v_mfma_f32_16x16x32_bf16 v[184:187], a[40:43], v[44:47], v[184:187]
v_mfma_f32_16x16x32_bf16 v[188:191], a[44:47], v[44:47], v[188:191]
buffer_load_dwordx4 v[12:15], v255, s[28:31], s65 offen offset:0 sc1
s_waitcnt vmcnt(23)
v_mfma_f32_16x16x32_bf16 v[128:131], a[48:51], v[48:51], v[128:131]
v_mfma_f32_16x16x32_bf16 v[132:135], a[52:55], v[48:51], v[132:135]
buffer_load_dwordx4 v[16:19], v255, s[28:31], s62 offen offset:1024 sc1
v_mfma_f32_16x16x32_bf16 v[136:139], a[56:59], v[48:51], v[136:139]
v_mfma_f32_16x16x32_bf16 v[140:143], a[60:63], v[48:51], v[140:143]
s_waitcnt vmcnt(23)
v_mfma_f32_16x16x32_bf16 v[144:147], a[48:51], v[52:55], v[144:147]
v_mfma_f32_16x16x32_bf16 v[148:151], a[52:55], v[52:55], v[148:151]
buffer_load_dwordx4 v[20:23], v255, s[28:31], s63 offen offset:1024 sc1
v_mfma_f32_16x16x32_bf16 v[152:155], a[56:59], v[52:55], v[152:155]
v_mfma_f32_16x16x32_bf16 v[156:159], a[60:63], v[52:55], v[156:159]
s_waitcnt vmcnt(23)
v_mfma_f32_16x16x32_bf16 v[160:163], a[48:51], v[56:59], v[160:163]
v_mfma_f32_16x16x32_bf16 v[164:167], a[52:55], v[56:59], v[164:167]
buffer_load_dwordx4 v[24:27], v255, s[28:31], s64 offen offset:1024 sc1
v_mfma_f32_16x16x32_bf16 v[168:171], a[56:59], v[56:59], v[168:171]
v_mfma_f32_16x16x32_bf16 v[172:175], a[60:63], v[56:59], v[172:175]
s_waitcnt vmcnt(23)
v_mfma_f32_16x16x32_bf16 v[176:179], a[48:51], v[60:63], v[176:179]
v_mfma_f32_16x16x32_bf16 v[180:183], a[52:55], v[60:63], v[180:183]
buffer_load_dwordx4 v[28:31], v255, s[28:31], s65 offen offset:1024 sc1
v_mfma_f32_16x16x32_bf16 v[184:187], a[56:59], v[60:63], v[184:187]
v_mfma_f32_16x16x32_bf16 v[188:191], a[60:63], v[60:63], v[188:191]
s_waitcnt vmcnt(23)
v_mfma_f32_16x16x32_bf16 v[128:131], a[64:67], v[64:67], v[128:131]
v_mfma_f32_16x16x32_bf16 v[132:135], a[68:71], v[64:67], v[132:135]
buffer_load_dwordx4 v[32:35], v255, s[28:31], s62 offen offset:2048 sc1
v_mfma_f32_16x16x32_bf16 v[136:139], a[72:75], v[64:67], v[136:139]
v_mfma_f32_16x16x32_bf16 v[140:143], a[76:79], v[64:67], v[140:143]
s_waitcnt vmcnt(23)
v_mfma_f32_16x16x32_bf16 v[144:147], a[64:67], v[68:71], v[144:147]
v_mfma_f32_16x16x32_bf16 v[148:151], a[68:71], v[68:71], v[148:151]
buffer_load_dwordx4 v[36:39], v255, s[28:31], s63 offen offset:2048 sc1
v_mfma_f32_16x16x32_bf16 v[152:155], a[72:75], v[68:71], v[152:155]
v_mfma_f32_16x16x32_bf16 v[156:159], a[76:79], v[68:71], v[156:159]
s_waitcnt vmcnt(23)
v_mfma_f32_16x16x32_bf16 v[160:163], a[64:67], v[72:75], v[160:163]
v_mfma_f32_16x16x32_bf16 v[164:167], a[68:71], v[72:75], v[164:167]
buffer_load_dwordx4 v[40:43], v255, s[28:31], s64 offen offset:2048 sc1
v_mfma_f32_16x16x32_bf16 v[168:171], a[72:75], v[72:75], v[168:171]
v_mfma_f32_16x16x32_bf16 v[172:175], a[76:79], v[72:75], v[172:175]
s_waitcnt vmcnt(23)
v_mfma_f32_16x16x32_bf16 v[176:179], a[64:67], v[76:79], v[176:179]
v_mfma_f32_16x16x32_bf16 v[180:183], a[68:71], v[76:79], v[180:183]
buffer_load_dwordx4 v[44:47], v255, s[28:31], s65 offen offset:2048 sc1
v_mfma_f32_16x16x32_bf16 v[184:187], a[72:75], v[76:79], v[184:187]
v_mfma_f32_16x16x32_bf16 v[188:191], a[76:79], v[76:79], v[188:191]
s_waitcnt vmcnt(23)
v_mfma_f32_16x16x32_bf16 v[128:131], a[80:83], v[80:83], v[128:131]
v_mfma_f32_16x16x32_bf16 v[132:135], a[84:87], v[80:83], v[132:135]
buffer_load_dwordx4 v[48:51], v255, s[28:31], s62 offen offset:3072 sc1
v_mfma_f32_16x16x32_bf16 v[136:139], a[88:91], v[80:83], v[136:139]
v_mfma_f32_16x16x32_bf16 v[140:143], a[92:95], v[80:83], v[140:143]
s_waitcnt vmcnt(23)
v_mfma_f32_16x16x32_bf16 v[144:147], a[80:83], v[84:87], v[144:147]
v_mfma_f32_16x16x32_bf16 v[148:151], a[84:87], v[84:87], v[148:151]
buffer_load_dwordx4 v[52:55], v255, s[28:31], s63 offen offset:3072 sc1
v_mfma_f32_16x16x32_bf16 v[152:155], a[88:91], v[84:87], v[152:155]
v_mfma_f32_16x16x32_bf16 v[156:159], a[92:95], v[84:87], v[156:159]
s_waitcnt vmcnt(23)
v_mfma_f32_16x16x32_bf16 v[160:163], a[80:83], v[88:91], v[160:163]
v_mfma_f32_16x16x32_bf16 v[164:167], a[84:87], v[88:91], v[164:167]
buffer_load_dwordx4 v[56:59], v255, s[28:31], s64 offen offset:3072 sc1
v_mfma_f32_16x16x32_bf16 v[168:171], a[88:91], v[88:91], v[168:171]
v_mfma_f32_16x16x32_bf16 v[172:175], a[92:95], v[88:91], v[172:175]
s_waitcnt vmcnt(23)
v_mfma_f32_16x16x32_bf16 v[176:179], a[80:83], v[92:95], v[176:179]
v_mfma_f32_16x16x32_bf16 v[180:183], a[84:87], v[92:95], v[180:183]
buffer_load_dwordx4 v[60:63], v255, s[28:31], s65 offen offset:3072 sc1
v_mfma_f32_16x16x32_bf16 v[184:187], a[88:91], v[92:95], v[184:187]
v_mfma_f32_16x16x32_bf16 v[188:191], a[92:95], v[92:95], v[188:191]
s_waitcnt vmcnt(23)
v_mfma_f32_16x16x32_bf16 v[128:131], a[96:99], v[96:99], v[128:131]
v_mfma_f32_16x16x32_bf16 v[132:135], a[100:103], v[96:99], v[132:135]
s_add_u32 s62, s62, 4096
s_add_u32 s63, s63, 4096
s_add_u32 s64, s64, 4096
s_add_u32 s65, s65, 4096
buffer_load_dwordx4 v[64:67], v255, s[28:31], s62 offen offset:0 sc1
v_mfma_f32_16x16x32_bf16 v[136:139], a[104:107], v[96:99], v[136:139]
v_mfma_f32_16x16x32_bf16 v[140:143], a[108:111], v[96:99], v[140:143]
s_waitcnt vmcnt(23)
v_mfma_f32_16x16x32_bf16 v[144:147], a[96:99], v[100:103], v[144:147]
v_mfma_f32_16x16x32_bf16 v[148:151], a[100:103], v[100:103], v[148:151]
buffer_load_dwordx4 v[68:71], v255, s[28:31], s63 offen offset:0 sc1
v_mfma_f32_16x16x32_bf16 v[152:155], a[104:107], v[100:103], v[152:155]
v_mfma_f32_16x16x32_bf16 v[156:159], a[108:111], v[100:103], v[156:159]
s_waitcnt vmcnt(23)
v_mfma_f32_16x16x32_bf16 v[160:163], a[96:99], v[104:107], v[160:163]
v_mfma_f32_16x16x32_bf16 v[164:167], a[100:103], v[104:107], v[164:167]
buffer_load_dwordx4 v[72:75], v255, s[28:31], s64 offen offset:0 sc1
v_mfma_f32_16x16x32_bf16 v[168:171], a[104:107], v[104:107], v[168:171]
v_mfma_f32_16x16x32_bf16 v[172:175], a[108:111], v[104:107], v[172:175]
s_waitcnt vmcnt(23)
v_mfma_f32_16x16x32_bf16 v[176:179], a[96:99], v[108:111], v[176:179]
v_mfma_f32_16x16x32_bf16 v[180:183], a[100:103], v[108:111], v[180:183]
buffer_load_dwordx4 v[76:79], v255, s[28:31], s65 offen offset:0 sc1
v_mfma_f32_16x16x32_bf16 v[184:187], a[104:107], v[108:111], v[184:187]
v_mfma_f32_16x16x32_bf16 v[188:191], a[108:111], v[108:111], v[188:191]
s_waitcnt vmcnt(23)
v_mfma_f32_16x16x32_bf16 v[128:131], a[112:115], v[112:115], v[128:131]
v_mfma_f32_16x16x32_bf16 v[132:135], a[116:119], v[112:115], v[132:135]
buffer_load_dwordx4 v[80:83], v255, s[28:31], s62 offen offset:1024 sc1
v_mfma_f32_16x16x32_bf16 v[136:139], a[120:123], v[112:115], v[136:139]
v_mfma_f32_16x16x32_bf16 v[140:143], a[124:127], v[112:115], v[140:143]
s_waitcnt vmcnt(23)
v_mfma_f32_16x16x32_bf16 v[144:147], a[112:115], v[116:119], v[144:147]
v_mfma_f32_16x16x32_bf16 v[148:151], a[116:119], v[116:119], v[148:151]
buffer_load_dwordx4 v[84:87], v255, s[28:31], s63 offen offset:1024 sc1
v_mfma_f32_16x16x32_bf16 v[152:155], a[120:123], v[116:119], v[152:155]
v_mfma_f32_16x16x32_bf16 v[156:159], a[124:127], v[116:119], v[156:159]
s_waitcnt vmcnt(23)
v_mfma_f32_16x16x32_bf16 v[160:163], a[112:115], v[120:123], v[160:163]
v_mfma_f32_16x16x32_bf16 v[164:167], a[116:119], v[120:123], v[164:167]
buffer_load_dwordx4 v[88:91], v255, s[28:31], s64 offen offset:1024 sc1
v_mfma_f32_16x16x32_bf16 v[168:171], a[120:123], v[120:123], v[168:171]
v_mfma_f32_16x16x32_bf16 v[172:175], a[124:127], v[120:123], v[172:175]
s_waitcnt vmcnt(23)
v_mfma_f32_16x16x32_bf16 v[176:179], a[112:115], v[124:127], v[176:179]
v_mfma_f32_16x16x32_bf16 v[180:183], a[116:119], v[124:127], v[180:183]
buffer_load_dwordx4 v[92:95], v255, s[28:31], s65 offen offset:1024 sc1
v_mfma_f32_16x16x32_bf16 v[184:187], a[120:123], v[124:127], v[184:187]
v_mfma_f32_16x16x32_bf16 v[188:191], a[124:127], v[124:127], v[188:191]
s_waitcnt vmcnt(23)
v_mfma_f32_16x16x32_bf16 v[128:131], a[128:131], v[0:3], v[128:131]
v_mfma_f32_16x16x32_bf16 v[132:135], a[132:135], v[0:3], v[132:135]
s_barrier
s_add_u32 m0, s95, 0
s_add_u32 s47, s94, 1024
buffer_load_dwordx4 v232, s[12:15], s47 offen offset:0 lds
v_mfma_f32_16x16x32_bf16 v[136:139], a[136:139], v[0:3], v[136:139]
v_mfma_f32_16x16x32_bf16 v[140:143], a[140:143], v[0:3], v[140:143]
buffer_load_dwordx4 v233, s[12:15], s47 offen offset:1024 lds
s_waitcnt vmcnt(24)
v_mfma_f32_16x16x32_bf16 v[144:147], a[128:131], v[4:7], v[144:147]
v_mfma_f32_16x16x32_bf16 v[148:151], a[132:135], v[4:7], v[148:151]
buffer_load_dwordx4 v234, s[12:15], s47 offen offset:2048 lds
v_mfma_f32_16x16x32_bf16 v[152:155], a[136:139], v[4:7], v[152:155]
v_mfma_f32_16x16x32_bf16 v[156:159], a[140:143], v[4:7], v[156:159]
buffer_load_dwordx4 v235, s[12:15], s47 offen offset:3072 lds
s_waitcnt vmcnt(25)
v_mfma_f32_16x16x32_bf16 v[160:163], a[128:131], v[8:11], v[160:163]
v_mfma_f32_16x16x32_bf16 v[164:167], a[132:135], v[8:11], v[164:167]
s_add_u32 m0, s95, 16384
s_add_u32 s47, s94, 197632
buffer_load_dwordx4 v232, s[12:15], s47 offen offset:0 lds
v_mfma_f32_16x16x32_bf16 v[168:171], a[136:139], v[8:11], v[168:171]
v_mfma_f32_16x16x32_bf16 v[172:175], a[140:143], v[8:11], v[172:175]
buffer_load_dwordx4 v233, s[12:15], s47 offen offset:1024 lds
s_waitcnt vmcnt(26)
v_mfma_f32_16x16x32_bf16 v[176:179], a[128:131], v[12:15], v[176:179]
v_mfma_f32_16x16x32_bf16 v[180:183], a[132:135], v[12:15], v[180:183]
buffer_load_dwordx4 v234, s[12:15], s47 offen offset:2048 lds
v_mfma_f32_16x16x32_bf16 v[184:187], a[136:139], v[12:15], v[184:187]
v_mfma_f32_16x16x32_bf16 v[188:191], a[140:143], v[12:15], v[188:191]
buffer_load_dwordx4 v235, s[12:15], s47 offen offset:3072 lds
s_waitcnt vmcnt(27)
v_mfma_f32_16x16x32_bf16 v[128:131], a[144:147], v[16:19], v[128:131]
v_mfma_f32_16x16x32_bf16 v[132:135], a[148:151], v[16:19], v[132:135]
s_add_u32 m0, s95, 32768
s_add_u32 s47, s94, 394240
buffer_load_dwordx4 v232, s[12:15], s47 offen offset:0 lds
v_mfma_f32_16x16x32_bf16 v[136:139], a[152:155], v[16:19], v[136:139]
v_mfma_f32_16x16x32_bf16 v[140:143], a[156:159], v[16:19], v[140:143]
buffer_load_dwordx4 v233, s[12:15], s47 offen offset:1024 lds
s_waitcnt vmcnt(28)
v_mfma_f32_16x16x32_bf16 v[144:147], a[144:147], v[20:23], v[144:147]
v_mfma_f32_16x16x32_bf16 v[148:151], a[148:151], v[20:23], v[148:151]
buffer_load_dwordx4 v234, s[12:15], s47 offen offset:2048 lds
v_mfma_f32_16x16x32_bf16 v[152:155], a[152:155], v[20:23], v[152:155]
v_mfma_f32_16x16x32_bf16 v[156:159], a[156:159], v[20:23], v[156:159]
buffer_load_dwordx4 v235, s[12:15], s47 offen offset:3072 lds
s_waitcnt vmcnt(29)
v_mfma_f32_16x16x32_bf16 v[160:163], a[144:147], v[24:27], v[160:163]
v_mfma_f32_16x16x32_bf16 v[164:167], a[148:151], v[24:27], v[164:167]
v_mfma_f32_16x16x32_bf16 v[168:171], a[152:155], v[24:27], v[168:171]
v_mfma_f32_16x16x32_bf16 v[172:175], a[156:159], v[24:27], v[172:175]
s_waitcnt vmcnt(28)
v_mfma_f32_16x16x32_bf16 v[176:179], a[144:147], v[28:31], v[176:179]
v_mfma_f32_16x16x32_bf16 v[180:183], a[148:151], v[28:31], v[180:183]
v_mfma_f32_16x16x32_bf16 v[184:187], a[152:155], v[28:31], v[184:187]
v_mfma_f32_16x16x32_bf16 v[188:191], a[156:159], v[28:31], v[188:191]
s_waitcnt vmcnt(27)
v_mfma_f32_16x16x32_bf16 v[128:131], a[160:163], v[32:35], v[128:131]
v_mfma_f32_16x16x32_bf16 v[132:135], a[164:167], v[32:35], v[132:135]
v_mfma_f32_16x16x32_bf16 v[136:139], a[168:171], v[32:35], v[136:139]
v_mfma_f32_16x16x32_bf16 v[140:143], a[172:175], v[32:35], v[140:143]
s_waitcnt vmcnt(26)
v_mfma_f32_16x16x32_bf16 v[144:147], a[160:163], v[36:39], v[144:147]
v_mfma_f32_16x16x32_bf16 v[148:151], a[164:167], v[36:39], v[148:151]
v_mfma_f32_16x16x32_bf16 v[152:155], a[168:171], v[36:39], v[152:155]
v_mfma_f32_16x16x32_bf16 v[156:159], a[172:175], v[36:39], v[156:159]
s_waitcnt vmcnt(25)
v_mfma_f32_16x16x32_bf16 v[160:163], a[160:163], v[40:43], v[160:163]
v_mfma_f32_16x16x32_bf16 v[164:167], a[164:167], v[40:43], v[164:167]
v_mfma_f32_16x16x32_bf16 v[168:171], a[168:171], v[40:43], v[168:171]
v_mfma_f32_16x16x32_bf16 v[172:175], a[172:175], v[40:43], v[172:175]
s_waitcnt vmcnt(24)
v_mfma_f32_16x16x32_bf16 v[176:179], a[160:163], v[44:47], v[176:179]
v_mfma_f32_16x16x32_bf16 v[180:183], a[164:167], v[44:47], v[180:183]
v_mfma_f32_16x16x32_bf16 v[184:187], a[168:171], v[44:47], v[184:187]
v_mfma_f32_16x16x32_bf16 v[188:191], a[172:175], v[44:47], v[188:191]
s_waitcnt vmcnt(23)
v_mfma_f32_16x16x32_bf16 v[128:131], a[176:179], v[48:51], v[128:131]
v_mfma_f32_16x16x32_bf16 v[132:135], a[180:183], v[48:51], v[132:135]
v_mfma_f32_16x16x32_bf16 v[136:139], a[184:187], v[48:51], v[136:139]
v_mfma_f32_16x16x32_bf16 v[140:143], a[188:191], v[48:51], v[140:143]
s_waitcnt vmcnt(22)
v_mfma_f32_16x16x32_bf16 v[144:147], a[176:179], v[52:55], v[144:147]
v_mfma_f32_16x16x32_bf16 v[148:151], a[180:183], v[52:55], v[148:151]
v_mfma_f32_16x16x32_bf16 v[152:155], a[184:187], v[52:55], v[152:155]
v_mfma_f32_16x16x32_bf16 v[156:159], a[188:191], v[52:55], v[156:159]
s_waitcnt vmcnt(21)
v_mfma_f32_16x16x32_bf16 v[160:163], a[176:179], v[56:59], v[160:163]
v_mfma_f32_16x16x32_bf16 v[164:167], a[180:183], v[56:59], v[164:167]
v_mfma_f32_16x16x32_bf16 v[168:171], a[184:187], v[56:59], v[168:171]
v_mfma_f32_16x16x32_bf16 v[172:175], a[188:191], v[56:59], v[172:175]
s_waitcnt vmcnt(20)
v_mfma_f32_16x16x32_bf16 v[176:179], a[176:179], v[60:63], v[176:179]
v_mfma_f32_16x16x32_bf16 v[180:183], a[180:183], v[60:63], v[180:183]
v_mfma_f32_16x16x32_bf16 v[184:187], a[184:187], v[60:63], v[184:187]
v_mfma_f32_16x16x32_bf16 v[188:191], a[188:191], v[60:63], v[188:191]
s_waitcnt vmcnt(19)
v_mfma_f32_16x16x32_bf16 v[128:131], a[192:195], v[64:67], v[128:131]
v_mfma_f32_16x16x32_bf16 v[132:135], a[196:199], v[64:67], v[132:135]
v_mfma_f32_16x16x32_bf16 v[136:139], a[200:203], v[64:67], v[136:139]
v_mfma_f32_16x16x32_bf16 v[140:143], a[204:207], v[64:67], v[140:143]
s_waitcnt vmcnt(18)
v_mfma_f32_16x16x32_bf16 v[144:147], a[192:195], v[68:71], v[144:147]
v_mfma_f32_16x16x32_bf16 v[148:151], a[196:199], v[68:71], v[148:151]
v_mfma_f32_16x16x32_bf16 v[152:155], a[200:203], v[68:71], v[152:155]
v_mfma_f32_16x16x32_bf16 v[156:159], a[204:207], v[68:71], v[156:159]
s_waitcnt vmcnt(17)
v_mfma_f32_16x16x32_bf16 v[160:163], a[192:195], v[72:75], v[160:163]
v_mfma_f32_16x16x32_bf16 v[164:167], a[196:199], v[72:75], v[164:167]
v_mfma_f32_16x16x32_bf16 v[168:171], a[200:203], v[72:75], v[168:171]
v_mfma_f32_16x16x32_bf16 v[172:175], a[204:207], v[72:75], v[172:175]
s_waitcnt vmcnt(16)
v_mfma_f32_16x16x32_bf16 v[176:179], a[192:195], v[76:79], v[176:179]
v_mfma_f32_16x16x32_bf16 v[180:183], a[196:199], v[76:79], v[180:183]
v_mfma_f32_16x16x32_bf16 v[184:187], a[200:203], v[76:79], v[184:187]
v_mfma_f32_16x16x32_bf16 v[188:191], a[204:207], v[76:79], v[188:191]
s_waitcnt vmcnt(15)
v_mfma_f32_16x16x32_bf16 v[128:131], a[208:211], v[80:83], v[128:131]
v_mfma_f32_16x16x32_bf16 v[132:135], a[212:215], v[80:83], v[132:135]
v_mfma_f32_16x16x32_bf16 v[136:139], a[216:219], v[80:83], v[136:139]
v_mfma_f32_16x16x32_bf16 v[140:143], a[220:223], v[80:83], v[140:143]
s_waitcnt vmcnt(14)
v_mfma_f32_16x16x32_bf16 v[144:147], a[208:211], v[84:87], v[144:147]
v_mfma_f32_16x16x32_bf16 v[148:151], a[212:215], v[84:87], v[148:151]
v_mfma_f32_16x16x32_bf16 v[152:155], a[216:219], v[84:87], v[152:155]
v_mfma_f32_16x16x32_bf16 v[156:159], a[220:223], v[84:87], v[156:159]
s_waitcnt vmcnt(13)
v_mfma_f32_16x16x32_bf16 v[160:163], a[208:211], v[88:91], v[160:163]
v_mfma_f32_16x16x32_bf16 v[164:167], a[212:215], v[88:91], v[164:167]
v_mfma_f32_16x16x32_bf16 v[168:171], a[216:219], v[88:91], v[168:171]
v_mfma_f32_16x16x32_bf16 v[172:175], a[220:223], v[88:91], v[172:175]
s_waitcnt vmcnt(12)
v_mfma_f32_16x16x32_bf16 v[176:179], a[208:211], v[92:95], v[176:179]
v_mfma_f32_16x16x32_bf16 v[180:183], a[212:215], v[92:95], v[180:183]
v_mfma_f32_16x16x32_bf16 v[184:187], a[216:219], v[92:95], v[184:187]
v_mfma_f32_16x16x32_bf16 v[188:191], a[220:223], v[92:95], v[188:191]
v_cvt_pk_bf16_f32 v144, v144, v145
v_cvt_pk_bf16_f32 v145, v146, v147
v_cvt_pk_bf16_f32 v146, v148, v149
v_cvt_pk_bf16_f32 v147, v150, v151
ds_write_b128 v225, v[144:147] offset:0
s_add_u32 m0, s95, 49152
s_add_u32 s47, s94, 590848
buffer_load_dwordx4 v232, s[12:15], s47 offen offset:0 lds
v_cvt_pk_bf16_f32 v152, v152, v153
v_cvt_pk_bf16_f32 v153, v154, v155
v_cvt_pk_bf16_f32 v154, v156, v157
v_cvt_pk_bf16_f32 v155, v158, v159
ds_write_b128 v225, v[152:155] offset:1024
buffer_load_dwordx4 v233, s[12:15], s47 offen offset:1024 lds
v_cvt_pk_bf16_f32 v160, v160, v161
v_cvt_pk_bf16_f32 v161, v162, v163
v_cvt_pk_bf16_f32 v162, v164, v165
v_cvt_pk_bf16_f32 v163, v166, v167
ds_write_b128 v226, v[160:163] offset:0
buffer_load_dwordx4 v234, s[12:15], s47 offen offset:2048 lds
v_cvt_pk_bf16_f32 v168, v168, v169
v_cvt_pk_bf16_f32 v169, v170, v171
v_cvt_pk_bf16_f32 v170, v172, v173
v_cvt_pk_bf16_f32 v171, v174, v175
ds_write_b128 v226, v[168:171] offset:1024
buffer_load_dwordx4 v235, s[12:15], s47 offen offset:3072 lds
v_cvt_pk_bf16_f32 v176, v176, v177
v_cvt_pk_bf16_f32 v177, v178, v179
v_cvt_pk_bf16_f32 v178, v180, v181
v_cvt_pk_bf16_f32 v179, v182, v183
ds_write_b128 v227, v[176:179] offset:0
s_add_u32 m0, s95, 65536
s_add_u32 s47, s94, 787456
buffer_load_dwordx4 v232, s[12:15], s47 offen offset:0 lds
v_cvt_pk_bf16_f32 v184, v184, v185
v_cvt_pk_bf16_f32 v185, v186, v187
v_cvt_pk_bf16_f32 v186, v188, v189
v_cvt_pk_bf16_f32 v187, v190, v191
ds_write_b128 v227, v[184:187] offset:1024
buffer_load_dwordx4 v233, s[12:15], s47 offen offset:1024 lds
s_lshl_b32 s54, s49, 2
s_add_u32 s54, s54, s48
s_mul_i32 s92, s54, 16384
s_lshl_b32 s56, s50, 11
s_add_u32 s92, s92, s56
buffer_load_dwordx4 v234, s[12:15], s47 offen offset:2048 lds
s_add_u32 s92, s92, 5242880
s_lshl_b32 s54, s54, 10
s_lshr_b32 s55, s50, 1
s_lshl_b32 s55, s55, 8
s_add_u32 s54, s54, s55
buffer_load_dwordx4 v235, s[12:15], s47 offen offset:3072 lds
s_and_b32 s55, s50, 1
s_lshl_b32 s55, s55, 3
s_add_u32 s54, s54, s55
s_add_u32 s93, s54, 262144
s_mov_b32 s88, 0xaaaaaaaa
s_add_u32 m0, s95, 81920
s_add_u32 s47, s94, 984064
buffer_load_dwordx4 v232, s[12:15], s47 offen offset:0 lds
s_mov_b32 s89, s88
s_mov_b32 s90, 0xcccccccc
s_mov_b32 s91, s90
v_and_b32 v228, 0xff, v255
s_lshl_b32 s59, s49, 7
buffer_load_dwordx4 v233, s[12:15], s47 offen offset:1024 lds
s_add_u32 s59, s59, 12288
s_lshl_b32 s56, s50, 2
s_add_u32 s56, s56, s48
s_lshl_b32 s56, s56, 2
s_add_u32 s56, s56, s59
buffer_load_dwordx4 v234, s[12:15], s47 offen offset:2048 lds
s_waitcnt lgkmcnt(0)
s_barrier
ds_read_b128 v[144:147], v224 offset:0
ds_read_b128 v[148:151], v224 offset:1024
ds_read_b128 v[152:155], v224 offset:2048
buffer_load_dwordx4 v235, s[12:15], s47 offen offset:3072 lds
ds_read_b128 v[156:159], v224 offset:3072
ds_read_b128 v[160:163], v224 offset:4096
ds_read_b128 v[164:167], v224 offset:5120
s_waitcnt lgkmcnt(5)
v_mfma_f32_16x16x16_bf16 v[128:131], v[222:223], v[144:145], v[128:131]
v_mfma_f32_16x16x16_bf16 v[132:135], v[222:223], v[146:147], v[132:135]
s_waitcnt lgkmcnt(4)
v_mfma_f32_16x16x16_bf16 v[136:139], v[222:223], v[148:149], v[136:139]
v_mfma_f32_16x16x16_bf16 v[140:143], v[222:223], v[150:151], v[140:143]
s_waitcnt lgkmcnt(3)
v_mfma_f32_16x16x16_bf16 v[128:131], v[222:223], v[152:153], v[128:131]
v_mfma_f32_16x16x16_bf16 v[132:135], v[222:223], v[154:155], v[132:135]
s_waitcnt lgkmcnt(2)
v_mfma_f32_16x16x16_bf16 v[136:139], v[222:223], v[156:157], v[136:139]
v_mfma_f32_16x16x16_bf16 v[140:143], v[222:223], v[158:159], v[140:143]
s_waitcnt lgkmcnt(1)
v_mfma_f32_16x16x16_bf16 v[128:131], v[222:223], v[160:161], v[128:131]
v_mfma_f32_16x16x16_bf16 v[132:135], v[222:223], v[162:163], v[132:135]
s_waitcnt lgkmcnt(0)
v_mfma_f32_16x16x16_bf16 v[136:139], v[222:223], v[164:165], v[136:139]
v_mfma_f32_16x16x16_bf16 v[140:143], v[222:223], v[166:167], v[140:143]
s_nop 3
v_cvt_pk_bf16_f32 v244, v128, v129
v_cvt_pk_bf16_f32 v245, v130, v131
v_cvt_pk_bf16_f32 v246, v132, v133
v_cvt_pk_bf16_f32 v247, v134, v135
buffer_store_dwordx4 v[244:247], v255, s[28:31], s92 offen offset:0
s_nop 0
v_mfma_f32_16x16x32_bf16 v[180:183], v[244:247], v[244:247], 0
v_mfma_f32_16x16x32_bf16 v[176:179], a[236:239], v[244:247], 0
v_cvt_pk_bf16_f32 v248, v136, v137
v_cvt_pk_bf16_f32 v249, v138, v139
v_cvt_pk_bf16_f32 v250, v140, v141
v_cvt_pk_bf16_f32 v251, v142, v143
buffer_store_dwordx4 v[248:251], v255, s[28:31], s92 offen offset:1024
s_nop 0
v_mfma_f32_16x16x32_bf16 v[180:183], v[248:251], v[248:251], v[180:183]
v_mfma_f32_16x16x32_bf16 v[176:179], a[236:239], v[248:251], v[176:179]
s_nop 6
v_cndmask_b32_e64 v180, v180, v181, s[88:89]
v_cndmask_b32_e64 v182, v182, v183, s[88:89]
v_cndmask_b32_e64 v177, v180, v182, s[90:91]
s_mov_b32 exec_lo, 0x00f0000f
s_mov_b32 exec_hi, 0xf0000f00
buffer_store_dwordx2 v[176:177], v228, s[28:31], s93 offen
s_mov_b64 exec, -1
s_waitcnt vmcnt(0)
s_mov_b64 exec, 1
v_mov_b32 v243, 1
s_cmp_lg_u32 s46, 0
s_cbranch_scc1 SG23
buffer_store_dword v243, off, s[28:31], s56
s_branch SG22
SG23:
buffer_wbl2 sc1
s_waitcnt vmcnt(0)
buffer_store_dword v243, off, s[28:31], s56 sc1
SG22:
s_mov_b64 exec, -1
s_add_u32 m0, s95, 98304
s_add_u32 s47, s94, 1180672
buffer_load_dwordx4 v232, s[12:15], s47 offen offset:0 lds
buffer_load_dwordx4 v233, s[12:15], s47 offen offset:1024 lds
buffer_load_dwordx4 v234, s[12:15], s47 offen offset:2048 lds
buffer_load_dwordx4 v235, s[12:15], s47 offen offset:3072 lds
s_add_u32 m0, s95, 114688
s_add_u32 s47, s94, 1377280
buffer_load_dwordx4 v232, s[12:15], s47 offen offset:0 lds
buffer_load_dwordx4 v233, s[12:15], s47 offen offset:1024 lds
buffer_load_dwordx4 v234, s[12:15], s47 offen offset:2048 lds
buffer_load_dwordx4 v235, s[12:15], s47 offen offset:3072 lds
s_and_b32 s54, s48, 1
s_lshl_b32 s54, s54, 1
s_lshl_b32 s55, s49, 2
s_add_u32 s56, s54, s55
s_lshl_b32 s63, s56, 10
s_add_u32 s63, s63, 262144
s_mul_i32 s62, s56, 16384
s_add_u32 s62, s62, 5242880
v_add_u32 v240, 16384, v255
s_lshl_b32 s54, s54, 2
s_add_u32 s54, s54, s59
v_bfe_u32 v231, v255, 5, 3
v_lshlrev_b32 v231, 4, v231
v_bfe_u32 v230, v255, 4, 1
v_lshl_add_u32 v231, v230, 2, v231
s_mov_b32 s57, 100000
PL24:
buffer_load_dword v230, v231, s[28:31], s54 offen sc1
s_waitcnt vmcnt(0)
v_cmp_ne_u32 vcc, 1, v230
s_sub_u32 s57, s57, 1
s_nop 3
s_cbranch_vccz PL25
s_cmp_lg_u32 s57, 0
s_cbranch_scc1 PL24
PL25:
s_lshr_b32 s54, s48, 1
s_lshl_b32 s54, s54, 6
v_xor_b32 v224, s54, v254
v_xor_b32 v225, 32, v224
v_add_u32 v226, 65536, v224
v_add_u32 v227, 65536, v225
v_add_u32 v228, 131072, v224
v_add_u32 v229, 131072, v225
buffer_load_dwordx4 v[0:3], v255, s[28:31], s62 offen offset:0 sc1
buffer_load_dwordx4 v[64:67], v240, s[28:31], s62 offen offset:0 sc1
buffer_load_dwordx4 v[4:7], v255, s[28:31], s62 offen offset:1024 sc1
buffer_load_dwordx4 v[68:71], v240, s[28:31], s62 offen offset:1024 sc1
buffer_load_dwordx4 v[8:11], v255, s[28:31], s62 offen offset:2048 sc1
buffer_load_dwordx4 v[72:75], v240, s[28:31], s62 offen offset:2048 sc1
buffer_load_dwordx4 v[12:15], v255, s[28:31], s62 offen offset:3072 sc1
buffer_load_dwordx4 v[76:79], v240, s[28:31], s62 offen offset:3072 sc1
s_add_u32 s62, s62, 4096
buffer_load_dwordx4 v[16:19], v255, s[28:31], s62 offen offset:0 sc1
buffer_load_dwordx4 v[80:83], v240, s[28:31], s62 offen offset:0 sc1
buffer_load_dwordx4 v[160:163], v255, s[28:31], s63 offen offset:0 sc1
buffer_load_dwordx4 v[164:167], v255, s[28:31], s63 offen offset:1024 sc1
s_lshl_b32 s58, s50, 7
v_mul_u32_u24 v232, 3072, v253
v_add_u32 v232, v232, v252
v_add_u32 v233, 23552, v232
v_add_u32 v234, 47104, v232
v_add_u32 v235, 70656, v232
s_mul_i32 s94, s48, 98304
s_add_u32 s94, s94, s58
s_lshl_b32 s95, s48, 12
s_mul_i32 s92, s48, 24576
s_add_u32 s92, s92, s58
s_add_u32 s92, s92, 1474560
s_lshl_b32 s93, s48, 10
s_add_u32 s93, s93, 32768
s_cmp_lt_u32 s48, 3
s_cselect_b32 s88, 393216, 0
s_cselect_b32 s89, 16384, 0
s_add_u32 s88, s88, s94
s_add_u32 s89, s89, s95
s_barrier
ds_read_b64_tr_b16 v[192:193], v224 offset:0
ds_read_b64_tr_b16 v[194:195], v224 offset:2048
ds_read_b64_tr_b16 v[196:197], v225 offset:0
ds_read_b64_tr_b16 v[198:199], v225 offset:2048
ds_read_b64_tr_b16 v[200:201], v224 offset:4096
ds_read_b64_tr_b16 v[202:203], v224 offset:6144
ds_read_b64_tr_b16 v[204:205], v225 offset:4096
ds_read_b64_tr_b16 v[206:207], v225 offset:6144
ds_read_b64_tr_b16 v[208:209], v224 offset:8192
ds_read_b64_tr_b16 v[210:211], v224 offset:10240
ds_read_b64_tr_b16 v[212:213], v225 offset:8192
ds_read_b64_tr_b16 v[214:215], v225 offset:10240
s_waitcnt vmcnt(10)
s_waitcnt lgkmcnt(10)
v_mfma_f32_16x16x32_bf16 v[128:131], v[0:3], v[192:195], 0
ds_read_b64_tr_b16 v[216:217], v224 offset:12288
v_mfma_f32_16x16x32_bf16 v[144:147], v[64:67], v[192:195], 0
ds_read_b64_tr_b16 v[218:219], v224 offset:14336
s_waitcnt lgkmcnt(10)
v_mfma_f32_16x16x32_bf16 v[132:135], v[0:3], v[196:199], 0
ds_read_b64_tr_b16 v[220:221], v225 offset:12288
buffer_load_dwordx4 v[20:23], v255, s[28:31], s62 offen offset:1024 sc1
v_mfma_f32_16x16x32_bf16 v[148:151], v[64:67], v[196:199], 0
ds_read_b64_tr_b16 v[222:223], v225 offset:14336
s_waitcnt lgkmcnt(10)
v_mfma_f32_16x16x32_bf16 v[136:139], v[0:3], v[200:203], 0
ds_read_b64_tr_b16 v[192:193], v224 offset:16384
v_mfma_f32_16x16x32_bf16 v[152:155], v[64:67], v[200:203], 0
ds_read_b64_tr_b16 v[194:195], v224 offset:18432
s_waitcnt lgkmcnt(10)
v_mfma_f32_16x16x32_bf16 v[140:143], v[0:3], v[204:207], 0
ds_read_b64_tr_b16 v[196:197], v225 offset:16384
buffer_load_dwordx4 v[84:87], v240, s[28:31], s62 offen offset:1024 sc1
v_mfma_f32_16x16x32_bf16 v[156:159], v[64:67], v[204:207], 0
ds_read_b64_tr_b16 v[198:199], v225 offset:18432
s_waitcnt vmcnt(10)
s_waitcnt lgkmcnt(10)
v_mfma_f32_16x16x32_bf16 v[128:131], v[4:7], v[208:211], v[128:131]
ds_read_b64_tr_b16 v[200:201], v224 offset:20480
v_mfma_f32_16x16x32_bf16 v[144:147], v[68:71], v[208:211], v[144:147]
ds_read_b64_tr_b16 v[202:203], v224 offset:22528
s_waitcnt lgkmcnt(10)
v_mfma_f32_16x16x32_bf16 v[132:135], v[4:7], v[212:215], v[132:135]
ds_read_b64_tr_b16 v[204:205], v225 offset:20480
buffer_load_dwordx4 v[24:27], v255, s[28:31], s62 offen offset:2048 sc1
v_mfma_f32_16x16x32_bf16 v[148:151], v[68:71], v[212:215], v[148:151]
ds_read_b64_tr_b16 v[206:207], v225 offset:22528
s_waitcnt lgkmcnt(10)
v_mfma_f32_16x16x32_bf16 v[136:139], v[4:7], v[216:219], v[136:139]
ds_read_b64_tr_b16 v[208:209], v224 offset:24576
v_mfma_f32_16x16x32_bf16 v[152:155], v[68:71], v[216:219], v[152:155]
ds_read_b64_tr_b16 v[210:211], v224 offset:26624
s_waitcnt lgkmcnt(10)
v_mfma_f32_16x16x32_bf16 v[140:143], v[4:7], v[220:223], v[140:143]
ds_read_b64_tr_b16 v[212:213], v225 offset:24576
buffer_load_dwordx4 v[88:91], v240, s[28:31], s62 offen offset:2048 sc1
v_mfma_f32_16x16x32_bf16 v[156:159], v[68:71], v[220:223], v[156:159]
ds_read_b64_tr_b16 v[214:215], v225 offset:26624
s_waitcnt vmcnt(10)
s_waitcnt lgkmcnt(10)
v_mfma_f32_16x16x32_bf16 v[128:131], v[8:11], v[192:195], v[128:131]
ds_read_b64_tr_b16 v[216:217], v224 offset:28672
v_mfma_f32_16x16x32_bf16 v[144:147], v[72:75], v[192:195], v[144:147]
ds_read_b64_tr_b16 v[218:219], v224 offset:30720
s_waitcnt lgkmcnt(10)
v_mfma_f32_16x16x32_bf16 v[132:135], v[8:11], v[196:199], v[132:135]
ds_read_b64_tr_b16 v[220:221], v225 offset:28672
buffer_load_dwordx4 v[28:31], v255, s[28:31], s62 offen offset:3072 sc1
v_mfma_f32_16x16x32_bf16 v[148:151], v[72:75], v[196:199], v[148:151]
ds_read_b64_tr_b16 v[222:223], v225 offset:30720
s_waitcnt lgkmcnt(10)
v_mfma_f32_16x16x32_bf16 v[136:139], v[8:11], v[200:203], v[136:139]
ds_read_b64_tr_b16 v[192:193], v224 offset:32768
v_mfma_f32_16x16x32_bf16 v[152:155], v[72:75], v[200:203], v[152:155]
ds_read_b64_tr_b16 v[194:195], v224 offset:34816
s_waitcnt lgkmcnt(10)
v_mfma_f32_16x16x32_bf16 v[140:143], v[8:11], v[204:207], v[140:143]
ds_read_b64_tr_b16 v[196:197], v225 offset:32768
buffer_load_dwordx4 v[92:95], v240, s[28:31], s62 offen offset:3072 sc1
v_mfma_f32_16x16x32_bf16 v[156:159], v[72:75], v[204:207], v[156:159]
ds_read_b64_tr_b16 v[198:199], v225 offset:34816
s_waitcnt vmcnt(10)
s_waitcnt lgkmcnt(10)
v_mfma_f32_16x16x32_bf16 v[128:131], v[12:15], v[208:211], v[128:131]
ds_read_b64_tr_b16 v[200:201], v224 offset:36864
v_mfma_f32_16x16x32_bf16 v[144:147], v[76:79], v[208:211], v[144:147]
ds_read_b64_tr_b16 v[202:203], v224 offset:38912
s_waitcnt lgkmcnt(10)
v_mfma_f32_16x16x32_bf16 v[132:135], v[12:15], v[212:215], v[132:135]
ds_read_b64_tr_b16 v[204:205], v225 offset:36864
s_add_u32 s62, s62, 4096
v_mfma_f32_16x16x32_bf16 v[148:151], v[76:79], v[212:215], v[148:151]
ds_read_b64_tr_b16 v[206:207], v225 offset:38912
s_waitcnt lgkmcnt(10)
v_mfma_f32_16x16x32_bf16 v[136:139], v[12:15], v[216:219], v[136:139]
ds_read_b64_tr_b16 v[208:209], v224 offset:40960
buffer_load_dwordx4 v[32:35], v255, s[28:31], s62 offen offset:0 sc1
v_mfma_f32_16x16x32_bf16 v[152:155], v[76:79], v[216:219], v[152:155]
ds_read_b64_tr_b16 v[210:211], v224 offset:43008
s_waitcnt lgkmcnt(10)
v_mfma_f32_16x16x32_bf16 v[140:143], v[12:15], v[220:223], v[140:143]
ds_read_b64_tr_b16 v[212:213], v225 offset:40960
buffer_load_dwordx4 v[96:99], v240, s[28:31], s62 offen offset:0 sc1
v_mfma_f32_16x16x32_bf16 v[156:159], v[76:79], v[220:223], v[156:159]
ds_read_b64_tr_b16 v[214:215], v225 offset:43008
s_waitcnt vmcnt(10)
s_waitcnt lgkmcnt(10)
v_mfma_f32_16x16x32_bf16 v[128:131], v[16:19], v[192:195], v[128:131]
ds_read_b64_tr_b16 v[216:217], v224 offset:45056
v_mfma_f32_16x16x32_bf16 v[144:147], v[80:83], v[192:195], v[144:147]
ds_read_b64_tr_b16 v[218:219], v224 offset:47104
s_waitcnt lgkmcnt(10)
v_mfma_f32_16x16x32_bf16 v[132:135], v[16:19], v[196:199], v[132:135]
ds_read_b64_tr_b16 v[220:221], v225 offset:45056
buffer_load_dwordx4 v[36:39], v255, s[28:31], s62 offen offset:1024 sc1
v_mfma_f32_16x16x32_bf16 v[148:151], v[80:83], v[196:199], v[148:151]
ds_read_b64_tr_b16 v[222:223], v225 offset:47104
s_waitcnt lgkmcnt(10)
v_mfma_f32_16x16x32_bf16 v[136:139], v[16:19], v[200:203], v[136:139]
ds_read_b64_tr_b16 v[192:193], v224 offset:49152
v_mfma_f32_16x16x32_bf16 v[152:155], v[80:83], v[200:203], v[152:155]
ds_read_b64_tr_b16 v[194:195], v224 offset:51200
s_waitcnt lgkmcnt(10)
v_mfma_f32_16x16x32_bf16 v[140:143], v[16:19], v[204:207], v[140:143]
ds_read_b64_tr_b16 v[196:197], v225 offset:49152
buffer_load_dwordx4 v[100:103], v240, s[28:31], s62 offen offset:1024 sc1
v_mfma_f32_16x16x32_bf16 v[156:159], v[80:83], v[204:207], v[156:159]
ds_read_b64_tr_b16 v[198:199], v225 offset:51200
s_waitcnt vmcnt(8)
s_waitcnt lgkmcnt(10)
v_mfma_f32_16x16x32_bf16 v[128:131], v[20:23], v[208:211], v[128:131]
ds_read_b64_tr_b16 v[200:201], v224 offset:53248
v_mfma_f32_16x16x32_bf16 v[144:147], v[84:87], v[208:211], v[144:147]
ds_read_b64_tr_b16 v[202:203], v224 offset:55296
s_waitcnt lgkmcnt(10)
v_mfma_f32_16x16x32_bf16 v[132:135], v[20:23], v[212:215], v[132:135]
ds_read_b64_tr_b16 v[204:205], v225 offset:53248
buffer_load_dwordx4 v[40:43], v255, s[28:31], s62 offen offset:2048 sc1
v_mfma_f32_16x16x32_bf16 v[148:151], v[84:87], v[212:215], v[148:151]
ds_read_b64_tr_b16 v[206:207], v225 offset:55296
s_waitcnt lgkmcnt(10)
v_mfma_f32_16x16x32_bf16 v[136:139], v[20:23], v[216:219], v[136:139]
ds_read_b64_tr_b16 v[208:209], v224 offset:57344
v_mfma_f32_16x16x32_bf16 v[152:155], v[84:87], v[216:219], v[152:155]
ds_read_b64_tr_b16 v[210:211], v224 offset:59392
s_waitcnt lgkmcnt(10)
v_mfma_f32_16x16x32_bf16 v[140:143], v[20:23], v[220:223], v[140:143]
ds_read_b64_tr_b16 v[212:213], v225 offset:57344
buffer_load_dwordx4 v[104:107], v240, s[28:31], s62 offen offset:2048 sc1
v_mfma_f32_16x16x32_bf16 v[156:159], v[84:87], v[220:223], v[156:159]
ds_read_b64_tr_b16 v[214:215], v225 offset:59392
s_waitcnt vmcnt(8)
s_waitcnt lgkmcnt(10)
v_mfma_f32_16x16x32_bf16 v[128:131], v[24:27], v[192:195], v[128:131]
ds_read_b64_tr_b16 v[216:217], v224 offset:61440
v_mfma_f32_16x16x32_bf16 v[144:147], v[88:91], v[192:195], v[144:147]
ds_read_b64_tr_b16 v[218:219], v224 offset:63488
s_waitcnt lgkmcnt(10)
v_mfma_f32_16x16x32_bf16 v[132:135], v[24:27], v[196:199], v[132:135]
ds_read_b64_tr_b16 v[220:221], v225 offset:61440
buffer_load_dwordx4 v[44:47], v255, s[28:31], s62 offen offset:3072 sc1
v_mfma_f32_16x16x32_bf16 v[148:151], v[88:91], v[196:199], v[148:151]
ds_read_b64_tr_b16 v[222:223], v225 offset:63488
s_waitcnt lgkmcnt(10)
v_mfma_f32_16x16x32_bf16 v[136:139], v[24:27], v[200:203], v[136:139]
ds_read_b64_tr_b16 v[192:193], v226 offset:0
v_mfma_f32_16x16x32_bf16 v[152:155], v[88:91], v[200:203], v[152:155]
ds_read_b64_tr_b16 v[194:195], v226 offset:2048
s_waitcnt lgkmcnt(10)
v_mfma_f32_16x16x32_bf16 v[140:143], v[24:27], v[204:207], v[140:143]
ds_read_b64_tr_b16 v[196:197], v227 offset:0
buffer_load_dwordx4 v[108:111], v240, s[28:31], s62 offen offset:3072 sc1
v_mfma_f32_16x16x32_bf16 v[156:159], v[88:91], v[204:207], v[156:159]
ds_read_b64_tr_b16 v[198:199], v227 offset:2048
s_waitcnt vmcnt(8)
s_waitcnt lgkmcnt(10)
v_mfma_f32_16x16x32_bf16 v[128:131], v[28:31], v[208:211], v[128:131]
ds_read_b64_tr_b16 v[200:201], v226 offset:4096
v_add_f32 v236, v160, v162
v_add_f32 v237, v161, v163
v_mfma_f32_16x16x32_bf16 v[144:147], v[92:95], v[208:211], v[144:147]
ds_read_b64_tr_b16 v[202:203], v226 offset:6144
v_add_f32 v238, v164, v166
s_waitcnt lgkmcnt(10)
v_mfma_f32_16x16x32_bf16 v[132:135], v[28:31], v[212:215], v[132:135]
ds_read_b64_tr_b16 v[204:205], v227 offset:4096
s_add_u32 s62, s62, 4096
v_add_f32 v239, v165, v167
v_mov_b32 v168, v236
v_mfma_f32_16x16x32_bf16 v[148:151], v[92:95], v[212:215], v[148:151]
ds_read_b64_tr_b16 v[206:207], v227 offset:6144
v_mov_b32 v169, v237
v_mov_b32 v170, v238
s_waitcnt lgkmcnt(10)
v_mfma_f32_16x16x32_bf16 v[136:139], v[28:31], v[216:219], v[136:139]
ds_read_b64_tr_b16 v[208:209], v226 offset:8192
buffer_load_dwordx4 v[48:51], v255, s[28:31], s62 offen offset:0 sc1
v_mov_b32 v171, v239
v_mfma_f32_16x16x32_bf16 v[152:155], v[92:95], v[216:219], v[152:155]
ds_read_b64_tr_b16 v[210:211], v226 offset:10240
v_permlane16_swap_b32 v168, v236
v_permlane16_swap_b32 v169, v237
s_waitcnt lgkmcnt(10)
v_mfma_f32_16x16x32_bf16 v[140:143], v[28:31], v[220:223], v[140:143]
ds_read_b64_tr_b16 v[212:213], v227 offset:8192
buffer_load_dwordx4 v[112:115], v240, s[28:31], s62 offen offset:0 sc1
v_permlane16_swap_b32 v170, v238
v_permlane16_swap_b32 v171, v239
v_mfma_f32_16x16x32_bf16 v[156:159], v[92:95], v[220:223], v[156:159]
ds_read_b64_tr_b16 v[214:215], v227 offset:10240
v_add_f32 v236, v236, v168
v_add_f32 v237, v237, v169
s_waitcnt vmcnt(8)
s_waitcnt lgkmcnt(10)
v_mfma_f32_16x16x32_bf16 v[128:131], v[32:35], v[192:195], v[128:131]
ds_read_b64_tr_b16 v[216:217], v226 offset:12288
v_add_f32 v238, v238, v170
v_add_f32 v239, v239, v171
v_mfma_f32_16x16x32_bf16 v[144:147], v[96:99], v[192:195], v[144:147]
ds_read_b64_tr_b16 v[218:219], v226 offset:14336
v_mov_b32 v168, v236
v_mov_b32 v169, v237
s_waitcnt lgkmcnt(10)
v_mfma_f32_16x16x32_bf16 v[132:135], v[32:35], v[196:199], v[132:135]
ds_read_b64_tr_b16 v[220:221], v227 offset:12288
buffer_load_dwordx4 v[52:55], v255, s[28:31], s62 offen offset:1024 sc1
v_mov_b32 v170, v238
v_mfma_f32_16x16x32_bf16 v[148:151], v[96:99], v[196:199], v[148:151]
ds_read_b64_tr_b16 v[222:223], v227 offset:14336
v_mov_b32 v171, v239
v_permlane32_swap_b32 v168, v236
s_waitcnt lgkmcnt(10)
v_mfma_f32_16x16x32_bf16 v[136:139], v[32:35], v[200:203], v[136:139]
ds_read_b64_tr_b16 v[192:193], v226 offset:16384
v_permlane32_swap_b32 v169, v237
v_permlane32_swap_b32 v170, v238
v_permlane32_swap_b32 v171, v239
v_mfma_f32_16x16x32_bf16 v[152:155], v[96:99], v[200:203], v[152:155]
ds_read_b64_tr_b16 v[194:195], v226 offset:18432
v_add_f32 v236, v236, v168
s_add_u32 m0, s95, 131072
s_waitcnt lgkmcnt(10)
v_mfma_f32_16x16x32_bf16 v[140:143], v[32:35], v[204:207], v[140:143]
ds_read_b64_tr_b16 v[196:197], v227 offset:16384
buffer_load_dwordx4 v[116:119], v240, s[28:31], s62 offen offset:1024 sc1
v_add_f32 v237, v237, v169
v_add_f32 v238, v238, v170
v_mfma_f32_16x16x32_bf16 v[156:159], v[96:99], v[204:207], v[156:159]
ds_read_b64_tr_b16 v[198:199], v227 offset:18432
v_add_f32 v239, v239, v171
v_mul_f32 v236, 0x3b000000, v236
s_add_u32 s47, s94, 0
s_waitcnt vmcnt(8)
s_waitcnt lgkmcnt(10)
v_mfma_f32_16x16x32_bf16 v[128:131], v[36:39], v[208:211], v[128:131]
ds_read_b64_tr_b16 v[200:201], v226 offset:20480
v_mul_f32 v168, v236, v236
v_fma_f32 v237, v237, s60, -v168
v_mfma_f32_16x16x32_bf16 v[144:147], v[100:103], v[208:211], v[144:147]
ds_read_b64_tr_b16 v[202:203], v226 offset:22528
v_max_f32 v237, 0, v237
buffer_load_dwordx4 v232, s[12:15], s47 offen offset:0 lds
s_waitcnt lgkmcnt(10)
v_mfma_f32_16x16x32_bf16 v[132:135], v[36:39], v[212:215], v[132:135]
ds_read_b64_tr_b16 v[204:205], v227 offset:20480
buffer_load_dwordx4 v[56:59], v255, s[28:31], s62 offen offset:2048 sc1
v_add_f32 v237, 0x3727c5ac, v237
v_rsq_f32 v168, v237
v_mfma_f32_16x16x32_bf16 v[148:151], v[100:103], v[212:215], v[148:151]
ds_read_b64_tr_b16 v[206:207], v227 offset:22528
v_mul_f32 v237, -v236, v168
v_mov_b32 v236, v168
buffer_load_dwordx4 v233, s[12:15], s47 offen offset:1024 lds
s_waitcnt lgkmcnt(10)
v_mfma_f32_16x16x32_bf16 v[136:139], v[36:39], v[216:219], v[136:139]
ds_read_b64_tr_b16 v[208:209], v226 offset:24576
v_mul_f32 v238, 0x3b000000, v238
v_mul_f32 v169, v238, v238
v_mfma_f32_16x16x32_bf16 v[152:155], v[100:103], v[216:219], v[152:155]
ds_read_b64_tr_b16 v[210:211], v226 offset:26624
v_fma_f32 v239, v239, s60, -v169
buffer_load_dwordx4 v234, s[12:15], s47 offen offset:2048 lds
s_waitcnt lgkmcnt(10)
v_mfma_f32_16x16x32_bf16 v[140:143], v[36:39], v[220:223], v[140:143]
ds_read_b64_tr_b16 v[212:213], v227 offset:24576
buffer_load_dwordx4 v[120:123], v240, s[28:31], s62 offen offset:2048 sc1
v_max_f32 v239, 0, v239
v_add_f32 v239, 0x3727c5ac, v239
v_mfma_f32_16x16x32_bf16 v[156:159], v[100:103], v[220:223], v[156:159]
ds_read_b64_tr_b16 v[214:215], v227 offset:26624
v_rsq_f32 v169, v239
s_nop 0
v_mul_f32 v239, -v238, v169
buffer_load_dwordx4 v235, s[12:15], s47 offen offset:3072 lds
s_waitcnt vmcnt(12)
s_waitcnt lgkmcnt(10)
v_mfma_f32_16x16x32_bf16 v[128:131], v[40:43], v[192:195], v[128:131]
ds_read_b64_tr_b16 v[216:217], v226 offset:28672
v_mov_b32 v238, v169
s_lshl_b32 s54, s48, 8
s_add_u32 s54, s54, 162304
v_mfma_f32_16x16x32_bf16 v[144:147], v[104:107], v[192:195], v[144:147]
ds_read_b64_tr_b16 v[218:219], v226 offset:30720
v_bfe_u32 v241, v255, 4, 4
s_add_u32 m0, s89, 131072
s_waitcnt lgkmcnt(10)
v_mfma_f32_16x16x32_bf16 v[132:135], v[40:43], v[196:199], v[132:135]
ds_read_b64_tr_b16 v[220:221], v227 offset:28672
buffer_load_dwordx4 v[60:63], v255, s[28:31], s62 offen offset:3072 sc1
v_lshl_add_u32 v241, v241, 2, s54
ds_write_b32 v241, v236 offset:0
v_mfma_f32_16x16x32_bf16 v[148:151], v[104:107], v[196:199], v[148:151]
ds_read_b64_tr_b16 v[222:223], v227 offset:30720
ds_write_b32 v241, v237 offset:128
s_add_u32 s47, s88, 0
s_waitcnt lgkmcnt(10)
v_mfma_f32_16x16x32_bf16 v[136:139], v[40:43], v[200:203], v[136:139]
ds_read_b64_tr_b16 v[192:193], v226 offset:32768
ds_write_b32 v241, v238 offset:64
ds_write_b32 v241, v239 offset:192
v_lshrrev_b32 v242, 8, v255
v_mfma_f32_16x16x32_bf16 v[152:155], v[104:107], v[200:203], v[152:155]
ds_read_b64_tr_b16 v[194:195], v226 offset:34816
v_lshl_add_u32 v242, v242, 4, s54
buffer_load_dwordx4 v232, s[12:15], s47 offen offset:0 lds
s_waitcnt lgkmcnt(10)
v_mfma_f32_16x16x32_bf16 v[140:143], v[40:43], v[204:207], v[140:143]
ds_read_b64_tr_b16 v[196:197], v227 offset:32768
buffer_load_dwordx4 v[124:127], v240, s[28:31], s62 offen offset:3072 sc1
ds_read_b128 v[176:179], v242 offset:0
ds_read_b128 v[180:183], v242 offset:64
v_mfma_f32_16x16x32_bf16 v[156:159], v[104:107], v[204:207], v[156:159]
ds_read_b64_tr_b16 v[198:199], v227 offset:34816
ds_read_b128 v[184:187], v242 offset:128
ds_read_b128 v[188:191], v242 offset:192
buffer_load_dwordx4 v233, s[12:15], s47 offen offset:1024 lds
s_waitcnt vmcnt(14)
s_barrier
s_waitcnt lgkmcnt(10)
v_mfma_f32_16x16x32_bf16 v[128:131], v[44:47], v[208:211], v[128:131]
ds_read_b64_tr_b16 v[200:201], v226 offset:36864
buffer_load_dwordx4 v234, s[12:15], s47 offen offset:2048 lds
v_mfma_f32_16x16x32_bf16 v[144:147], v[108:111], v[208:211], v[144:147]
ds_read_b64_tr_b16 v[202:203], v226 offset:38912
s_waitcnt lgkmcnt(10)
v_mfma_f32_16x16x32_bf16 v[132:135], v[44:47], v[212:215], v[132:135]
ds_read_b64_tr_b16 v[204:205], v227 offset:36864
buffer_load_dwordx4 v235, s[12:15], s47 offen offset:3072 lds
v_mfma_f32_16x16x32_bf16 v[148:151], v[108:111], v[212:215], v[148:151]
ds_read_b64_tr_b16 v[206:207], v227 offset:38912
s_waitcnt lgkmcnt(10)
v_mfma_f32_16x16x32_bf16 v[136:139], v[44:47], v[216:219], v[136:139]
ds_read_b64_tr_b16 v[208:209], v226 offset:40960
v_mfma_f32_16x16x32_bf16 v[152:155], v[108:111], v[216:219], v[152:155]
ds_read_b64_tr_b16 v[210:211], v226 offset:43008
s_waitcnt lgkmcnt(10)
v_mfma_f32_16x16x32_bf16 v[140:143], v[44:47], v[220:223], v[140:143]
ds_read_b64_tr_b16 v[212:213], v227 offset:40960
s_add_u32 m0, s95, 0
v_mfma_f32_16x16x32_bf16 v[156:159], v[108:111], v[220:223], v[156:159]
ds_read_b64_tr_b16 v[214:215], v227 offset:43008
s_waitcnt vmcnt(14)
s_waitcnt lgkmcnt(10)
v_mfma_f32_16x16x32_bf16 v[128:131], v[48:51], v[192:195], v[128:131]
ds_read_b64_tr_b16 v[216:217], v226 offset:45056
s_add_u32 s47, s94, 688128
v_mfma_f32_16x16x32_bf16 v[144:147], v[112:115], v[192:195], v[144:147]
ds_read_b64_tr_b16 v[218:219], v226 offset:47104
s_waitcnt lgkmcnt(10)
v_mfma_f32_16x16x32_bf16 v[132:135], v[48:51], v[196:199], v[132:135]
ds_read_b64_tr_b16 v[220:221], v227 offset:45056
buffer_load_dwordx4 v232, s[12:15], s47 offen offset:0 lds
v_mfma_f32_16x16x32_bf16 v[148:151], v[112:115], v[196:199], v[148:151]
ds_read_b64_tr_b16 v[222:223], v227 offset:47104
s_waitcnt lgkmcnt(10)
v_mfma_f32_16x16x32_bf16 v[136:139], v[48:51], v[200:203], v[136:139]
ds_read_b64_tr_b16 v[192:193], v226 offset:49152
buffer_load_dwordx4 v233, s[12:15], s47 offen offset:1024 lds
v_mfma_f32_16x16x32_bf16 v[152:155], v[112:115], v[200:203], v[152:155]
ds_read_b64_tr_b16 v[194:195], v226 offset:51200
s_waitcnt lgkmcnt(10)
v_mfma_f32_16x16x32_bf16 v[140:143], v[48:51], v[204:207], v[140:143]
ds_read_b64_tr_b16 v[196:197], v227 offset:49152
buffer_load_dwordx4 v234, s[12:15], s47 offen offset:2048 lds
v_mfma_f32_16x16x32_bf16 v[156:159], v[112:115], v[204:207], v[156:159]
ds_read_b64_tr_b16 v[198:199], v227 offset:51200
s_waitcnt vmcnt(15)
s_waitcnt lgkmcnt(10)
v_mfma_f32_16x16x32_bf16 v[128:131], v[52:55], v[208:211], v[128:131]
ds_read_b64_tr_b16 v[200:201], v226 offset:53248
buffer_load_dwordx4 v235, s[12:15], s47 offen offset:3072 lds
v_mfma_f32_16x16x32_bf16 v[144:147], v[116:119], v[208:211], v[144:147]
ds_read_b64_tr_b16 v[202:203], v226 offset:55296
s_waitcnt lgkmcnt(10)
v_mfma_f32_16x16x32_bf16 v[132:135], v[52:55], v[212:215], v[132:135]
ds_read_b64_tr_b16 v[204:205], v227 offset:53248
s_add_u32 m0, s95, 16384
v_mfma_f32_16x16x32_bf16 v[148:151], v[116:119], v[212:215], v[148:151]
ds_read_b64_tr_b16 v[206:207], v227 offset:55296
s_waitcnt lgkmcnt(10)
v_mfma_f32_16x16x32_bf16 v[136:139], v[52:55], v[216:219], v[136:139]
ds_read_b64_tr_b16 v[208:209], v226 offset:57344
v_mfma_f32_16x16x32_bf16 v[152:155], v[116:119], v[216:219], v[152:155]
ds_read_b64_tr_b16 v[210:211], v226 offset:59392
s_waitcnt lgkmcnt(10)
v_mfma_f32_16x16x32_bf16 v[140:143], v[52:55], v[220:223], v[140:143]
ds_read_b64_tr_b16 v[212:213], v227 offset:57344
s_add_u32 s47, s94, 1081344
v_mfma_f32_16x16x32_bf16 v[156:159], v[116:119], v[220:223], v[156:159]
ds_read_b64_tr_b16 v[214:215], v227 offset:59392
s_waitcnt vmcnt(11)
s_waitcnt lgkmcnt(10)
v_mfma_f32_16x16x32_bf16 v[128:131], v[56:59], v[192:195], v[128:131]
ds_read_b64_tr_b16 v[216:217], v226 offset:61440
buffer_load_dwordx4 v232, s[12:15], s47 offen offset:0 lds
v_mfma_f32_16x16x32_bf16 v[144:147], v[120:123], v[192:195], v[144:147]
ds_read_b64_tr_b16 v[218:219], v226 offset:63488
s_waitcnt lgkmcnt(10)
v_mfma_f32_16x16x32_bf16 v[132:135], v[56:59], v[196:199], v[132:135]
ds_read_b64_tr_b16 v[220:221], v227 offset:61440
buffer_load_dwordx4 v233, s[12:15], s47 offen offset:1024 lds
v_mfma_f32_16x16x32_bf16 v[148:151], v[120:123], v[196:199], v[148:151]
ds_read_b64_tr_b16 v[222:223], v227 offset:63488
s_waitcnt lgkmcnt(10)
v_mfma_f32_16x16x32_bf16 v[136:139], v[56:59], v[200:203], v[136:139]
buffer_load_dwordx4 v234, s[12:15], s47 offen offset:2048 lds
v_mfma_f32_16x16x32_bf16 v[152:155], v[120:123], v[200:203], v[152:155]
s_waitcnt lgkmcnt(8)
v_mfma_f32_16x16x32_bf16 v[140:143], v[56:59], v[204:207], v[140:143]
buffer_load_dwordx4 v235, s[12:15], s47 offen offset:3072 lds
v_mfma_f32_16x16x32_bf16 v[156:159], v[120:123], v[204:207], v[156:159]
s_waitcnt vmcnt(11)
s_waitcnt lgkmcnt(6)
v_mfma_f32_16x16x32_bf16 v[128:131], v[60:63], v[208:211], v[128:131]
s_mov_b32 m0, s93
v_mfma_f32_16x16x32_bf16 v[144:147], v[124:127], v[208:211], v[144:147]
s_waitcnt lgkmcnt(4)
v_mfma_f32_16x16x32_bf16 v[132:135], v[60:63], v[212:215], v[132:135]
s_nop 0
v_mfma_f32_16x16x32_bf16 v[148:151], v[124:127], v[212:215], v[148:151]
s_waitcnt lgkmcnt(2)
v_mfma_f32_16x16x32_bf16 v[136:139], v[60:63], v[216:219], v[136:139]
buffer_load_dwordx4 v232, s[12:15], s92 offen lds
v_mfma_f32_16x16x32_bf16 v[152:155], v[124:127], v[216:219], v[152:155]
s_waitcnt lgkmcnt(0)
v_mfma_f32_16x16x32_bf16 v[140:143], v[60:63], v[220:223], v[140:143]
v_mfma_f32_16x16x32_bf16 v[156:159], v[124:127], v[220:223], v[156:159]
s_barrier
v_mul_u32_u24 v232, 1024, v253
v_add_u32 v232, v232, v252
v_add_u32 v233, 7168, v232
v_add_u32 v234, 14336, v232
v_add_u32 v235, 21504, v232
s_lshl_b32 s62, s48, 17
s_lshl_b32 s54, s50, 7
s_add_u32 s62, s62, s54
s_lshl_b32 s63, s48, 14
v_mov_b32 v192, 0x3fb8aa3b
v_mov_b32 v193, 0xb5c1a2a0
s_mov_b32 s61, 0x358637bd
v_mov_b32 v194, s61
v_mov_b32 v195, 0
v_accvgpr_read_b32 v196, a224
v_accvgpr_read_b32 v197, a225
v_accvgpr_read_b32 v198, a226
v_accvgpr_read_b32 v199, a227
v_pk_fma_f32 v[216:217], v[184:185], v[196:197], v[194:195] op_sel:[0,0,0] op_sel_hi:[1,0,0]
v_pk_fma_f32 v[218:219], v[186:187], v[196:197], v[194:195] op_sel:[0,0,0] op_sel_hi:[1,0,0]
v_pk_fma_f32 v[220:221], v[188:189], v[196:197], v[194:195] op_sel:[0,0,0] op_sel_hi:[1,0,0]
v_pk_fma_f32 v[222:223], v[190:191], v[196:197], v[194:195] op_sel:[0,0,0] op_sel_hi:[1,0,0]
v_pk_fma_f32 v[128:129], v[128:129], v[176:177], v[216:217]
v_pk_fma_f32 v[130:131], v[130:131], v[178:179], v[218:219]
v_pk_fma_f32 v[144:145], v[144:145], v[180:181], v[220:221]
v_pk_fma_f32 v[146:147], v[146:147], v[182:183], v[222:223]
v_pk_fma_f32 v[216:217], v[128:129], v[192:193], v[192:193] op_sel:[0,0,1] op_sel_hi:[1,0,1]
v_pk_fma_f32 v[218:219], v[130:131], v[192:193], v[192:193] op_sel:[0,0,1] op_sel_hi:[1,0,1]
v_pk_fma_f32 v[220:221], v[144:145], v[192:193], v[192:193] op_sel:[0,0,1] op_sel_hi:[1,0,1]
s_add_u32 m0, s63, 49152
s_add_u32 s47, s62, 0
buffer_load_dwordx4 v232, s[16:19], s47 offen offset:0 lds
v_pk_fma_f32 v[222:223], v[146:147], v[192:193], v[192:193] op_sel:[0,0,1] op_sel_hi:[1,0,1]
v_exp_f32_e64 v216, v216 clamp
v_exp_f32_e64 v218, v218 clamp
v_exp_f32_e64 v220, v220 clamp
v_exp_f32_e64 v222, v222 clamp
v_exp_f32_e64 v217, v217 clamp
v_exp_f32_e64 v219, v219 clamp
v_exp_f32_e64 v221, v221 clamp
v_exp_f32_e64 v223, v223 clamp
v_max_f32 v128, s61, v128
v_max_f32 v130, s61, v130
v_max_f32 v144, s61, v144
v_max_f32 v146, s61, v146
v_max_f32 v129, s61, v129
v_max_f32 v131, s61, v131
v_max_f32 v145, s61, v145
v_max_f32 v147, s61, v147
v_pk_add_f32 v[128:129], v[128:129], v[216:217]
v_pk_add_f32 v[130:131], v[130:131], v[218:219]
v_pk_add_f32 v[144:145], v[144:145], v[220:221]
buffer_load_dwordx4 v233, s[16:19], s47 offen offset:1024 lds
v_pk_add_f32 v[146:147], v[146:147], v[222:223]
v_cvt_pk_bf16_f32 v200, v128, v129
v_cvt_pk_bf16_f32 v201, v130, v131
v_cvt_pk_bf16_f32 v202, v144, v145
v_cvt_pk_bf16_f32 v203, v146, v147
v_pk_fma_f32 v[216:217], v[184:185], v[196:197], v[194:195] op_sel:[0,1,0] op_sel_hi:[1,1,0]
v_pk_fma_f32 v[218:219], v[186:187], v[196:197], v[194:195] op_sel:[0,1,0] op_sel_hi:[1,1,0]
v_pk_fma_f32 v[220:221], v[188:189], v[196:197], v[194:195] op_sel:[0,1,0] op_sel_hi:[1,1,0]
v_pk_fma_f32 v[222:223], v[190:191], v[196:197], v[194:195] op_sel:[0,1,0] op_sel_hi:[1,1,0]
v_pk_fma_f32 v[132:133], v[132:133], v[176:177], v[216:217]
v_pk_fma_f32 v[134:135], v[134:135], v[178:179], v[218:219]
v_pk_fma_f32 v[148:149], v[148:149], v[180:181], v[220:221]
v_pk_fma_f32 v[150:151], v[150:151], v[182:183], v[222:223]
v_pk_fma_f32 v[216:217], v[132:133], v[192:193], v[192:193] op_sel:[0,0,1] op_sel_hi:[1,0,1]
v_pk_fma_f32 v[218:219], v[134:135], v[192:193], v[192:193] op_sel:[0,0,1] op_sel_hi:[1,0,1]
v_pk_fma_f32 v[220:221], v[148:149], v[192:193], v[192:193] op_sel:[0,0,1] op_sel_hi:[1,0,1]
v_pk_fma_f32 v[222:223], v[150:151], v[192:193], v[192:193] op_sel:[0,0,1] op_sel_hi:[1,0,1]
v_exp_f32_e64 v216, v216 clamp
v_exp_f32_e64 v218, v218 clamp
v_exp_f32_e64 v220, v220 clamp
buffer_load_dwordx4 v234, s[16:19], s47 offen offset:2048 lds
v_exp_f32_e64 v222, v222 clamp
v_exp_f32_e64 v217, v217 clamp
v_exp_f32_e64 v219, v219 clamp
v_exp_f32_e64 v221, v221 clamp
v_exp_f32_e64 v223, v223 clamp
v_max_f32 v132, s61, v132
v_max_f32 v134, s61, v134
v_max_f32 v148, s61, v148
v_max_f32 v150, s61, v150
v_max_f32 v133, s61, v133
v_max_f32 v135, s61, v135
v_max_f32 v149, s61, v149
v_max_f32 v151, s61, v151
v_pk_add_f32 v[132:133], v[132:133], v[216:217]
v_pk_add_f32 v[134:135], v[134:135], v[218:219]
v_pk_add_f32 v[148:149], v[148:149], v[220:221]
v_pk_add_f32 v[150:151], v[150:151], v[222:223]
v_cvt_pk_bf16_f32 v204, v132, v133
v_cvt_pk_bf16_f32 v205, v134, v135
v_cvt_pk_bf16_f32 v206, v148, v149
buffer_load_dwordx4 v235, s[16:19], s47 offen offset:3072 lds
v_cvt_pk_bf16_f32 v207, v150, v151
v_pk_fma_f32 v[216:217], v[184:185], v[198:199], v[194:195] op_sel:[0,0,1] op_sel_hi:[1,0,1]
v_pk_fma_f32 v[218:219], v[186:187], v[198:199], v[194:195] op_sel:[0,0,1] op_sel_hi:[1,0,1]
v_pk_fma_f32 v[220:221], v[188:189], v[198:199], v[194:195] op_sel:[0,0,1] op_sel_hi:[1,0,1]
v_pk_fma_f32 v[222:223], v[190:191], v[198:199], v[194:195] op_sel:[0,0,1] op_sel_hi:[1,0,1]
v_pk_fma_f32 v[136:137], v[136:137], v[176:177], v[216:217]
v_pk_fma_f32 v[138:139], v[138:139], v[178:179], v[218:219]
v_pk_fma_f32 v[152:153], v[152:153], v[180:181], v[220:221]
v_pk_fma_f32 v[154:155], v[154:155], v[182:183], v[222:223]
v_cvt_pk_bf16_f32 v208, v136, v137
v_cvt_pk_bf16_f32 v209, v138, v139
v_cvt_pk_bf16_f32 v210, v152, v153
v_cvt_pk_bf16_f32 v211, v154, v155
v_pk_fma_f32 v[216:217], v[184:185], v[198:199], v[194:195] op_sel:[0,1,1] op_sel_hi:[1,1,1]
v_pk_fma_f32 v[218:219], v[186:187], v[198:199], v[194:195] op_sel:[0,1,1] op_sel_hi:[1,1,1]
v_pk_fma_f32 v[220:221], v[188:189], v[198:199], v[194:195] op_sel:[0,1,1] op_sel_hi:[1,1,1]
v_pk_fma_f32 v[222:223], v[190:191], v[198:199], v[194:195] op_sel:[0,1,1] op_sel_hi:[1,1,1]
v_pk_fma_f32 v[140:141], v[140:141], v[176:177], v[216:217]
v_pk_fma_f32 v[142:143], v[142:143], v[178:179], v[218:219]
v_pk_fma_f32 v[156:157], v[156:157], v[180:181], v[220:221]
s_add_u32 m0, s63, 53248
s_add_u32 s47, s62, 32768
buffer_load_dwordx4 v232, s[16:19], s47 offen offset:0 lds
v_pk_fma_f32 v[158:159], v[158:159], v[182:183], v[222:223]
v_cvt_pk_bf16_f32 v212, v140, v141
v_cvt_pk_bf16_f32 v213, v142, v143
v_cvt_pk_bf16_f32 v214, v156, v157
v_cvt_pk_bf16_f32 v215, v158, v159
v_mfma_f32_16x16x32_bf16 v[128:131], v[200:203], v[208:211], 0
v_mfma_f32_16x16x32_bf16 v[132:135], v[200:203], a[236:239], 0
v_mfma_f32_16x16x32_bf16 v[136:139], v[204:207], v[212:215], 0
v_mfma_f32_16x16x32_bf16 v[140:143], v[204:207], a[236:239], 0
s_and_b32 s54, s48, 1
s_lshl_b32 s54, s54, 2
s_and_b32 s55, s48, 2
s_add_u32 s54, s54, s55
s_lshl_b32 s55, s54, 10
v_add_u32 v216, s55, v255
s_lshl_b32 s55, s54, 6
v_lshrrev_b32 v217, 8, v255
v_lshl_add_u32 v217, v217, 4, s55
ds_write_b128 v216, v[128:131] offset:36864
ds_write_b128 v217, v[132:135] offset:45056
ds_write_b128 v216, v[136:139] offset:37888
ds_write_b128 v217, v[140:143] offset:45120
v_lshrrev_b32 v216, 2, v255
s_lshl_b32 s54, s48, 10
s_add_u32 s54, s54, 36864
v_add_u32 v217, s54, v216
s_lshl_b32 s54, s48, 6
s_add_u32 s54, s54, 45056
v_add_u32 v218, s54, v216
s_lshl_b32 s55, s50, 2
s_add_u32 s55, s55, s48
s_lshl_b32 s92, s55, 10
s_add_u32 s92, s92, 165888
s_lshl_b32 s93, s55, 6
s_add_u32 s93, s93, 198656
s_waitcnt vmcnt(5) lgkmcnt(0)
s_barrier
ds_read2st64_b32 v[128:129], v217 offset0:0 offset1:16
ds_read2st64_b32 v[130:131], v217 offset0:1 offset1:17
ds_read2st64_b32 v[132:133], v217 offset0:2 offset1:18
ds_read2st64_b32 v[134:135], v217 offset0:3 offset1:19
ds_read2st64_b32 v[136:137], v218 offset0:0 offset1:1
s_waitcnt lgkmcnt(0)
v_add_f32 v128, v128, v129
v_add_f32 v130, v130, v131
v_add_f32 v132, v132, v133
v_add_f32 v134, v134, v135
v_add_f32 v136, v136, v137
buffer_atomic_add_f32 v128, v216, s[28:31], s92 offen offset:0 sc1
buffer_atomic_add_f32 v130, v216, s[28:31], s92 offen offset:256 sc1
buffer_atomic_add_f32 v132, v216, s[28:31], s92 offen offset:512 sc1
buffer_atomic_add_f32 v134, v216, s[28:31], s92 offen offset:768 sc1
s_mov_b64 exec, 0xffff
buffer_atomic_add_f32 v136, v216, s[28:31], s93 offen sc1
s_mov_b64 exec, -1
ds_read_b64_tr_b16 v[192:193], v228 offset:0
ds_read_b64_tr_b16 v[194:195], v228 offset:2048
ds_read_b64_tr_b16 v[196:197], v229 offset:0
ds_read_b64_tr_b16 v[198:199], v229 offset:2048
ds_read_b64_tr_b16 v[200:201], v228 offset:4096
ds_read_b64_tr_b16 v[202:203], v228 offset:6144
ds_read_b64_tr_b16 v[204:205], v229 offset:4096
ds_read_b64_tr_b16 v[206:207], v229 offset:6144
ds_read_b64_tr_b16 v[208:209], v228 offset:8192
ds_read_b64_tr_b16 v[210:211], v228 offset:10240
ds_read_b64_tr_b16 v[212:213], v229 offset:8192
ds_read_b64_tr_b16 v[214:215], v229 offset:10240
s_waitcnt lgkmcnt(10)
v_mfma_f32_16x16x32_bf16 v[168:171], v[192:195], v[0:3], 0
ds_read_b64_tr_b16 v[216:217], v228 offset:12288
v_mfma_f32_16x16x32_bf16 v[176:179], v[192:195], v[64:67], 0
ds_read_b64_tr_b16 v[218:219], v228 offset:14336
s_waitcnt lgkmcnt(10)
v_mfma_f32_16x16x32_bf16 v[172:175], v[196:199], v[0:3], 0
ds_read_b64_tr_b16 v[220:221], v229 offset:12288
buffer_load_dwordx4 v233, s[16:19], s47 offen offset:1024 lds
v_mfma_f32_16x16x32_bf16 v[180:183], v[196:199], v[64:67], 0
ds_read_b64_tr_b16 v[222:223], v229 offset:14336
s_waitcnt lgkmcnt(10)
v_mfma_f32_16x16x32_bf16 v[168:171], v[200:203], v[4:7], v[168:171]
ds_read_b64_tr_b16 v[192:193], v228 offset:16384
v_mfma_f32_16x16x32_bf16 v[176:179], v[200:203], v[68:71], v[176:179]
ds_read_b64_tr_b16 v[194:195], v228 offset:18432
s_waitcnt lgkmcnt(10)
v_mfma_f32_16x16x32_bf16 v[172:175], v[204:207], v[4:7], v[172:175]
ds_read_b64_tr_b16 v[196:197], v229 offset:16384
buffer_load_dwordx4 v234, s[16:19], s47 offen offset:2048 lds
v_mfma_f32_16x16x32_bf16 v[180:183], v[204:207], v[68:71], v[180:183]
ds_read_b64_tr_b16 v[198:199], v229 offset:18432
s_waitcnt lgkmcnt(10)
v_mfma_f32_16x16x32_bf16 v[168:171], v[208:211], v[8:11], v[168:171]
ds_read_b64_tr_b16 v[200:201], v228 offset:20480
v_mfma_f32_16x16x32_bf16 v[176:179], v[208:211], v[72:75], v[176:179]
ds_read_b64_tr_b16 v[202:203], v228 offset:22528
s_waitcnt lgkmcnt(10)
v_mfma_f32_16x16x32_bf16 v[172:175], v[212:215], v[8:11], v[172:175]
ds_read_b64_tr_b16 v[204:205], v229 offset:20480
buffer_load_dwordx4 v235, s[16:19], s47 offen offset:3072 lds
v_mfma_f32_16x16x32_bf16 v[180:183], v[212:215], v[72:75], v[180:183]
ds_read_b64_tr_b16 v[206:207], v229 offset:22528
s_waitcnt lgkmcnt(10)
v_mfma_f32_16x16x32_bf16 v[168:171], v[216:219], v[12:15], v[168:171]
ds_read_b64_tr_b16 v[208:209], v228 offset:24576
v_mfma_f32_16x16x32_bf16 v[176:179], v[216:219], v[76:79], v[176:179]
ds_read_b64_tr_b16 v[210:211], v228 offset:26624
s_waitcnt lgkmcnt(10)
v_mfma_f32_16x16x32_bf16 v[172:175], v[220:223], v[12:15], v[172:175]
ds_read_b64_tr_b16 v[212:213], v229 offset:24576
s_add_u32 m0, s63, 57344
v_mfma_f32_16x16x32_bf16 v[180:183], v[220:223], v[76:79], v[180:183]
ds_read_b64_tr_b16 v[214:215], v229 offset:26624
s_waitcnt lgkmcnt(10)
v_mfma_f32_16x16x32_bf16 v[168:171], v[192:195], v[16:19], v[168:171]
ds_read_b64_tr_b16 v[216:217], v224 offset:0
v_mfma_f32_16x16x32_bf16 v[176:179], v[192:195], v[80:83], v[176:179]
ds_read_b64_tr_b16 v[218:219], v224 offset:2048
s_waitcnt lgkmcnt(10)
v_mfma_f32_16x16x32_bf16 v[172:175], v[196:199], v[16:19], v[172:175]
ds_read_b64_tr_b16 v[220:221], v225 offset:0
s_add_u32 s47, s62, 65536
v_mfma_f32_16x16x32_bf16 v[180:183], v[196:199], v[80:83], v[180:183]
ds_read_b64_tr_b16 v[222:223], v225 offset:2048
s_waitcnt lgkmcnt(10)
v_mfma_f32_16x16x32_bf16 v[168:171], v[200:203], v[20:23], v[168:171]
ds_read_b64_tr_b16 v[192:193], v224 offset:4096
v_mfma_f32_16x16x32_bf16 v[176:179], v[200:203], v[84:87], v[176:179]
ds_read_b64_tr_b16 v[194:195], v224 offset:6144
s_waitcnt lgkmcnt(10)
v_mfma_f32_16x16x32_bf16 v[172:175], v[204:207], v[20:23], v[172:175]
ds_read_b64_tr_b16 v[196:197], v225 offset:4096
buffer_load_dwordx4 v232, s[16:19], s47 offen offset:0 lds
v_mfma_f32_16x16x32_bf16 v[180:183], v[204:207], v[84:87], v[180:183]
ds_read_b64_tr_b16 v[198:199], v225 offset:6144
s_waitcnt lgkmcnt(10)
v_mfma_f32_16x16x32_bf16 v[168:171], v[208:211], v[24:27], v[168:171]
ds_read_b64_tr_b16 v[200:201], v224 offset:8192
v_mfma_f32_16x16x32_bf16 v[176:179], v[208:211], v[88:91], v[176:179]
ds_read_b64_tr_b16 v[202:203], v224 offset:10240
s_waitcnt lgkmcnt(10)
v_mfma_f32_16x16x32_bf16 v[172:175], v[212:215], v[24:27], v[172:175]
ds_read_b64_tr_b16 v[204:205], v225 offset:8192
buffer_load_dwordx4 v233, s[16:19], s47 offen offset:1024 lds
v_mfma_f32_16x16x32_bf16 v[180:183], v[212:215], v[88:91], v[180:183]
ds_read_b64_tr_b16 v[206:207], v225 offset:10240
s_waitcnt lgkmcnt(10)
v_mfma_f32_16x16x32_bf16 v[168:171], v[216:219], v[28:31], v[168:171]
ds_read_b64_tr_b16 v[208:209], v224 offset:12288
buffer_load_dwordx4 v234, s[16:19], s47 offen offset:2048 lds
v_mfma_f32_16x16x32_bf16 v[176:179], v[216:219], v[92:95], v[176:179]
ds_read_b64_tr_b16 v[210:211], v224 offset:14336
s_waitcnt lgkmcnt(10)
v_mfma_f32_16x16x32_bf16 v[172:175], v[220:223], v[28:31], v[172:175]
ds_read_b64_tr_b16 v[212:213], v225 offset:12288
v_mfma_f32_16x16x32_bf16 v[180:183], v[220:223], v[92:95], v[180:183]
ds_read_b64_tr_b16 v[214:215], v225 offset:14336
s_waitcnt lgkmcnt(10)
v_mfma_f32_16x16x32_bf16 v[168:171], v[192:195], v[32:35], v[168:171]
ds_read_b64_tr_b16 v[216:217], v224 offset:16384
buffer_load_dwordx4 v235, s[16:19], s47 offen offset:3072 lds
v_mfma_f32_16x16x32_bf16 v[176:179], v[192:195], v[96:99], v[176:179]
ds_read_b64_tr_b16 v[218:219], v224 offset:18432
s_waitcnt lgkmcnt(10)
v_mfma_f32_16x16x32_bf16 v[172:175], v[196:199], v[32:35], v[172:175]
ds_read_b64_tr_b16 v[220:221], v225 offset:16384
v_mfma_f32_16x16x32_bf16 v[180:183], v[196:199], v[96:99], v[180:183]
ds_read_b64_tr_b16 v[222:223], v225 offset:18432
s_waitcnt lgkmcnt(10)
v_mfma_f32_16x16x32_bf16 v[168:171], v[200:203], v[36:39], v[168:171]
ds_read_b64_tr_b16 v[192:193], v224 offset:20480
s_add_u32 m0, s63, 61440
v_mfma_f32_16x16x32_bf16 v[176:179], v[200:203], v[100:103], v[176:179]
ds_read_b64_tr_b16 v[194:195], v224 offset:22528
s_waitcnt lgkmcnt(10)
v_mfma_f32_16x16x32_bf16 v[172:175], v[204:207], v[36:39], v[172:175]
ds_read_b64_tr_b16 v[196:197], v225 offset:20480
v_mfma_f32_16x16x32_bf16 v[180:183], v[204:207], v[100:103], v[180:183]
ds_read_b64_tr_b16 v[198:199], v225 offset:22528
s_waitcnt lgkmcnt(10)
v_mfma_f32_16x16x32_bf16 v[168:171], v[208:211], v[40:43], v[168:171]
ds_read_b64_tr_b16 v[200:201], v224 offset:24576
s_add_u32 s47, s62, 98304
v_mfma_f32_16x16x32_bf16 v[176:179], v[208:211], v[104:107], v[176:179]
ds_read_b64_tr_b16 v[202:203], v224 offset:26624
s_waitcnt lgkmcnt(10)
v_mfma_f32_16x16x32_bf16 v[172:175], v[212:215], v[40:43], v[172:175]
ds_read_b64_tr_b16 v[204:205], v225 offset:24576
v_mfma_f32_16x16x32_bf16 v[180:183], v[212:215], v[104:107], v[180:183]
ds_read_b64_tr_b16 v[206:207], v225 offset:26624
s_waitcnt lgkmcnt(10)
v_mfma_f32_16x16x32_bf16 v[168:171], v[216:219], v[44:47], v[168:171]
ds_read_b64_tr_b16 v[208:209], v224 offset:28672
buffer_load_dwordx4 v232, s[16:19], s47 offen offset:0 lds
v_mfma_f32_16x16x32_bf16 v[176:179], v[216:219], v[108:111], v[176:179]
ds_read_b64_tr_b16 v[210:211], v224 offset:30720
s_waitcnt lgkmcnt(10)
v_mfma_f32_16x16x32_bf16 v[172:175], v[220:223], v[44:47], v[172:175]
ds_read_b64_tr_b16 v[212:213], v225 offset:28672
v_mfma_f32_16x16x32_bf16 v[180:183], v[220:223], v[108:111], v[180:183]
ds_read_b64_tr_b16 v[214:215], v225 offset:30720
s_waitcnt lgkmcnt(10)
v_mfma_f32_16x16x32_bf16 v[168:171], v[192:195], v[48:51], v[168:171]
ds_read_b64_tr_b16 v[216:217], v224 offset:32768
buffer_load_dwordx4 v233, s[16:19], s47 offen offset:1024 lds
v_mfma_f32_16x16x32_bf16 v[176:179], v[192:195], v[112:115], v[176:179]
ds_read_b64_tr_b16 v[218:219], v224 offset:34816
s_waitcnt lgkmcnt(10)
v_mfma_f32_16x16x32_bf16 v[172:175], v[196:199], v[48:51], v[172:175]
ds_read_b64_tr_b16 v[220:221], v225 offset:32768
v_mfma_f32_16x16x32_bf16 v[180:183], v[196:199], v[112:115], v[180:183]
ds_read_b64_tr_b16 v[222:223], v225 offset:34816
s_waitcnt lgkmcnt(10)
v_mfma_f32_16x16x32_bf16 v[168:171], v[200:203], v[52:55], v[168:171]
buffer_load_dwordx4 v234, s[16:19], s47 offen offset:2048 lds
v_mfma_f32_16x16x32_bf16 v[176:179], v[200:203], v[116:119], v[176:179]
s_waitcnt lgkmcnt(8)
v_mfma_f32_16x16x32_bf16 v[172:175], v[204:207], v[52:55], v[172:175]
buffer_load_dwordx4 v235, s[16:19], s47 offen offset:3072 lds
v_mfma_f32_16x16x32_bf16 v[180:183], v[204:207], v[116:119], v[180:183]
s_waitcnt lgkmcnt(6)
v_mfma_f32_16x16x32_bf16 v[168:171], v[208:211], v[56:59], v[168:171]
v_mfma_f32_16x16x32_bf16 v[176:179], v[208:211], v[120:123], v[176:179]
s_waitcnt lgkmcnt(4)
v_mfma_f32_16x16x32_bf16 v[172:175], v[212:215], v[56:59], v[172:175]
v_mfma_f32_16x16x32_bf16 v[180:183], v[212:215], v[120:123], v[180:183]
s_waitcnt lgkmcnt(2)
v_mfma_f32_16x16x32_bf16 v[168:171], v[216:219], v[60:63], v[168:171]
v_mfma_f32_16x16x32_bf16 v[176:179], v[216:219], v[124:127], v[176:179]
s_waitcnt lgkmcnt(0)
v_mfma_f32_16x16x32_bf16 v[172:175], v[220:223], v[60:63], v[172:175]
v_mfma_f32_16x16x32_bf16 v[180:183], v[220:223], v[124:127], v[180:183]
v_mov_b32 v216, 159744
v_mov_b32 v217, 1
s_lshl_b32 s54, s50, 5
s_add_u32 s54, s54, s49
s_lshr_b32 s54, s54, 0
s_lshl_b32 s54, s54, 7
s_and_b32 s55, s49, 0
s_lshl_b32 s55, s55, 2
s_add_u32 s54, s54, s55
s_add_u32 s54, s54, 98304
s_waitcnt vmcnt(11)
s_mov_b64 exec, 1
ds_add_rtn_u32 v218, v216, v217
s_waitcnt lgkmcnt(0)
v_cmp_ne_u32 vcc, 7, v218
s_nop 4
s_cbranch_vccnz KS26
buffer_store_dword v217, off, s[28:31], s54 sc1
KS26:
s_mov_b64 exec, -1
v_mov_b32 v192, 0x3fb8aa3b
v_mov_b32 v193, 0xb5c1a2a0
v_mov_b32 v194, s61
v_accvgpr_read_b32 v184, a228
v_accvgpr_read_b32 v185, a229
v_accvgpr_read_b32 v186, a230
v_accvgpr_read_b32 v187, a231
v_accvgpr_read_b32 v188, a232
v_accvgpr_read_b32 v189, a233
v_accvgpr_read_b32 v190, a234
v_accvgpr_read_b32 v191, a235
s_and_b32 s54, s48, 1
s_lshl_b32 s54, s54, 1
s_lshl_b32 s55, s49, 2
s_add_u32 s54, s54, s55
s_mul_i32 s54, s54, 57344
s_lshl_b32 s55, s50, 1
s_lshr_b32 s56, s48, 1
s_add_u32 s55, s55, s56
s_lshl_b32 s55, s55, 10
s_add_u32 s54, s54, s55
s_add_u32 s54, s54, 11534336
v_pk_fma_f32 v[216:217], v[184:185], v[236:237], v[194:195] op_sel:[0,1,0] op_sel_hi:[1,1,0]
v_pk_fma_f32 v[218:219], v[186:187], v[236:237], v[194:195] op_sel:[0,1,0] op_sel_hi:[1,1,0]
v_pk_fma_f32 v[220:221], v[188:189], v[236:237], v[194:195] op_sel:[0,1,0] op_sel_hi:[1,1,0]
v_pk_fma_f32 v[222:223], v[190:191], v[236:237], v[194:195] op_sel:[0,1,0] op_sel_hi:[1,1,0]
v_pk_fma_f32 v[168:169], v[168:169], v[236:237], v[216:217] op_sel:[0,0,0] op_sel_hi:[1,0,1]
v_pk_fma_f32 v[170:171], v[170:171], v[236:237], v[218:219] op_sel:[0,0,0] op_sel_hi:[1,0,1]
v_pk_fma_f32 v[172:173], v[172:173], v[236:237], v[220:221] op_sel:[0,0,0] op_sel_hi:[1,0,1]
v_pk_fma_f32 v[174:175], v[174:175], v[236:237], v[222:223] op_sel:[0,0,0] op_sel_hi:[1,0,1]
v_pk_fma_f32 v[216:217], v[168:169], v[192:193], v[192:193] op_sel:[0,0,1] op_sel_hi:[1,0,1]
v_pk_fma_f32 v[218:219], v[170:171], v[192:193], v[192:193] op_sel:[0,0,1] op_sel_hi:[1,0,1]
v_pk_fma_f32 v[220:221], v[172:173], v[192:193], v[192:193] op_sel:[0,0,1] op_sel_hi:[1,0,1]
v_pk_fma_f32 v[222:223], v[174:175], v[192:193], v[192:193] op_sel:[0,0,1] op_sel_hi:[1,0,1]
v_exp_f32_e64 v216, v216 clamp
v_exp_f32_e64 v218, v218 clamp
v_exp_f32_e64 v220, v220 clamp
v_exp_f32_e64 v222, v222 clamp
v_exp_f32_e64 v217, v217 clamp
v_exp_f32_e64 v219, v219 clamp
v_exp_f32_e64 v221, v221 clamp
v_exp_f32_e64 v223, v223 clamp
v_max_f32 v168, s61, v168
v_max_f32 v170, s61, v170
v_max_f32 v172, s61, v172
v_max_f32 v174, s61, v174
v_max_f32 v169, s61, v169
v_max_f32 v171, s61, v171
v_max_f32 v173, s61, v173
v_max_f32 v175, s61, v175
v_pk_add_f32 v[168:169], v[168:169], v[216:217]
v_pk_add_f32 v[170:171], v[170:171], v[218:219]
v_pk_add_f32 v[172:173], v[172:173], v[220:221]
v_pk_add_f32 v[174:175], v[174:175], v[222:223]
v_cvt_pk_bf16_f32 v200, v168, v169
v_cvt_pk_bf16_f32 v201, v170, v171
v_cvt_pk_bf16_f32 v202, v172, v173
v_cvt_pk_bf16_f32 v203, v174, v175
buffer_store_dwordx4 v[200:203], v255, s[28:31], s54 offen
s_add_u32 s54, s54, 57344
v_pk_fma_f32 v[216:217], v[184:185], v[238:239], v[194:195] op_sel:[0,1,0] op_sel_hi:[1,1,0]
v_pk_fma_f32 v[218:219], v[186:187], v[238:239], v[194:195] op_sel:[0,1,0] op_sel_hi:[1,1,0]
v_pk_fma_f32 v[220:221], v[188:189], v[238:239], v[194:195] op_sel:[0,1,0] op_sel_hi:[1,1,0]
v_pk_fma_f32 v[222:223], v[190:191], v[238:239], v[194:195] op_sel:[0,1,0] op_sel_hi:[1,1,0]
v_pk_fma_f32 v[176:177], v[176:177], v[238:239], v[216:217] op_sel:[0,0,0] op_sel_hi:[1,0,1]
v_pk_fma_f32 v[178:179], v[178:179], v[238:239], v[218:219] op_sel:[0,0,0] op_sel_hi:[1,0,1]
v_pk_fma_f32 v[180:181], v[180:181], v[238:239], v[220:221] op_sel:[0,0,0] op_sel_hi:[1,0,1]
v_pk_fma_f32 v[182:183], v[182:183], v[238:239], v[222:223] op_sel:[0,0,0] op_sel_hi:[1,0,1]
v_pk_fma_f32 v[216:217], v[176:177], v[192:193], v[192:193] op_sel:[0,0,1] op_sel_hi:[1,0,1]
v_pk_fma_f32 v[218:219], v[178:179], v[192:193], v[192:193] op_sel:[0,0,1] op_sel_hi:[1,0,1]
v_pk_fma_f32 v[220:221], v[180:181], v[192:193], v[192:193] op_sel:[0,0,1] op_sel_hi:[1,0,1]
v_pk_fma_f32 v[222:223], v[182:183], v[192:193], v[192:193] op_sel:[0,0,1] op_sel_hi:[1,0,1]
v_exp_f32_e64 v216, v216 clamp
v_exp_f32_e64 v218, v218 clamp
v_exp_f32_e64 v220, v220 clamp
v_exp_f32_e64 v222, v222 clamp
v_exp_f32_e64 v217, v217 clamp
v_exp_f32_e64 v219, v219 clamp
v_exp_f32_e64 v221, v221 clamp
v_exp_f32_e64 v223, v223 clamp
v_max_f32 v176, s61, v176
v_max_f32 v178, s61, v178
v_max_f32 v180, s61, v180
v_max_f32 v182, s61, v182
v_max_f32 v177, s61, v177
v_max_f32 v179, s61, v179
v_max_f32 v181, s61, v181
v_max_f32 v183, s61, v183
v_pk_add_f32 v[176:177], v[176:177], v[216:217]
v_pk_add_f32 v[178:179], v[178:179], v[218:219]
v_pk_add_f32 v[180:181], v[180:181], v[220:221]
v_pk_add_f32 v[182:183], v[182:183], v[222:223]
v_cvt_pk_bf16_f32 v204, v176, v177
v_cvt_pk_bf16_f32 v205, v178, v179
v_cvt_pk_bf16_f32 v206, v180, v181
v_cvt_pk_bf16_f32 v207, v182, v183
buffer_store_dwordx4 v[204:207], v255, s[28:31], s54 offen
s_add_u32 s55, s63, 49152
v_add_u32 v224, s55, v254
v_xor_b32 v225, 32, v224
v_xor_b32 v226, 64, v224
v_xor_b32 v227, 96, v224
s_lshl_b32 s59, s49, 7
s_add_u32 s59, s59, 65536
s_lshl_b32 s56, s50, 2
s_add_u32 s56, s56, s48
s_lshl_b32 s56, s56, 2
s_add_u32 s56, s56, s59
v_bfe_u32 v231, v255, 4, 3
v_lshlrev_b32 v231, 2, v231
s_waitcnt vmcnt(0)
s_mov_b64 exec, 1
v_mov_b32 v243, 1
s_cmp_lg_u32 s46, 0
s_cbranch_scc1 SG28
buffer_store_dword v243, off, s[28:31], s56
s_branch SG27
SG28:
buffer_wbl2 sc1
s_waitcnt vmcnt(0)
buffer_store_dword v243, off, s[28:31], s56 sc1
SG27:
s_mov_b64 exec, -1
ds_read_b64_tr_b16 v[64:65], v224 offset:0
ds_read_b64_tr_b16 v[66:67], v224 offset:2048
ds_read_b64_tr_b16 v[68:69], v225 offset:0
ds_read_b64_tr_b16 v[70:71], v225 offset:2048
ds_read_b64_tr_b16 v[72:73], v226 offset:0
ds_read_b64_tr_b16 v[74:75], v226 offset:2048
ds_read_b64_tr_b16 v[76:77], v227 offset:0
ds_read_b64_tr_b16 v[78:79], v227 offset:2048
ds_read_b64_tr_b16 v[80:81], v224 offset:4096
ds_read_b64_tr_b16 v[82:83], v224 offset:6144
ds_read_b64_tr_b16 v[84:85], v225 offset:4096
ds_read_b64_tr_b16 v[86:87], v225 offset:6144
ds_read_b64_tr_b16 v[88:89], v226 offset:4096
ds_read_b64_tr_b16 v[90:91], v226 offset:6144
ds_read_b64_tr_b16 v[92:93], v227 offset:4096
ds_read_b64_tr_b16 v[94:95], v227 offset:6144
ds_read_b64_tr_b16 v[96:97], v224 offset:8192
ds_read_b64_tr_b16 v[98:99], v224 offset:10240
ds_read_b64_tr_b16 v[100:101], v225 offset:8192
ds_read_b64_tr_b16 v[102:103], v225 offset:10240
ds_read_b64_tr_b16 v[104:105], v226 offset:8192
ds_read_b64_tr_b16 v[106:107], v226 offset:10240
ds_read_b64_tr_b16 v[108:109], v227 offset:8192
ds_read_b64_tr_b16 v[110:111], v227 offset:10240
ds_read_b64_tr_b16 a[240:241], v224 offset:12288
ds_read_b64_tr_b16 a[242:243], v224 offset:14336
ds_read_b64_tr_b16 a[244:245], v225 offset:12288
ds_read_b64_tr_b16 a[246:247], v225 offset:14336
ds_read_b64_tr_b16 a[248:249], v226 offset:12288
ds_read_b64_tr_b16 a[250:251], v226 offset:14336
ds_read_b64_tr_b16 a[252:253], v227 offset:12288
ds_read_b64_tr_b16 a[254:255], v227 offset:14336
s_mul_i32 s54, s49, 229376
s_mul_i32 s55, s48, 4096
s_add_u32 s54, s54, s55
s_add_u32 s54, s54, 11534336
s_add_u32 s55, s48, 0
s_and_b32 s55, s55, 3
s_mul_i32 s55, s55, 57344
s_add_u32 s62, s54, s55
s_add_u32 s55, s48, 1
s_and_b32 s55, s55, 3
s_mul_i32 s55, s55, 57344
s_add_u32 s63, s54, s55
s_add_u32 s55, s48, 2
s_and_b32 s55, s55, 3
s_mul_i32 s55, s55, 57344
s_add_u32 s64, s54, s55
s_add_u32 s55, s48, 3
s_and_b32 s55, s55, 3
s_mul_i32 s55, s55, 57344
s_add_u32 s65, s54, s55
v_mul_u32_u24 v232, 3584, v253
v_add_u32 v232, v232, v252
v_add_u32 v233, 27648, v232
v_add_u32 v234, 55296, v232
v_add_u32 v235, 82944, v232
v_bfe_u32 v228, v255, 4, 4
v_lshrrev_b32 v229, 6, v255
v_and_b32 v229, 12, v229
v_sub_u32 v228, v228, v229
v_cmp_gt_u32 vcc, 4, v228
v_mov_b32 v126, 0x3f80
v_mov_b32 v127, 0
v_lshlrev_b32 v228, 4, v228
v_cndmask_b32 v126, 0, v126, vcc
v_lshlrev_b64 v[126:127], v228, v[126:127]
v_bfe_u32 v224, v255, 4, 1
v_cmp_eq_u32_e64 s[90:91], 0, v224
v_lshlrev_b32 v224, 6, v224
v_lshrrev_b32 v225, 8, v255
v_lshl_add_u32 v224, v225, 4, v224
s_lshl_b32 s88, s48, 13
s_lshl_b32 s92, s48, 13
s_add_u32 s88, s88, 98304
s_add_u32 s92, s92, 165888
s_add_u32 s93, s92, 4096
s_lshl_b32 s94, s48, 9
s_add_u32 s94, s94, 198656
s_mul_i32 s58, s48, 114688
s_lshl_b32 s54, s52, 8
s_add_u32 s58, s58, s54
s_lshl_b32 s95, s48, 12
s_lshl_b32 s54, s48, 5
s_add_u32 s59, s59, s54
s_waitcnt lgkmcnt(0)
s_barrier
s_mov_b32 s57, 100000
PL29:
buffer_load_dword v230, v231, s[28:31], s59 offen sc1
s_waitcnt vmcnt(0)
v_cmp_ne_u32 vcc, 1, v230
s_sub_u32 s57, s57, 1
s_nop 3
s_cbranch_vccz PL30
s_cmp_lg_u32 s57, 0
s_cbranch_scc1 PL29
PL30:
buffer_load_dwordx4 v[0:3], v255, s[28:31], s62 offen offset:0 sc1
buffer_load_dwordx4 v[16:19], v255, s[28:31], s63 offen offset:0 sc1
buffer_load_dwordx4 v[32:35], v255, s[28:31], s64 offen offset:0 sc1
buffer_load_dwordx4 v[48:51], v255, s[28:31], s65 offen offset:0 sc1
buffer_load_dwordx4 v[4:7], v255, s[28:31], s62 offen offset:1024 sc1
buffer_load_dwordx4 v[20:23], v255, s[28:31], s63 offen offset:1024 sc1
buffer_load_dwordx4 v[36:39], v255, s[28:31], s64 offen offset:1024 sc1
buffer_load_dwordx4 v[52:55], v255, s[28:31], s65 offen offset:1024 sc1
buffer_load_dwordx4 v[8:11], v255, s[28:31], s62 offen offset:2048 sc1
buffer_load_dwordx4 v[24:27], v255, s[28:31], s63 offen offset:2048 sc1
buffer_load_dwordx4 v[40:43], v255, s[28:31], s64 offen offset:2048 sc1
buffer_load_dwordx4 v[56:59], v255, s[28:31], s65 offen offset:2048 sc1
buffer_load_dwordx4 v[12:15], v255, s[28:31], s62 offen offset:3072 sc1
buffer_load_dwordx4 v[28:31], v255, s[28:31], s63 offen offset:3072 sc1
buffer_load_dwordx4 v[44:47], v255, s[28:31], s64 offen offset:3072 sc1
buffer_load_dwordx4 v[60:63], v255, s[28:31], s65 offen offset:3072 sc1
v_lshrrev_b32 v231, 4, v255
v_lshlrev_b32 v231, 7, v231
v_bfe_u32 v230, v255, 4, 0
v_lshl_add_u32 v231, v230, 2, v231
s_mov_b32 s57, 100000
PL31:
buffer_load_dword v230, v231, s[28:31], s88 offen sc1
s_waitcnt vmcnt(0)
v_cmp_ne_u32 vcc, 1, v230
s_sub_u32 s57, s57, 1
s_nop 3
s_cbranch_vccz PL32
s_cmp_lg_u32 s57, 0
s_cbranch_scc1 PL31
PL32:
buffer_load_dwordx4 v[160:163], v224, s[28:31], s94 offen offset:0 sc1
buffer_load_dwordx4 v[128:131], v255, s[28:31], s92 offen offset:0 sc1
buffer_load_dwordx4 v[132:135], v255, s[28:31], s92 offen offset:1024 sc1
buffer_load_dwordx4 v[164:167], v224, s[28:31], s94 offen offset:128 sc1
buffer_load_dwordx4 v[136:139], v255, s[28:31], s92 offen offset:2048 sc1
buffer_load_dwordx4 v[140:143], v255, s[28:31], s92 offen offset:3072 sc1
buffer_load_dwordx4 v[168:171], v224, s[28:31], s94 offen offset:256 sc1
buffer_load_dwordx4 v[144:147], v255, s[28:31], s93 offen offset:0 sc1
buffer_load_dwordx4 v[148:151], v255, s[28:31], s93 offen offset:1024 sc1
buffer_load_dwordx4 v[172:175], v224, s[28:31], s94 offen offset:384 sc1
buffer_load_dwordx4 v[152:155], v255, s[28:31], s93 offen offset:2048 sc1
buffer_load_dwordx4 v[156:159], v255, s[28:31], s93 offen offset:3072 sc1
s_add_u32 m0, s95, 0
s_add_u32 s47, s58, 0
buffer_load_dwordx4 v232, s[20:23], s47 offen offset:0 lds
buffer_load_dwordx4 v233, s[20:23], s47 offen offset:1024 lds
buffer_load_dwordx4 v234, s[20:23], s47 offen offset:2048 lds
buffer_load_dwordx4 v235, s[20:23], s47 offen offset:3072 lds
s_add_u32 m0, s95, 65536
s_add_u32 s47, s58, 128
buffer_load_dwordx4 v232, s[20:23], s47 offen offset:0 lds
buffer_load_dwordx4 v233, s[20:23], s47 offen offset:1024 lds
buffer_load_dwordx4 v234, s[20:23], s47 offen offset:2048 lds
buffer_load_dwordx4 v235, s[20:23], s47 offen offset:3072 lds
s_add_u32 m0, s95, 16384
s_add_u32 s47, s58, 458752
buffer_load_dwordx4 v232, s[20:23], s47 offen offset:0 lds
buffer_load_dwordx4 v233, s[20:23], s47 offen offset:1024 lds
buffer_load_dwordx4 v234, s[20:23], s47 offen offset:2048 lds
buffer_load_dwordx4 v235, s[20:23], s47 offen offset:3072 lds
v_mov_b32 v224, s61
v_mov_b32 v225, s61
v_mov_b32 v226, s61
v_mov_b32 v227, s61
s_waitcnt vmcnt(21)
v_cvt_pk_bf16_f32 v192, v128, v129
v_cvt_pk_bf16_f32 v193, v130, v131
v_cvt_pk_bf16_f32 v194, v132, v133
v_cvt_pk_bf16_f32 v195, v134, v135
v_cvt_pk_bf16_f32 v176, v160, v161
v_cndmask_b32_e64 v208, 0, v176, s[90:91]
v_cndmask_b32_e64 v210, v176, 0, s[90:91]
v_cvt_pk_bf16_f32 v177, v162, v163
v_cndmask_b32_e64 v209, 0, v177, s[90:91]
v_cndmask_b32_e64 v211, v177, 0, s[90:91]
s_waitcnt vmcnt(18)
v_cvt_pk_bf16_f32 v196, v136, v137
v_cvt_pk_bf16_f32 v197, v138, v139
v_cvt_pk_bf16_f32 v198, v140, v141
v_cvt_pk_bf16_f32 v199, v142, v143
v_cvt_pk_bf16_f32 v178, v164, v165
v_cndmask_b32_e64 v212, 0, v178, s[90:91]
v_cndmask_b32_e64 v214, v178, 0, s[90:91]
v_cvt_pk_bf16_f32 v179, v166, v167
v_cndmask_b32_e64 v213, 0, v179, s[90:91]
v_cndmask_b32_e64 v215, v179, 0, s[90:91]
s_waitcnt vmcnt(15)
v_cvt_pk_bf16_f32 v200, v144, v145
v_cvt_pk_bf16_f32 v201, v146, v147
v_cvt_pk_bf16_f32 v202, v148, v149
v_cvt_pk_bf16_f32 v203, v150, v151
v_cvt_pk_bf16_f32 v180, v168, v169
v_cndmask_b32_e64 v216, 0, v180, s[90:91]
v_cndmask_b32_e64 v218, v180, 0, s[90:91]
v_cvt_pk_bf16_f32 v181, v170, v171
v_cndmask_b32_e64 v217, 0, v181, s[90:91]
v_cndmask_b32_e64 v219, v181, 0, s[90:91]
s_waitcnt vmcnt(12)
v_cvt_pk_bf16_f32 v204, v152, v153
v_cvt_pk_bf16_f32 v205, v154, v155
v_cvt_pk_bf16_f32 v206, v156, v157
v_cvt_pk_bf16_f32 v207, v158, v159
v_cvt_pk_bf16_f32 v182, v172, v173
v_cndmask_b32_e64 v220, 0, v182, s[90:91]
v_cndmask_b32_e64 v222, v182, 0, s[90:91]
v_cvt_pk_bf16_f32 v183, v174, v175
v_cndmask_b32_e64 v221, 0, v183, s[90:91]
v_cndmask_b32_e64 v223, v183, 0, s[90:91]
v_mfma_f32_16x16x32_bf16 v[240:243], v[208:211], v[0:3], v[224:227]
v_mfma_f32_16x16x16_bf16 v[228:231], v[192:193], v[0:1], 0
v_mfma_f32_16x16x16_bf16 v[236:239], v[194:195], v[2:3], 0
v_mfma_f32_16x16x32_bf16 v[120:123], v[208:211], v[16:19], v[224:227]
s_nop 4
v_rcp_f32 v240, v240
v_rcp_f32 v241, v241
v_mfma_f32_16x16x16_bf16 v[112:115], v[192:193], v[16:17], 0
v_mul_f32 v228, v228, v240
v_mul_f32 v229, v229, v240
v_mfma_f32_16x16x16_bf16 v[116:119], v[194:195], v[18:19], 0
v_mul_f32 v230, v230, v240
v_mul_f32 v231, v231, v240
v_mfma_f32_16x16x16_bf16 v[128:131], v[126:127], v[244:245], 0
v_mul_f32 v236, v236, v241
v_mul_f32 v237, v237, v241
v_mfma_f32_16x16x16_bf16 v[132:135], v[126:127], v[246:247], 0
v_mul_f32 v238, v238, v241
v_mul_f32 v239, v239, v241
v_mfma_f32_16x16x16_bf16 v[136:139], v[126:127], v[248:249], 0
v_cvt_pk_bf16_f32 v0, v228, v229
v_cvt_pk_bf16_f32 v1, v230, v231
v_mfma_f32_16x16x16_bf16 v[140:143], v[126:127], v[250:251], 0
v_cvt_pk_bf16_f32 v2, v236, v237
v_cvt_pk_bf16_f32 v3, v238, v239
s_add_u32 m0, s95, 81920
s_add_u32 s47, s58, 458880
v_mfma_f32_16x16x32_bf16 v[240:243], v[208:211], v[32:35], v[224:227]
v_rcp_f32 v120, v120
v_rcp_f32 v121, v121
v_mfma_f32_16x16x16_bf16 v[228:231], v[192:193], v[32:33], 0
v_mul_f32 v112, v112, v120
v_mul_f32 v113, v113, v120
v_mfma_f32_16x16x16_bf16 v[236:239], v[194:195], v[34:35], 0
v_mul_f32 v114, v114, v120
v_mul_f32 v115, v115, v120
v_mfma_f32_16x16x32_bf16 v[128:131], v[64:67], v[0:3], v[128:131]
v_mul_f32 v116, v116, v121
v_mul_f32 v117, v117, v121
v_mfma_f32_16x16x32_bf16 v[132:135], v[68:71], v[0:3], v[132:135]
v_mul_f32 v118, v118, v121
v_mul_f32 v119, v119, v121
v_mfma_f32_16x16x32_bf16 v[136:139], v[72:75], v[0:3], v[136:139]
v_cvt_pk_bf16_f32 v16, v112, v113
v_cvt_pk_bf16_f32 v17, v114, v115
v_mfma_f32_16x16x32_bf16 v[140:143], v[76:79], v[0:3], v[140:143]
v_cvt_pk_bf16_f32 v18, v116, v117
v_cvt_pk_bf16_f32 v19, v118, v119
buffer_load_dwordx4 v232, s[20:23], s47 offen offset:0 lds
buffer_load_dwordx4 v233, s[20:23], s47 offen offset:1024 lds
v_mfma_f32_16x16x32_bf16 v[120:123], v[208:211], v[48:51], v[224:227]
v_rcp_f32 v240, v240
v_rcp_f32 v241, v241
v_mfma_f32_16x16x16_bf16 v[112:115], v[192:193], v[48:49], 0
v_mul_f32 v228, v228, v240
v_mul_f32 v229, v229, v240
v_mfma_f32_16x16x16_bf16 v[116:119], v[194:195], v[50:51], 0
v_mul_f32 v230, v230, v240
v_mul_f32 v231, v231, v240
v_mfma_f32_16x16x32_bf16 v[144:147], v[64:67], v[16:19], 0
v_mul_f32 v236, v236, v241
v_mul_f32 v237, v237, v241
v_mfma_f32_16x16x32_bf16 v[148:151], v[68:71], v[16:19], 0
v_mul_f32 v238, v238, v241
v_mul_f32 v239, v239, v241
v_mfma_f32_16x16x32_bf16 v[152:155], v[72:75], v[16:19], 0
v_cvt_pk_bf16_f32 v32, v228, v229
v_cvt_pk_bf16_f32 v33, v230, v231
v_mfma_f32_16x16x32_bf16 v[156:159], v[76:79], v[16:19], 0
v_cvt_pk_bf16_f32 v34, v236, v237
v_cvt_pk_bf16_f32 v35, v238, v239
buffer_load_dwordx4 v234, s[20:23], s47 offen offset:2048 lds
buffer_load_dwordx4 v235, s[20:23], s47 offen offset:3072 lds
v_mfma_f32_16x16x32_bf16 v[240:243], v[212:215], v[4:7], v[224:227]
v_rcp_f32 v120, v120
v_rcp_f32 v121, v121
v_mfma_f32_16x16x16_bf16 v[228:231], v[196:197], v[4:5], 0
v_mul_f32 v112, v112, v120
v_mul_f32 v113, v113, v120
v_mfma_f32_16x16x16_bf16 v[236:239], v[198:199], v[6:7], 0
v_mul_f32 v114, v114, v120
v_mul_f32 v115, v115, v120
v_mfma_f32_16x16x32_bf16 v[160:163], v[64:67], v[32:35], 0
v_mul_f32 v116, v116, v121
v_mul_f32 v117, v117, v121
v_mfma_f32_16x16x32_bf16 v[164:167], v[68:71], v[32:35], 0
v_mul_f32 v118, v118, v121
v_mul_f32 v119, v119, v121
v_mfma_f32_16x16x32_bf16 v[168:171], v[72:75], v[32:35], 0
v_cvt_pk_bf16_f32 v48, v112, v113
v_cvt_pk_bf16_f32 v49, v114, v115
v_mfma_f32_16x16x32_bf16 v[172:175], v[76:79], v[32:35], 0
v_cvt_pk_bf16_f32 v50, v116, v117
v_cvt_pk_bf16_f32 v51, v118, v119
s_add_u32 m0, s95, 32768
s_add_u32 s47, s58, 917504
v_mfma_f32_16x16x32_bf16 v[120:123], v[212:215], v[20:23], v[224:227]
v_rcp_f32 v240, v240
v_rcp_f32 v241, v241
v_mfma_f32_16x16x16_bf16 v[112:115], v[196:197], v[20:21], 0
v_mul_f32 v228, v228, v240
v_mul_f32 v229, v229, v240
v_mfma_f32_16x16x16_bf16 v[116:119], v[198:199], v[22:23], 0
v_mul_f32 v230, v230, v240
v_mul_f32 v231, v231, v240
v_mfma_f32_16x16x32_bf16 v[176:179], v[64:67], v[48:51], 0
v_mul_f32 v236, v236, v241
v_mul_f32 v237, v237, v241
v_mfma_f32_16x16x32_bf16 v[180:183], v[68:71], v[48:51], 0
v_mul_f32 v238, v238, v241
v_mul_f32 v239, v239, v241
v_mfma_f32_16x16x32_bf16 v[184:187], v[72:75], v[48:51], 0
v_cvt_pk_bf16_f32 v4, v228, v229
v_cvt_pk_bf16_f32 v5, v230, v231
v_mfma_f32_16x16x32_bf16 v[188:191], v[76:79], v[48:51], 0
v_cvt_pk_bf16_f32 v6, v236, v237
v_cvt_pk_bf16_f32 v7, v238, v239
buffer_load_dwordx4 v232, s[20:23], s47 offen offset:0 lds
buffer_load_dwordx4 v233, s[20:23], s47 offen offset:1024 lds
v_mfma_f32_16x16x32_bf16 v[240:243], v[212:215], v[36:39], v[224:227]
v_rcp_f32 v120, v120
v_rcp_f32 v121, v121
v_mfma_f32_16x16x16_bf16 v[228:231], v[196:197], v[36:37], 0
v_mul_f32 v112, v112, v120
v_mul_f32 v113, v113, v120
v_mfma_f32_16x16x16_bf16 v[236:239], v[198:199], v[38:39], 0
v_mul_f32 v114, v114, v120
v_mul_f32 v115, v115, v120
v_mfma_f32_16x16x32_bf16 v[128:131], v[80:83], v[4:7], v[128:131]
v_mul_f32 v116, v116, v121
v_mul_f32 v117, v117, v121
v_mfma_f32_16x16x32_bf16 v[132:135], v[84:87], v[4:7], v[132:135]
v_mul_f32 v118, v118, v121
v_mul_f32 v119, v119, v121
v_mfma_f32_16x16x32_bf16 v[136:139], v[88:91], v[4:7], v[136:139]
v_cvt_pk_bf16_f32 v20, v112, v113
v_cvt_pk_bf16_f32 v21, v114, v115
v_mfma_f32_16x16x32_bf16 v[140:143], v[92:95], v[4:7], v[140:143]
v_cvt_pk_bf16_f32 v22, v116, v117
v_cvt_pk_bf16_f32 v23, v118, v119
buffer_load_dwordx4 v234, s[20:23], s47 offen offset:2048 lds
buffer_load_dwordx4 v235, s[20:23], s47 offen offset:3072 lds
v_mfma_f32_16x16x32_bf16 v[120:123], v[212:215], v[52:55], v[224:227]
v_rcp_f32 v240, v240
v_rcp_f32 v241, v241
v_mfma_f32_16x16x16_bf16 v[112:115], v[196:197], v[52:53], 0
v_mul_f32 v228, v228, v240
v_mul_f32 v229, v229, v240
v_mfma_f32_16x16x16_bf16 v[116:119], v[198:199], v[54:55], 0
v_mul_f32 v230, v230, v240
v_mul_f32 v231, v231, v240
v_mfma_f32_16x16x32_bf16 v[144:147], v[80:83], v[20:23], v[144:147]
v_mul_f32 v236, v236, v241
v_mul_f32 v237, v237, v241
v_mfma_f32_16x16x32_bf16 v[148:151], v[84:87], v[20:23], v[148:151]
v_mul_f32 v238, v238, v241
v_mul_f32 v239, v239, v241
v_mfma_f32_16x16x32_bf16 v[152:155], v[88:91], v[20:23], v[152:155]
v_cvt_pk_bf16_f32 v36, v228, v229
v_cvt_pk_bf16_f32 v37, v230, v231
v_mfma_f32_16x16x32_bf16 v[156:159], v[92:95], v[20:23], v[156:159]
v_cvt_pk_bf16_f32 v38, v236, v237
v_cvt_pk_bf16_f32 v39, v238, v239
s_add_u32 m0, s95, 98304
s_add_u32 s47, s58, 917632
v_mfma_f32_16x16x32_bf16 v[240:243], v[216:219], v[8:11], v[224:227]
v_rcp_f32 v120, v120
v_rcp_f32 v121, v121
v_mfma_f32_16x16x16_bf16 v[228:231], v[200:201], v[8:9], 0
v_mul_f32 v112, v112, v120
v_mul_f32 v113, v113, v120
v_mfma_f32_16x16x16_bf16 v[236:239], v[202:203], v[10:11], 0
v_mul_f32 v114, v114, v120
v_mul_f32 v115, v115, v120
v_mfma_f32_16x16x32_bf16 v[160:163], v[80:83], v[36:39], v[160:163]
v_mul_f32 v116, v116, v121
v_mul_f32 v117, v117, v121
v_mfma_f32_16x16x32_bf16 v[164:167], v[84:87], v[36:39], v[164:167]
v_mul_f32 v118, v118, v121
v_mul_f32 v119, v119, v121
v_mfma_f32_16x16x32_bf16 v[168:171], v[88:91], v[36:39], v[168:171]
v_cvt_pk_bf16_f32 v52, v112, v113
v_cvt_pk_bf16_f32 v53, v114, v115
v_mfma_f32_16x16x32_bf16 v[172:175], v[92:95], v[36:39], v[172:175]
v_cvt_pk_bf16_f32 v54, v116, v117
v_cvt_pk_bf16_f32 v55, v118, v119
buffer_load_dwordx4 v232, s[20:23], s47 offen offset:0 lds
buffer_load_dwordx4 v233, s[20:23], s47 offen offset:1024 lds
v_mfma_f32_16x16x32_bf16 v[120:123], v[216:219], v[24:27], v[224:227]
v_rcp_f32 v240, v240
v_rcp_f32 v241, v241
v_mfma_f32_16x16x16_bf16 v[112:115], v[200:201], v[24:25], 0
v_mul_f32 v228, v228, v240
v_mul_f32 v229, v229, v240
v_mfma_f32_16x16x16_bf16 v[116:119], v[202:203], v[26:27], 0
v_mul_f32 v230, v230, v240
v_mul_f32 v231, v231, v240
v_mfma_f32_16x16x32_bf16 v[176:179], v[80:83], v[52:55], v[176:179]
v_mul_f32 v236, v236, v241
v_mul_f32 v237, v237, v241
v_mfma_f32_16x16x32_bf16 v[180:183], v[84:87], v[52:55], v[180:183]
v_mul_f32 v238, v238, v241
v_mul_f32 v239, v239, v241
v_mfma_f32_16x16x32_bf16 v[184:187], v[88:91], v[52:55], v[184:187]
v_cvt_pk_bf16_f32 v8, v228, v229
v_cvt_pk_bf16_f32 v9, v230, v231
v_mfma_f32_16x16x32_bf16 v[188:191], v[92:95], v[52:55], v[188:191]
v_cvt_pk_bf16_f32 v10, v236, v237
v_cvt_pk_bf16_f32 v11, v238, v239
buffer_load_dwordx4 v234, s[20:23], s47 offen offset:2048 lds
buffer_load_dwordx4 v235, s[20:23], s47 offen offset:3072 lds
v_mfma_f32_16x16x32_bf16 v[240:243], v[216:219], v[40:43], v[224:227]
v_rcp_f32 v120, v120
v_rcp_f32 v121, v121
v_mfma_f32_16x16x16_bf16 v[228:231], v[200:201], v[40:41], 0
v_mul_f32 v112, v112, v120
v_mul_f32 v113, v113, v120
v_mfma_f32_16x16x16_bf16 v[236:239], v[202:203], v[42:43], 0
v_mul_f32 v114, v114, v120
v_mul_f32 v115, v115, v120
v_mfma_f32_16x16x32_bf16 v[128:131], v[96:99], v[8:11], v[128:131]
v_mul_f32 v116, v116, v121
v_mul_f32 v117, v117, v121
v_mfma_f32_16x16x32_bf16 v[132:135], v[100:103], v[8:11], v[132:135]
v_mul_f32 v118, v118, v121
v_mul_f32 v119, v119, v121
v_mfma_f32_16x16x32_bf16 v[136:139], v[104:107], v[8:11], v[136:139]
v_cvt_pk_bf16_f32 v24, v112, v113
v_cvt_pk_bf16_f32 v25, v114, v115
v_mfma_f32_16x16x32_bf16 v[140:143], v[108:111], v[8:11], v[140:143]
v_cvt_pk_bf16_f32 v26, v116, v117
v_cvt_pk_bf16_f32 v27, v118, v119
s_add_u32 m0, s95, 49152
s_add_u32 s47, s58, 1376256
v_mfma_f32_16x16x32_bf16 v[120:123], v[216:219], v[56:59], v[224:227]
v_rcp_f32 v240, v240
v_rcp_f32 v241, v241
v_mfma_f32_16x16x16_bf16 v[112:115], v[200:201], v[56:57], 0
v_mul_f32 v228, v228, v240
v_mul_f32 v229, v229, v240
v_mfma_f32_16x16x16_bf16 v[116:119], v[202:203], v[58:59], 0
v_mul_f32 v230, v230, v240
v_mul_f32 v231, v231, v240
v_mfma_f32_16x16x32_bf16 v[144:147], v[96:99], v[24:27], v[144:147]
v_mul_f32 v236, v236, v241
v_mul_f32 v237, v237, v241
v_mfma_f32_16x16x32_bf16 v[148:151], v[100:103], v[24:27], v[148:151]
v_mul_f32 v238, v238, v241
v_mul_f32 v239, v239, v241
v_mfma_f32_16x16x32_bf16 v[152:155], v[104:107], v[24:27], v[152:155]
v_cvt_pk_bf16_f32 v40, v228, v229
v_cvt_pk_bf16_f32 v41, v230, v231
v_mfma_f32_16x16x32_bf16 v[156:159], v[108:111], v[24:27], v[156:159]
v_cvt_pk_bf16_f32 v42, v236, v237
v_cvt_pk_bf16_f32 v43, v238, v239
buffer_load_dwordx4 v232, s[20:23], s47 offen offset:0 lds
buffer_load_dwordx4 v233, s[20:23], s47 offen offset:1024 lds
v_mfma_f32_16x16x32_bf16 v[240:243], v[220:223], v[12:15], v[224:227]
v_rcp_f32 v120, v120
v_rcp_f32 v121, v121
v_mfma_f32_16x16x16_bf16 v[228:231], v[204:205], v[12:13], 0
v_mul_f32 v112, v112, v120
v_mul_f32 v113, v113, v120
v_mfma_f32_16x16x16_bf16 v[236:239], v[206:207], v[14:15], 0
v_mul_f32 v114, v114, v120
v_mul_f32 v115, v115, v120
v_mfma_f32_16x16x32_bf16 v[160:163], v[96:99], v[40:43], v[160:163]
v_mul_f32 v116, v116, v121
v_mul_f32 v117, v117, v121
v_mfma_f32_16x16x32_bf16 v[164:167], v[100:103], v[40:43], v[164:167]
v_mul_f32 v118, v118, v121
v_mul_f32 v119, v119, v121
v_mfma_f32_16x16x32_bf16 v[168:171], v[104:107], v[40:43], v[168:171]
v_cvt_pk_bf16_f32 v56, v112, v113
v_cvt_pk_bf16_f32 v57, v114, v115
v_mfma_f32_16x16x32_bf16 v[172:175], v[108:111], v[40:43], v[172:175]
v_cvt_pk_bf16_f32 v58, v116, v117
v_cvt_pk_bf16_f32 v59, v118, v119
buffer_load_dwordx4 v234, s[20:23], s47 offen offset:2048 lds
buffer_load_dwordx4 v235, s[20:23], s47 offen offset:3072 lds
v_mfma_f32_16x16x32_bf16 v[120:123], v[220:223], v[28:31], v[224:227]
v_rcp_f32 v240, v240
v_rcp_f32 v241, v241
v_mfma_f32_16x16x16_bf16 v[112:115], v[204:205], v[28:29], 0
v_mul_f32 v228, v228, v240
v_mul_f32 v229, v229, v240
v_mfma_f32_16x16x16_bf16 v[116:119], v[206:207], v[30:31], 0
v_mul_f32 v230, v230, v240
v_mul_f32 v231, v231, v240
v_mfma_f32_16x16x32_bf16 v[176:179], v[96:99], v[56:59], v[176:179]
v_mul_f32 v236, v236, v241
v_mul_f32 v237, v237, v241
v_mfma_f32_16x16x32_bf16 v[180:183], v[100:103], v[56:59], v[180:183]
v_mul_f32 v238, v238, v241
v_mul_f32 v239, v239, v241
v_mfma_f32_16x16x32_bf16 v[184:187], v[104:107], v[56:59], v[184:187]
v_cvt_pk_bf16_f32 v12, v228, v229
v_cvt_pk_bf16_f32 v13, v230, v231
v_mfma_f32_16x16x32_bf16 v[188:191], v[108:111], v[56:59], v[188:191]
v_cvt_pk_bf16_f32 v14, v236, v237
v_cvt_pk_bf16_f32 v15, v238, v239
s_add_u32 m0, s95, 114688
s_add_u32 s47, s58, 1376384
v_mfma_f32_16x16x32_bf16 v[240:243], v[220:223], v[44:47], v[224:227]
v_rcp_f32 v120, v120
v_rcp_f32 v121, v121
v_mfma_f32_16x16x16_bf16 v[228:231], v[204:205], v[44:45], 0
v_mul_f32 v112, v112, v120
v_mul_f32 v113, v113, v120
v_mfma_f32_16x16x16_bf16 v[236:239], v[206:207], v[46:47], 0
v_mul_f32 v114, v114, v120
v_mul_f32 v115, v115, v120
v_mfma_f32_16x16x32_bf16 v[128:131], a[240:243], v[12:15], v[128:131]
v_mul_f32 v116, v116, v121
v_mul_f32 v117, v117, v121
v_mfma_f32_16x16x32_bf16 v[132:135], a[244:247], v[12:15], v[132:135]
v_mul_f32 v118, v118, v121
v_mul_f32 v119, v119, v121
v_mfma_f32_16x16x32_bf16 v[136:139], a[248:251], v[12:15], v[136:139]
v_cvt_pk_bf16_f32 v28, v112, v113
v_cvt_pk_bf16_f32 v29, v114, v115
v_mfma_f32_16x16x32_bf16 v[140:143], a[252:255], v[12:15], v[140:143]
v_cvt_pk_bf16_f32 v30, v116, v117
v_cvt_pk_bf16_f32 v31, v118, v119
buffer_load_dwordx4 v232, s[20:23], s47 offen offset:0 lds
buffer_load_dwordx4 v233, s[20:23], s47 offen offset:1024 lds
v_mfma_f32_16x16x32_bf16 v[120:123], v[220:223], v[60:63], v[224:227]
v_rcp_f32 v240, v240
v_rcp_f32 v241, v241
v_mfma_f32_16x16x16_bf16 v[112:115], v[204:205], v[60:61], 0
v_mul_f32 v228, v228, v240
v_mul_f32 v229, v229, v240
v_mfma_f32_16x16x16_bf16 v[116:119], v[206:207], v[62:63], 0
v_mul_f32 v230, v230, v240
v_mul_f32 v231, v231, v240
v_mfma_f32_16x16x32_bf16 v[144:147], a[240:243], v[28:31], v[144:147]
v_mul_f32 v236, v236, v241
v_mul_f32 v237, v237, v241
v_mfma_f32_16x16x32_bf16 v[148:151], a[244:247], v[28:31], v[148:151]
v_mul_f32 v238, v238, v241
v_mul_f32 v239, v239, v241
v_mfma_f32_16x16x32_bf16 v[152:155], a[248:251], v[28:31], v[152:155]
v_cvt_pk_bf16_f32 v44, v228, v229
v_cvt_pk_bf16_f32 v45, v230, v231
v_mfma_f32_16x16x32_bf16 v[156:159], a[252:255], v[28:31], v[156:159]
v_cvt_pk_bf16_f32 v46, v236, v237
v_cvt_pk_bf16_f32 v47, v238, v239
buffer_load_dwordx4 v234, s[20:23], s47 offen offset:2048 lds
buffer_load_dwordx4 v235, s[20:23], s47 offen offset:3072 lds
v_mfma_f32_16x16x32_bf16 v[160:163], a[240:243], v[44:47], v[160:163]
v_rcp_f32 v120, v120
v_rcp_f32 v121, v121
v_mfma_f32_16x16x32_bf16 v[164:167], a[244:247], v[44:47], v[164:167]
v_mul_f32 v112, v112, v120
v_mul_f32 v113, v113, v120
v_mfma_f32_16x16x32_bf16 v[168:171], a[248:251], v[44:47], v[168:171]
v_mul_f32 v114, v114, v120
v_mul_f32 v115, v115, v120
v_mfma_f32_16x16x32_bf16 v[172:175], a[252:255], v[44:47], v[172:175]
v_mul_f32 v116, v116, v121
v_mul_f32 v117, v117, v121
v_mul_f32 v118, v118, v121
v_mul_f32 v119, v119, v121
v_cvt_pk_bf16_f32 v60, v112, v113
v_cvt_pk_bf16_f32 v61, v114, v115
v_cvt_pk_bf16_f32 v62, v116, v117
v_cvt_pk_bf16_f32 v63, v118, v119
s_nop 1
v_mfma_f32_16x16x32_bf16 v[176:179], a[240:243], v[60:63], v[176:179]
s_add_u32 s54, s48, 1
s_and_b32 s54, s54, 3
v_mfma_f32_16x16x32_bf16 v[180:183], a[244:247], v[60:63], v[180:183]
s_mul_i32 s54, s54, 6144
s_add_u32 s54, s54, 131072
v_mfma_f32_16x16x32_bf16 v[184:187], a[248:251], v[60:63], v[184:187]
v_add_u32 v225, s54, v255
s_add_u32 s54, s48, 2
v_mfma_f32_16x16x32_bf16 v[188:191], a[252:255], v[60:63], v[188:191]
s_and_b32 s54, s54, 3
s_mul_i32 s54, s54, 6144
s_add_u32 s54, s54, 133120
v_add_u32 v226, s54, v255
s_add_u32 s54, s48, 3
s_and_b32 s54, s54, 3
s_mul_i32 s54, s54, 6144
s_add_u32 s54, s54, 135168
v_add_u32 v227, s54, v255
s_mul_i32 s54, s48, 6144
s_add_u32 s54, s54, 131072
v_add_u32 v224, s54, v255
v_cvt_pk_bf16_f32 v144, v144, v145
v_cvt_pk_bf16_f32 v145, v146, v147
v_cvt_pk_bf16_f32 v146, v148, v149
v_cvt_pk_bf16_f32 v147, v150, v151
ds_write_b128 v225, v[144:147] offset:0
v_cvt_pk_bf16_f32 v152, v152, v153
v_cvt_pk_bf16_f32 v153, v154, v155
v_cvt_pk_bf16_f32 v154, v156, v157
v_cvt_pk_bf16_f32 v155, v158, v159
ds_write_b128 v225, v[152:155] offset:1024
v_cvt_pk_bf16_f32 v160, v160, v161
v_cvt_pk_bf16_f32 v161, v162, v163
v_cvt_pk_bf16_f32 v162, v164, v165
v_cvt_pk_bf16_f32 v163, v166, v167
ds_write_b128 v226, v[160:163] offset:0
v_cvt_pk_bf16_f32 v168, v168, v169
v_cvt_pk_bf16_f32 v169, v170, v171
v_cvt_pk_bf16_f32 v170, v172, v173
v_cvt_pk_bf16_f32 v171, v174, v175
ds_write_b128 v226, v[168:171] offset:1024
v_cvt_pk_bf16_f32 v176, v176, v177
v_cvt_pk_bf16_f32 v177, v178, v179
v_cvt_pk_bf16_f32 v178, v180, v181
v_cvt_pk_bf16_f32 v179, v182, v183
ds_write_b128 v227, v[176:179] offset:0
v_cvt_pk_bf16_f32 v184, v184, v185
v_cvt_pk_bf16_f32 v185, v186, v187
v_cvt_pk_bf16_f32 v186, v188, v189
v_cvt_pk_bf16_f32 v187, v190, v191
ds_write_b128 v227, v[184:187] offset:1024
s_lshl_b32 s54, s49, 2
s_add_u32 s54, s54, s48
s_mul_i32 s92, s54, 16384
s_lshl_b32 s56, s50, 11
s_add_u32 s92, s92, s56
s_add_u32 s92, s92, 5242880
s_lshl_b32 s54, s54, 10
s_lshr_b32 s55, s50, 1
s_lshl_b32 s55, s55, 8
s_add_u32 s54, s54, s55
s_and_b32 s55, s50, 1
s_lshl_b32 s55, s55, 3
s_add_u32 s54, s54, s55
s_add_u32 s93, s54, 262144
s_mov_b32 s88, 0xaaaaaaaa
s_mov_b32 s89, s88
s_mov_b32 s90, 0xcccccccc
s_mov_b32 s91, s90
v_and_b32 v228, 0xff, v255
s_lshl_b32 s59, s49, 7
s_add_u32 s59, s59, 69632
s_lshl_b32 s56, s50, 2
s_add_u32 s56, s56, s48
s_lshl_b32 s56, s56, 2
s_add_u32 s56, s56, s59
s_waitcnt lgkmcnt(0)
s_barrier
ds_read_b128 v[144:147], v224 offset:0
ds_read_b128 v[148:151], v224 offset:1024
ds_read_b128 v[152:155], v224 offset:2048
ds_read_b128 v[156:159], v224 offset:3072
ds_read_b128 v[160:163], v224 offset:4096
ds_read_b128 v[164:167], v224 offset:5120
s_waitcnt lgkmcnt(5)
v_mfma_f32_16x16x16_bf16 v[128:131], v[126:127], v[144:145], v[128:131]
v_mfma_f32_16x16x16_bf16 v[132:135], v[126:127], v[146:147], v[132:135]
s_waitcnt lgkmcnt(4)
v_mfma_f32_16x16x16_bf16 v[136:139], v[126:127], v[148:149], v[136:139]
v_mfma_f32_16x16x16_bf16 v[140:143], v[126:127], v[150:151], v[140:143]
s_waitcnt lgkmcnt(3)
v_mfma_f32_16x16x16_bf16 v[128:131], v[126:127], v[152:153], v[128:131]
v_mfma_f32_16x16x16_bf16 v[132:135], v[126:127], v[154:155], v[132:135]
s_waitcnt lgkmcnt(2)
v_mfma_f32_16x16x16_bf16 v[136:139], v[126:127], v[156:157], v[136:139]
v_mfma_f32_16x16x16_bf16 v[140:143], v[126:127], v[158:159], v[140:143]
s_waitcnt lgkmcnt(1)
v_mfma_f32_16x16x16_bf16 v[128:131], v[126:127], v[160:161], v[128:131]
v_mfma_f32_16x16x16_bf16 v[132:135], v[126:127], v[162:163], v[132:135]
s_waitcnt lgkmcnt(0)
v_mfma_f32_16x16x16_bf16 v[136:139], v[126:127], v[164:165], v[136:139]
v_mfma_f32_16x16x16_bf16 v[140:143], v[126:127], v[166:167], v[140:143]
s_nop 3
v_cvt_pk_bf16_f32 v244, v128, v129
v_cvt_pk_bf16_f32 v245, v130, v131
v_cvt_pk_bf16_f32 v246, v132, v133
v_cvt_pk_bf16_f32 v247, v134, v135
buffer_store_dwordx4 v[244:247], v255, s[28:31], s92 offen offset:0
s_nop 0
v_mfma_f32_16x16x32_bf16 v[180:183], v[244:247], v[244:247], 0
v_mfma_f32_16x16x32_bf16 v[176:179], a[236:239], v[244:247], 0
v_cvt_pk_bf16_f32 v248, v136, v137
v_cvt_pk_bf16_f32 v249, v138, v139
v_cvt_pk_bf16_f32 v250, v140, v141
v_cvt_pk_bf16_f32 v251, v142, v143
buffer_store_dwordx4 v[248:251], v255, s[28:31], s92 offen offset:1024
s_nop 0
v_mfma_f32_16x16x32_bf16 v[180:183], v[248:251], v[248:251], v[180:183]
v_mfma_f32_16x16x32_bf16 v[176:179], a[236:239], v[248:251], v[176:179]
s_nop 6
v_cndmask_b32_e64 v180, v180, v181, s[88:89]
v_cndmask_b32_e64 v182, v182, v183, s[88:89]
v_cndmask_b32_e64 v177, v180, v182, s[90:91]
s_mov_b32 exec_lo, 0x00f0000f
s_mov_b32 exec_hi, 0xf0000f00
buffer_store_dwordx2 v[176:177], v228, s[28:31], s93 offen
s_mov_b64 exec, -1
s_waitcnt vmcnt(0)
s_mov_b64 exec, 1
v_mov_b32 v243, 1
s_cmp_lg_u32 s46, 0
s_cbranch_scc1 SG34
buffer_store_dword v243, off, s[28:31], s56
s_branch SG33
SG34:
buffer_wbl2 sc1
s_waitcnt vmcnt(0)
buffer_store_dword v243, off, s[28:31], s56 sc1
SG33:
s_mov_b64 exec, -1
s_barrier
s_lshl_b32 s54, s48, 1
s_lshl_b32 s55, s51, 3
s_add_u32 s56, s54, s55
s_lshl_b32 s63, s56, 10
s_add_u32 s63, s63, 262144
s_mul_i32 s62, s56, 16384
s_add_u32 s62, s62, 5242880
v_add_u32 v240, 16384, v255
s_mul_i32 s56, s56, 57344
s_lshl_b32 s55, s52, 12
s_add_u32 s56, s56, s55
s_add_u32 s64, s56, 11534336
s_add_u32 s65, s64, 57344
s_mov_b32 s90, 0x409d30fc
s_mov_b32 s91, s90
s_mov_b32 s92, 0x3eeff558
s_mov_b32 s93, s92
v_lshrrev_b32 v232, 8, v255
v_lshlrev_b32 v232, 4, v232
v_add_u32 v232, 160768, v232
v_xor_b32 v224, 0, v254
v_xor_b32 v225, 32, v254
v_xor_b32 v226, 64, v254
v_xor_b32 v227, 96, v254
s_cmp_ge_u32 s52, 14
s_cbranch_scc1 ID35
s_lshl_b32 s54, s51, 1
s_lshr_b32 s55, s48, 1
s_add_u32 s54, s54, s55
s_lshl_b32 s54, s54, 7
s_and_b32 s55, s48, 1
s_lshl_b32 s55, s55, 3
s_add_u32 s54, s54, s55
s_add_u32 s54, s54, 69632
v_bfe_u32 v231, v255, 5, 3
v_lshlrev_b32 v231, 4, v231
v_bfe_u32 v230, v255, 4, 1
v_lshl_add_u32 v231, v230, 2, v231
s_mov_b32 s57, 100000
PL37:
buffer_load_dword v230, v231, s[28:31], s54 offen sc1
s_waitcnt vmcnt(0)
v_cmp_ne_u32 vcc, 1, v230
s_sub_u32 s57, s57, 1
s_nop 3
s_cbranch_vccz PL38
s_cmp_lg_u32 s57, 0
s_cbranch_scc1 PL37
PL38:
buffer_load_dwordx4 v[0:3], v255, s[28:31], s62 offen offset:0 sc1
buffer_load_dwordx4 v[64:67], v240, s[28:31], s62 offen offset:0 sc1
buffer_load_dwordx4 v[4:7], v255, s[28:31], s62 offen offset:1024 sc1
buffer_load_dwordx4 v[68:71], v240, s[28:31], s62 offen offset:1024 sc1
buffer_load_dwordx4 v[8:11], v255, s[28:31], s62 offen offset:2048 sc1
buffer_load_dwordx4 v[72:75], v240, s[28:31], s62 offen offset:2048 sc1
buffer_load_dwordx4 v[208:211], v255, s[28:31], s63 offen offset:0 sc1
buffer_load_dwordx4 v[212:215], v255, s[28:31], s63 offen offset:1024 sc1
v_add_u32 v228, 65536, v224
v_add_u32 v229, 65536, v225
v_add_u32 v230, 65536, v226
v_add_u32 v231, 65536, v227
ds_read_b64_tr_b16 v[192:193], v224 offset:0
ds_read_b64_tr_b16 v[194:195], v224 offset:2048
ds_read_b64_tr_b16 v[196:197], v225 offset:0
ds_read_b64_tr_b16 v[198:199], v225 offset:2048
ds_read_b64_tr_b16 v[200:201], v226 offset:0
ds_read_b64_tr_b16 v[202:203], v226 offset:2048
ds_read_b64_tr_b16 v[204:205], v227 offset:0
ds_read_b64_tr_b16 v[206:207], v227 offset:2048
ds_read_b64_tr_b16 a[240:241], v228 offset:0
ds_read_b64_tr_b16 a[242:243], v228 offset:2048
ds_read_b64_tr_b16 a[244:245], v229 offset:0
ds_read_b64_tr_b16 a[246:247], v229 offset:2048
s_waitcnt vmcnt(6)
s_waitcnt lgkmcnt(10)
v_mfma_f32_16x16x32_bf16 v[128:131], v[192:195], v[0:3], 0
ds_read_b64_tr_b16 a[248:249], v230 offset:0
v_mfma_f32_16x16x32_bf16 v[160:163], v[192:195], v[64:67], 0
ds_read_b64_tr_b16 a[250:251], v230 offset:2048
s_waitcnt lgkmcnt(10)
v_mfma_f32_16x16x32_bf16 v[132:135], v[196:199], v[0:3], 0
ds_read_b64_tr_b16 a[252:253], v231 offset:0
v_mfma_f32_16x16x32_bf16 v[164:167], v[196:199], v[64:67], 0
ds_read_b64_tr_b16 a[254:255], v231 offset:2048
s_waitcnt lgkmcnt(10)
v_mfma_f32_16x16x32_bf16 v[136:139], v[200:203], v[0:3], 0
ds_read_b64_tr_b16 v[192:193], v224 offset:4096
buffer_load_dwordx4 v[12:15], v255, s[28:31], s62 offen offset:3072 sc1
v_mfma_f32_16x16x32_bf16 v[168:171], v[200:203], v[64:67], 0
ds_read_b64_tr_b16 v[194:195], v224 offset:6144
s_waitcnt lgkmcnt(10)
v_mfma_f32_16x16x32_bf16 v[140:143], v[204:207], v[0:3], 0
ds_read_b64_tr_b16 v[196:197], v225 offset:4096
v_mfma_f32_16x16x32_bf16 v[172:175], v[204:207], v[64:67], 0
ds_read_b64_tr_b16 v[198:199], v225 offset:6144
s_waitcnt lgkmcnt(10)
v_mfma_f32_16x16x32_bf16 v[144:147], a[240:243], v[0:3], 0
ds_read_b64_tr_b16 v[200:201], v226 offset:4096
buffer_load_dwordx4 v[76:79], v240, s[28:31], s62 offen offset:3072 sc1
v_mfma_f32_16x16x32_bf16 v[176:179], a[240:243], v[64:67], 0
ds_read_b64_tr_b16 v[202:203], v226 offset:6144
s_waitcnt lgkmcnt(10)
v_mfma_f32_16x16x32_bf16 v[148:151], a[244:247], v[0:3], 0
ds_read_b64_tr_b16 v[204:205], v227 offset:4096
v_mfma_f32_16x16x32_bf16 v[180:183], a[244:247], v[64:67], 0
ds_read_b64_tr_b16 v[206:207], v227 offset:6144
s_waitcnt lgkmcnt(10)
v_mfma_f32_16x16x32_bf16 v[152:155], a[248:251], v[0:3], 0
ds_read_b64_tr_b16 a[240:241], v228 offset:4096
v_mfma_f32_16x16x32_bf16 v[184:187], a[248:251], v[64:67], 0
ds_read_b64_tr_b16 a[242:243], v228 offset:6144
s_waitcnt lgkmcnt(10)
v_mfma_f32_16x16x32_bf16 v[156:159], a[252:255], v[0:3], 0
ds_read_b64_tr_b16 a[244:245], v229 offset:4096
s_add_u32 s62, s62, 4096
v_mfma_f32_16x16x32_bf16 v[188:191], a[252:255], v[64:67], 0
ds_read_b64_tr_b16 a[246:247], v229 offset:6144
s_waitcnt vmcnt(6)
s_waitcnt lgkmcnt(10)
v_mfma_f32_16x16x32_bf16 v[128:131], v[192:195], v[4:7], v[128:131]
ds_read_b64_tr_b16 a[248:249], v230 offset:4096
v_mfma_f32_16x16x32_bf16 v[160:163], v[192:195], v[68:71], v[160:163]
ds_read_b64_tr_b16 a[250:251], v230 offset:6144
s_waitcnt lgkmcnt(10)
v_mfma_f32_16x16x32_bf16 v[132:135], v[196:199], v[4:7], v[132:135]
ds_read_b64_tr_b16 a[252:253], v231 offset:4096
buffer_load_dwordx4 v[16:19], v255, s[28:31], s62 offen offset:0 sc1
v_mfma_f32_16x16x32_bf16 v[164:167], v[196:199], v[68:71], v[164:167]
ds_read_b64_tr_b16 a[254:255], v231 offset:6144
s_waitcnt lgkmcnt(10)
v_mfma_f32_16x16x32_bf16 v[136:139], v[200:203], v[4:7], v[136:139]
ds_read_b64_tr_b16 v[192:193], v224 offset:8192
v_mfma_f32_16x16x32_bf16 v[168:171], v[200:203], v[68:71], v[168:171]
ds_read_b64_tr_b16 v[194:195], v224 offset:10240
s_waitcnt lgkmcnt(10)
v_mfma_f32_16x16x32_bf16 v[140:143], v[204:207], v[4:7], v[140:143]
ds_read_b64_tr_b16 v[196:197], v225 offset:8192
v_mfma_f32_16x16x32_bf16 v[172:175], v[204:207], v[68:71], v[172:175]
ds_read_b64_tr_b16 v[198:199], v225 offset:10240
s_waitcnt lgkmcnt(10)
v_mfma_f32_16x16x32_bf16 v[144:147], a[240:243], v[4:7], v[144:147]
ds_read_b64_tr_b16 v[200:201], v226 offset:8192
buffer_load_dwordx4 v[80:83], v240, s[28:31], s62 offen offset:0 sc1
v_mfma_f32_16x16x32_bf16 v[176:179], a[240:243], v[68:71], v[176:179]
ds_read_b64_tr_b16 v[202:203], v226 offset:10240
s_waitcnt lgkmcnt(10)
v_mfma_f32_16x16x32_bf16 v[148:151], a[244:247], v[4:7], v[148:151]
ds_read_b64_tr_b16 v[204:205], v227 offset:8192
v_mfma_f32_16x16x32_bf16 v[180:183], a[244:247], v[68:71], v[180:183]
ds_read_b64_tr_b16 v[206:207], v227 offset:10240
s_waitcnt lgkmcnt(10)
v_mfma_f32_16x16x32_bf16 v[152:155], a[248:251], v[4:7], v[152:155]
ds_read_b64_tr_b16 a[240:241], v228 offset:8192
buffer_load_dwordx4 v[20:23], v255, s[28:31], s62 offen offset:1024 sc1
v_mfma_f32_16x16x32_bf16 v[184:187], a[248:251], v[68:71], v[184:187]
ds_read_b64_tr_b16 a[242:243], v228 offset:10240
s_waitcnt lgkmcnt(10)
v_mfma_f32_16x16x32_bf16 v[156:159], a[252:255], v[4:7], v[156:159]
ds_read_b64_tr_b16 a[244:245], v229 offset:8192
v_mfma_f32_16x16x32_bf16 v[188:191], a[252:255], v[68:71], v[188:191]
ds_read_b64_tr_b16 a[246:247], v229 offset:10240
s_waitcnt vmcnt(7)
s_waitcnt lgkmcnt(10)
v_mfma_f32_16x16x32_bf16 v[128:131], v[192:195], v[8:11], v[128:131]
ds_read_b64_tr_b16 a[248:249], v230 offset:8192
v_mfma_f32_16x16x32_bf16 v[160:163], v[192:195], v[72:75], v[160:163]
ds_read_b64_tr_b16 a[250:251], v230 offset:10240
s_waitcnt lgkmcnt(10)
v_mfma_f32_16x16x32_bf16 v[132:135], v[196:199], v[8:11], v[132:135]
ds_read_b64_tr_b16 a[252:253], v231 offset:8192
buffer_load_dwordx4 v[84:87], v240, s[28:31], s62 offen offset:1024 sc1
v_mfma_f32_16x16x32_bf16 v[164:167], v[196:199], v[72:75], v[164:167]
ds_read_b64_tr_b16 a[254:255], v231 offset:10240
s_waitcnt lgkmcnt(10)
v_mfma_f32_16x16x32_bf16 v[136:139], v[200:203], v[8:11], v[136:139]
ds_read_b64_tr_b16 v[192:193], v224 offset:12288
v_mfma_f32_16x16x32_bf16 v[168:171], v[200:203], v[72:75], v[168:171]
ds_read_b64_tr_b16 v[194:195], v224 offset:14336
s_waitcnt lgkmcnt(10)
v_mfma_f32_16x16x32_bf16 v[140:143], v[204:207], v[8:11], v[140:143]
ds_read_b64_tr_b16 v[196:197], v225 offset:12288
buffer_load_dwordx4 v[24:27], v255, s[28:31], s62 offen offset:2048 sc1
v_mfma_f32_16x16x32_bf16 v[172:175], v[204:207], v[72:75], v[172:175]
ds_read_b64_tr_b16 v[198:199], v225 offset:14336
s_waitcnt lgkmcnt(10)
v_mfma_f32_16x16x32_bf16 v[144:147], a[240:243], v[8:11], v[144:147]
ds_read_b64_tr_b16 v[200:201], v226 offset:12288
v_mfma_f32_16x16x32_bf16 v[176:179], a[240:243], v[72:75], v[176:179]
ds_read_b64_tr_b16 v[202:203], v226 offset:14336
s_waitcnt lgkmcnt(10)
v_mfma_f32_16x16x32_bf16 v[148:151], a[244:247], v[8:11], v[148:151]
ds_read_b64_tr_b16 v[204:205], v227 offset:12288
v_mfma_f32_16x16x32_bf16 v[180:183], a[244:247], v[72:75], v[180:183]
ds_read_b64_tr_b16 v[206:207], v227 offset:14336
s_waitcnt lgkmcnt(10)
v_mfma_f32_16x16x32_bf16 v[152:155], a[248:251], v[8:11], v[152:155]
ds_read_b64_tr_b16 a[240:241], v228 offset:12288
buffer_load_dwordx4 v[88:91], v240, s[28:31], s62 offen offset:2048 sc1
v_mfma_f32_16x16x32_bf16 v[184:187], a[248:251], v[72:75], v[184:187]
ds_read_b64_tr_b16 a[242:243], v228 offset:14336
s_waitcnt lgkmcnt(10)
v_mfma_f32_16x16x32_bf16 v[156:159], a[252:255], v[8:11], v[156:159]
ds_read_b64_tr_b16 a[244:245], v229 offset:12288
v_mfma_f32_16x16x32_bf16 v[188:191], a[252:255], v[72:75], v[188:191]
ds_read_b64_tr_b16 a[246:247], v229 offset:14336
s_waitcnt vmcnt(6)
s_waitcnt lgkmcnt(10)
v_mfma_f32_16x16x32_bf16 v[128:131], v[192:195], v[12:15], v[128:131]
ds_read_b64_tr_b16 a[248:249], v230 offset:12288
buffer_load_dwordx4 v[28:31], v255, s[28:31], s62 offen offset:3072 sc1
v_mfma_f32_16x16x32_bf16 v[160:163], v[192:195], v[76:79], v[160:163]
ds_read_b64_tr_b16 a[250:251], v230 offset:14336
s_waitcnt lgkmcnt(10)
v_mfma_f32_16x16x32_bf16 v[132:135], v[196:199], v[12:15], v[132:135]
ds_read_b64_tr_b16 a[252:253], v231 offset:12288
v_mfma_f32_16x16x32_bf16 v[164:167], v[196:199], v[76:79], v[164:167]
ds_read_b64_tr_b16 a[254:255], v231 offset:14336
s_waitcnt lgkmcnt(10)
v_mfma_f32_16x16x32_bf16 v[136:139], v[200:203], v[12:15], v[136:139]
ds_read_b64_tr_b16 v[192:193], v224 offset:16384
v_mfma_f32_16x16x32_bf16 v[168:171], v[200:203], v[76:79], v[168:171]
ds_read_b64_tr_b16 v[194:195], v224 offset:18432
s_waitcnt lgkmcnt(10)
v_mfma_f32_16x16x32_bf16 v[140:143], v[204:207], v[12:15], v[140:143]
ds_read_b64_tr_b16 v[196:197], v225 offset:16384
buffer_load_dwordx4 v[92:95], v240, s[28:31], s62 offen offset:3072 sc1
v_mfma_f32_16x16x32_bf16 v[172:175], v[204:207], v[76:79], v[172:175]
ds_read_b64_tr_b16 v[198:199], v225 offset:18432
s_waitcnt lgkmcnt(10)
v_mfma_f32_16x16x32_bf16 v[144:147], a[240:243], v[12:15], v[144:147]
ds_read_b64_tr_b16 v[200:201], v226 offset:16384
v_mfma_f32_16x16x32_bf16 v[176:179], a[240:243], v[76:79], v[176:179]
ds_read_b64_tr_b16 v[202:203], v226 offset:18432
s_waitcnt lgkmcnt(10)
v_mfma_f32_16x16x32_bf16 v[148:151], a[244:247], v[12:15], v[148:151]
ds_read_b64_tr_b16 v[204:205], v227 offset:16384
s_add_u32 s62, s62, 4096
v_mfma_f32_16x16x32_bf16 v[180:183], a[244:247], v[76:79], v[180:183]
ds_read_b64_tr_b16 v[206:207], v227 offset:18432
s_waitcnt lgkmcnt(10)
v_mfma_f32_16x16x32_bf16 v[152:155], a[248:251], v[12:15], v[152:155]
ds_read_b64_tr_b16 a[240:241], v228 offset:16384
v_mfma_f32_16x16x32_bf16 v[184:187], a[248:251], v[76:79], v[184:187]
ds_read_b64_tr_b16 a[242:243], v228 offset:18432
s_waitcnt lgkmcnt(10)
v_mfma_f32_16x16x32_bf16 v[156:159], a[252:255], v[12:15], v[156:159]
ds_read_b64_tr_b16 a[244:245], v229 offset:16384
v_mfma_f32_16x16x32_bf16 v[188:191], a[252:255], v[76:79], v[188:191]
ds_read_b64_tr_b16 a[246:247], v229 offset:18432
s_waitcnt vmcnt(6)
s_waitcnt lgkmcnt(10)
v_mfma_f32_16x16x32_bf16 v[128:131], v[192:195], v[16:19], v[128:131]
ds_read_b64_tr_b16 a[248:249], v230 offset:16384
buffer_load_dwordx4 v[32:35], v255, s[28:31], s62 offen offset:0 sc1
v_mfma_f32_16x16x32_bf16 v[160:163], v[192:195], v[80:83], v[160:163]
ds_read_b64_tr_b16 a[250:251], v230 offset:18432
s_waitcnt lgkmcnt(10)
v_mfma_f32_16x16x32_bf16 v[132:135], v[196:199], v[16:19], v[132:135]
ds_read_b64_tr_b16 a[252:253], v231 offset:16384
v_mfma_f32_16x16x32_bf16 v[164:167], v[196:199], v[80:83], v[164:167]
ds_read_b64_tr_b16 a[254:255], v231 offset:18432
s_waitcnt lgkmcnt(10)
v_mfma_f32_16x16x32_bf16 v[136:139], v[200:203], v[16:19], v[136:139]
ds_read_b64_tr_b16 v[192:193], v224 offset:20480
buffer_load_dwordx4 v[96:99], v240, s[28:31], s62 offen offset:0 sc1
v_mfma_f32_16x16x32_bf16 v[168:171], v[200:203], v[80:83], v[168:171]
ds_read_b64_tr_b16 v[194:195], v224 offset:22528
s_waitcnt lgkmcnt(10)
v_mfma_f32_16x16x32_bf16 v[140:143], v[204:207], v[16:19], v[140:143]
ds_read_b64_tr_b16 v[196:197], v225 offset:20480
v_mfma_f32_16x16x32_bf16 v[172:175], v[204:207], v[80:83], v[172:175]
ds_read_b64_tr_b16 v[198:199], v225 offset:22528
s_waitcnt lgkmcnt(10)
v_mfma_f32_16x16x32_bf16 v[144:147], a[240:243], v[16:19], v[144:147]
ds_read_b64_tr_b16 v[200:201], v226 offset:20480
v_mfma_f32_16x16x32_bf16 v[176:179], a[240:243], v[80:83], v[176:179]
ds_read_b64_tr_b16 v[202:203], v226 offset:22528
s_waitcnt lgkmcnt(10)
v_mfma_f32_16x16x32_bf16 v[148:151], a[244:247], v[16:19], v[148:151]
ds_read_b64_tr_b16 v[204:205], v227 offset:20480
buffer_load_dwordx4 v[36:39], v255, s[28:31], s62 offen offset:1024 sc1
v_mfma_f32_16x16x32_bf16 v[180:183], a[244:247], v[80:83], v[180:183]
ds_read_b64_tr_b16 v[206:207], v227 offset:22528
s_waitcnt lgkmcnt(10)
v_mfma_f32_16x16x32_bf16 v[152:155], a[248:251], v[16:19], v[152:155]
ds_read_b64_tr_b16 a[240:241], v228 offset:20480
v_mfma_f32_16x16x32_bf16 v[184:187], a[248:251], v[80:83], v[184:187]
ds_read_b64_tr_b16 a[242:243], v228 offset:22528
s_waitcnt lgkmcnt(10)
v_mfma_f32_16x16x32_bf16 v[156:159], a[252:255], v[16:19], v[156:159]
ds_read_b64_tr_b16 a[244:245], v229 offset:20480
buffer_load_dwordx4 v[100:103], v240, s[28:31], s62 offen offset:1024 sc1
v_mfma_f32_16x16x32_bf16 v[188:191], a[252:255], v[80:83], v[188:191]
ds_read_b64_tr_b16 a[246:247], v229 offset:22528
s_waitcnt vmcnt(8)
s_waitcnt lgkmcnt(10)
v_mfma_f32_16x16x32_bf16 v[128:131], v[192:195], v[20:23], v[128:131]
ds_read_b64_tr_b16 a[248:249], v230 offset:20480
v_mfma_f32_16x16x32_bf16 v[160:163], v[192:195], v[84:87], v[160:163]
ds_read_b64_tr_b16 a[250:251], v230 offset:22528
s_waitcnt lgkmcnt(10)
v_mfma_f32_16x16x32_bf16 v[132:135], v[196:199], v[20:23], v[132:135]
ds_read_b64_tr_b16 a[252:253], v231 offset:20480
v_mfma_f32_16x16x32_bf16 v[164:167], v[196:199], v[84:87], v[164:167]
ds_read_b64_tr_b16 a[254:255], v231 offset:22528
s_waitcnt lgkmcnt(10)
v_mfma_f32_16x16x32_bf16 v[136:139], v[200:203], v[20:23], v[136:139]
ds_read_b64_tr_b16 v[192:193], v224 offset:24576
buffer_load_dwordx4 v[40:43], v255, s[28:31], s62 offen offset:2048 sc1
v_mfma_f32_16x16x32_bf16 v[168:171], v[200:203], v[84:87], v[168:171]
ds_read_b64_tr_b16 v[194:195], v224 offset:26624
s_waitcnt lgkmcnt(10)
v_mfma_f32_16x16x32_bf16 v[140:143], v[204:207], v[20:23], v[140:143]
ds_read_b64_tr_b16 v[196:197], v225 offset:24576
v_mfma_f32_16x16x32_bf16 v[172:175], v[204:207], v[84:87], v[172:175]
ds_read_b64_tr_b16 v[198:199], v225 offset:26624
s_waitcnt lgkmcnt(10)
v_mfma_f32_16x16x32_bf16 v[144:147], a[240:243], v[20:23], v[144:147]
ds_read_b64_tr_b16 v[200:201], v226 offset:24576
buffer_load_dwordx4 v[104:107], v240, s[28:31], s62 offen offset:2048 sc1
v_mfma_f32_16x16x32_bf16 v[176:179], a[240:243], v[84:87], v[176:179]
ds_read_b64_tr_b16 v[202:203], v226 offset:26624
s_waitcnt lgkmcnt(10)
v_mfma_f32_16x16x32_bf16 v[148:151], a[244:247], v[20:23], v[148:151]
ds_read_b64_tr_b16 v[204:205], v227 offset:24576
v_mfma_f32_16x16x32_bf16 v[180:183], a[244:247], v[84:87], v[180:183]
ds_read_b64_tr_b16 v[206:207], v227 offset:26624
s_waitcnt lgkmcnt(10)
v_mfma_f32_16x16x32_bf16 v[152:155], a[248:251], v[20:23], v[152:155]
ds_read_b64_tr_b16 a[240:241], v228 offset:24576
v_mfma_f32_16x16x32_bf16 v[184:187], a[248:251], v[84:87], v[184:187]
ds_read_b64_tr_b16 a[242:243], v228 offset:26624
s_waitcnt lgkmcnt(10)
v_mfma_f32_16x16x32_bf16 v[156:159], a[252:255], v[20:23], v[156:159]
ds_read_b64_tr_b16 a[244:245], v229 offset:24576
buffer_load_dwordx4 v[44:47], v255, s[28:31], s62 offen offset:3072 sc1
v_mfma_f32_16x16x32_bf16 v[188:191], a[252:255], v[84:87], v[188:191]
ds_read_b64_tr_b16 a[246:247], v229 offset:26624
s_waitcnt vmcnt(9)
s_waitcnt lgkmcnt(10)
v_mfma_f32_16x16x32_bf16 v[128:131], v[192:195], v[24:27], v[128:131]
ds_read_b64_tr_b16 a[248:249], v230 offset:24576
v_mfma_f32_16x16x32_bf16 v[160:163], v[192:195], v[88:91], v[160:163]
ds_read_b64_tr_b16 a[250:251], v230 offset:26624
s_waitcnt lgkmcnt(10)
v_mfma_f32_16x16x32_bf16 v[132:135], v[196:199], v[24:27], v[132:135]
ds_read_b64_tr_b16 a[252:253], v231 offset:24576
buffer_load_dwordx4 v[108:111], v240, s[28:31], s62 offen offset:3072 sc1
v_mfma_f32_16x16x32_bf16 v[164:167], v[196:199], v[88:91], v[164:167]
ds_read_b64_tr_b16 a[254:255], v231 offset:26624
s_waitcnt lgkmcnt(10)
v_mfma_f32_16x16x32_bf16 v[136:139], v[200:203], v[24:27], v[136:139]
ds_read_b64_tr_b16 v[192:193], v224 offset:28672
v_mfma_f32_16x16x32_bf16 v[168:171], v[200:203], v[88:91], v[168:171]
ds_read_b64_tr_b16 v[194:195], v224 offset:30720
s_waitcnt lgkmcnt(10)
v_mfma_f32_16x16x32_bf16 v[140:143], v[204:207], v[24:27], v[140:143]
ds_read_b64_tr_b16 v[196:197], v225 offset:28672
v_mfma_f32_16x16x32_bf16 v[172:175], v[204:207], v[88:91], v[172:175]
ds_read_b64_tr_b16 v[198:199], v225 offset:30720
s_waitcnt lgkmcnt(10)
v_mfma_f32_16x16x32_bf16 v[144:147], a[240:243], v[24:27], v[144:147]
ds_read_b64_tr_b16 v[200:201], v226 offset:28672
s_add_u32 s62, s62, 4096
v_mfma_f32_16x16x32_bf16 v[176:179], a[240:243], v[88:91], v[176:179]
ds_read_b64_tr_b16 v[202:203], v226 offset:30720
s_waitcnt lgkmcnt(10)
v_mfma_f32_16x16x32_bf16 v[148:151], a[244:247], v[24:27], v[148:151]
ds_read_b64_tr_b16 v[204:205], v227 offset:28672
v_mfma_f32_16x16x32_bf16 v[180:183], a[244:247], v[88:91], v[180:183]
ds_read_b64_tr_b16 v[206:207], v227 offset:30720
s_waitcnt lgkmcnt(10)
v_mfma_f32_16x16x32_bf16 v[152:155], a[248:251], v[24:27], v[152:155]
ds_read_b64_tr_b16 a[240:241], v228 offset:28672
buffer_load_dwordx4 v[48:51], v255, s[28:31], s62 offen offset:0 sc1
v_mfma_f32_16x16x32_bf16 v[184:187], a[248:251], v[88:91], v[184:187]
ds_read_b64_tr_b16 a[242:243], v228 offset:30720
s_waitcnt lgkmcnt(10)
v_mfma_f32_16x16x32_bf16 v[156:159], a[252:255], v[24:27], v[156:159]
ds_read_b64_tr_b16 a[244:245], v229 offset:28672
v_mfma_f32_16x16x32_bf16 v[188:191], a[252:255], v[88:91], v[188:191]
ds_read_b64_tr_b16 a[246:247], v229 offset:30720
s_waitcnt vmcnt(9)
s_waitcnt lgkmcnt(10)
v_mfma_f32_16x16x32_bf16 v[128:131], v[192:195], v[28:31], v[128:131]
ds_read_b64_tr_b16 a[248:249], v230 offset:28672
v_mfma_f32_16x16x32_bf16 v[160:163], v[192:195], v[92:95], v[160:163]
ds_read_b64_tr_b16 a[250:251], v230 offset:30720
s_waitcnt lgkmcnt(10)
v_mfma_f32_16x16x32_bf16 v[132:135], v[196:199], v[28:31], v[132:135]
ds_read_b64_tr_b16 a[252:253], v231 offset:28672
buffer_load_dwordx4 v[112:115], v240, s[28:31], s62 offen offset:0 sc1
v_mfma_f32_16x16x32_bf16 v[164:167], v[196:199], v[92:95], v[164:167]
ds_read_b64_tr_b16 a[254:255], v231 offset:30720
s_waitcnt lgkmcnt(10)
v_mfma_f32_16x16x32_bf16 v[136:139], v[200:203], v[28:31], v[136:139]
ds_read_b64_tr_b16 v[192:193], v224 offset:32768
v_mfma_f32_16x16x32_bf16 v[168:171], v[200:203], v[92:95], v[168:171]
ds_read_b64_tr_b16 v[194:195], v224 offset:34816
s_waitcnt lgkmcnt(10)
v_mfma_f32_16x16x32_bf16 v[140:143], v[204:207], v[28:31], v[140:143]
ds_read_b64_tr_b16 v[196:197], v225 offset:32768
buffer_load_dwordx4 v[52:55], v255, s[28:31], s62 offen offset:1024 sc1
v_mfma_f32_16x16x32_bf16 v[172:175], v[204:207], v[92:95], v[172:175]
ds_read_b64_tr_b16 v[198:199], v225 offset:34816
s_waitcnt lgkmcnt(10)
v_mfma_f32_16x16x32_bf16 v[144:147], a[240:243], v[28:31], v[144:147]
ds_read_b64_tr_b16 v[200:201], v226 offset:32768
v_mfma_f32_16x16x32_bf16 v[176:179], a[240:243], v[92:95], v[176:179]
ds_read_b64_tr_b16 v[202:203], v226 offset:34816
s_waitcnt lgkmcnt(10)
v_mfma_f32_16x16x32_bf16 v[148:151], a[244:247], v[28:31], v[148:151]
ds_read_b64_tr_b16 v[204:205], v227 offset:32768
v_mfma_f32_16x16x32_bf16 v[180:183], a[244:247], v[92:95], v[180:183]
ds_read_b64_tr_b16 v[206:207], v227 offset:34816
s_waitcnt lgkmcnt(10)
v_mfma_f32_16x16x32_bf16 v[152:155], a[248:251], v[28:31], v[152:155]
ds_read_b64_tr_b16 a[240:241], v228 offset:32768
buffer_load_dwordx4 v[116:119], v240, s[28:31], s62 offen offset:1024 sc1
v_mfma_f32_16x16x32_bf16 v[184:187], a[248:251], v[92:95], v[184:187]
ds_read_b64_tr_b16 a[242:243], v228 offset:34816
s_waitcnt lgkmcnt(10)
v_mfma_f32_16x16x32_bf16 v[156:159], a[252:255], v[28:31], v[156:159]
ds_read_b64_tr_b16 a[244:245], v229 offset:32768
v_mfma_f32_16x16x32_bf16 v[188:191], a[252:255], v[92:95], v[188:191]
ds_read_b64_tr_b16 a[246:247], v229 offset:34816
s_waitcnt vmcnt(10)
s_waitcnt lgkmcnt(10)
v_mfma_f32_16x16x32_bf16 v[128:131], v[192:195], v[32:35], v[128:131]
ds_read_b64_tr_b16 a[248:249], v230 offset:32768
buffer_load_dwordx4 v[56:59], v255, s[28:31], s62 offen offset:2048 sc1
v_mfma_f32_16x16x32_bf16 v[160:163], v[192:195], v[96:99], v[160:163]
ds_read_b64_tr_b16 a[250:251], v230 offset:34816
s_waitcnt lgkmcnt(10)
v_mfma_f32_16x16x32_bf16 v[132:135], v[196:199], v[32:35], v[132:135]
ds_read_b64_tr_b16 a[252:253], v231 offset:32768
v_mfma_f32_16x16x32_bf16 v[164:167], v[196:199], v[96:99], v[164:167]
ds_read_b64_tr_b16 a[254:255], v231 offset:34816
s_waitcnt lgkmcnt(10)
v_mfma_f32_16x16x32_bf16 v[136:139], v[200:203], v[32:35], v[136:139]
ds_read_b64_tr_b16 v[192:193], v224 offset:36864
v_mfma_f32_16x16x32_bf16 v[168:171], v[200:203], v[96:99], v[168:171]
ds_read_b64_tr_b16 v[194:195], v224 offset:38912
s_waitcnt lgkmcnt(10)
v_mfma_f32_16x16x32_bf16 v[140:143], v[204:207], v[32:35], v[140:143]
ds_read_b64_tr_b16 v[196:197], v225 offset:36864
buffer_load_dwordx4 v[120:123], v240, s[28:31], s62 offen offset:2048 sc1
v_mfma_f32_16x16x32_bf16 v[172:175], v[204:207], v[96:99], v[172:175]
ds_read_b64_tr_b16 v[198:199], v225 offset:38912
s_waitcnt lgkmcnt(10)
v_mfma_f32_16x16x32_bf16 v[144:147], a[240:243], v[32:35], v[144:147]
ds_read_b64_tr_b16 v[200:201], v226 offset:36864
v_mfma_f32_16x16x32_bf16 v[176:179], a[240:243], v[96:99], v[176:179]
ds_read_b64_tr_b16 v[202:203], v226 offset:38912
s_waitcnt lgkmcnt(10)
v_mfma_f32_16x16x32_bf16 v[148:151], a[244:247], v[32:35], v[148:151]
ds_read_b64_tr_b16 v[204:205], v227 offset:36864
buffer_load_dwordx4 v[60:63], v255, s[28:31], s62 offen offset:3072 sc1
v_mfma_f32_16x16x32_bf16 v[180:183], a[244:247], v[96:99], v[180:183]
ds_read_b64_tr_b16 v[206:207], v227 offset:38912
s_waitcnt lgkmcnt(10)
v_mfma_f32_16x16x32_bf16 v[152:155], a[248:251], v[32:35], v[152:155]
ds_read_b64_tr_b16 a[240:241], v228 offset:36864
v_mfma_f32_16x16x32_bf16 v[184:187], a[248:251], v[96:99], v[184:187]
ds_read_b64_tr_b16 a[242:243], v228 offset:38912
s_waitcnt lgkmcnt(10)
v_mfma_f32_16x16x32_bf16 v[156:159], a[252:255], v[32:35], v[156:159]
ds_read_b64_tr_b16 a[244:245], v229 offset:36864
buffer_load_dwordx4 v[124:127], v240, s[28:31], s62 offen offset:3072 sc1
v_mfma_f32_16x16x32_bf16 v[188:191], a[252:255], v[96:99], v[188:191]
ds_read_b64_tr_b16 a[246:247], v229 offset:38912
s_waitcnt vmcnt(12)
s_waitcnt lgkmcnt(10)
v_mfma_f32_16x16x32_bf16 v[128:131], v[192:195], v[36:39], v[128:131]
ds_read_b64_tr_b16 a[248:249], v230 offset:36864
v_add_f32 v236, v208, v210
v_mfma_f32_16x16x32_bf16 v[160:163], v[192:195], v[100:103], v[160:163]
ds_read_b64_tr_b16 a[250:251], v230 offset:38912
s_waitcnt lgkmcnt(10)
v_mfma_f32_16x16x32_bf16 v[132:135], v[196:199], v[36:39], v[132:135]
ds_read_b64_tr_b16 a[252:253], v231 offset:36864
v_add_f32 v237, v209, v211
v_mfma_f32_16x16x32_bf16 v[164:167], v[196:199], v[100:103], v[164:167]
ds_read_b64_tr_b16 a[254:255], v231 offset:38912
s_waitcnt lgkmcnt(10)
v_mfma_f32_16x16x32_bf16 v[136:139], v[200:203], v[36:39], v[136:139]
ds_read_b64_tr_b16 v[192:193], v224 offset:40960
v_add_f32 v238, v212, v214
v_mfma_f32_16x16x32_bf16 v[168:171], v[200:203], v[100:103], v[168:171]
ds_read_b64_tr_b16 v[194:195], v224 offset:43008
s_waitcnt lgkmcnt(10)
v_mfma_f32_16x16x32_bf16 v[140:143], v[204:207], v[36:39], v[140:143]
ds_read_b64_tr_b16 v[196:197], v225 offset:40960
v_add_f32 v239, v213, v215
v_mfma_f32_16x16x32_bf16 v[172:175], v[204:207], v[100:103], v[172:175]
ds_read_b64_tr_b16 v[198:199], v225 offset:43008
s_waitcnt lgkmcnt(10)
v_mfma_f32_16x16x32_bf16 v[144:147], a[240:243], v[36:39], v[144:147]
ds_read_b64_tr_b16 v[200:201], v226 offset:40960
v_mov_b32 v216, v236
v_mfma_f32_16x16x32_bf16 v[176:179], a[240:243], v[100:103], v[176:179]
ds_read_b64_tr_b16 v[202:203], v226 offset:43008
v_mov_b32 v217, v237
s_waitcnt lgkmcnt(10)
v_mfma_f32_16x16x32_bf16 v[148:151], a[244:247], v[36:39], v[148:151]
ds_read_b64_tr_b16 v[204:205], v227 offset:40960
v_mov_b32 v218, v238
v_mfma_f32_16x16x32_bf16 v[180:183], a[244:247], v[100:103], v[180:183]
ds_read_b64_tr_b16 v[206:207], v227 offset:43008
s_waitcnt lgkmcnt(10)
v_mfma_f32_16x16x32_bf16 v[152:155], a[248:251], v[36:39], v[152:155]
ds_read_b64_tr_b16 a[240:241], v228 offset:40960
v_mov_b32 v219, v239
v_mfma_f32_16x16x32_bf16 v[184:187], a[248:251], v[100:103], v[184:187]
ds_read_b64_tr_b16 a[242:243], v228 offset:43008
s_waitcnt lgkmcnt(10)
v_mfma_f32_16x16x32_bf16 v[156:159], a[252:255], v[36:39], v[156:159]
ds_read_b64_tr_b16 a[244:245], v229 offset:40960
v_permlane16_swap_b32 v216, v236
v_mfma_f32_16x16x32_bf16 v[188:191], a[252:255], v[100:103], v[188:191]
ds_read_b64_tr_b16 a[246:247], v229 offset:43008
s_waitcnt vmcnt(10)
s_waitcnt lgkmcnt(10)
v_mfma_f32_16x16x32_bf16 v[128:131], v[192:195], v[40:43], v[128:131]
ds_read_b64_tr_b16 a[248:249], v230 offset:40960
v_permlane16_swap_b32 v217, v237
v_mfma_f32_16x16x32_bf16 v[160:163], v[192:195], v[104:107], v[160:163]
ds_read_b64_tr_b16 a[250:251], v230 offset:43008
s_waitcnt lgkmcnt(10)
v_mfma_f32_16x16x32_bf16 v[132:135], v[196:199], v[40:43], v[132:135]
ds_read_b64_tr_b16 a[252:253], v231 offset:40960
v_permlane16_swap_b32 v218, v238
v_mfma_f32_16x16x32_bf16 v[164:167], v[196:199], v[104:107], v[164:167]
ds_read_b64_tr_b16 a[254:255], v231 offset:43008
v_permlane16_swap_b32 v219, v239
s_waitcnt lgkmcnt(10)
v_mfma_f32_16x16x32_bf16 v[136:139], v[200:203], v[40:43], v[136:139]
ds_read_b64_tr_b16 v[192:193], v224 offset:45056
v_add_f32 v236, v236, v216
v_mfma_f32_16x16x32_bf16 v[168:171], v[200:203], v[104:107], v[168:171]
ds_read_b64_tr_b16 v[194:195], v224 offset:47104
s_waitcnt lgkmcnt(10)
v_mfma_f32_16x16x32_bf16 v[140:143], v[204:207], v[40:43], v[140:143]
ds_read_b64_tr_b16 v[196:197], v225 offset:45056
v_add_f32 v237, v237, v217
v_mfma_f32_16x16x32_bf16 v[172:175], v[204:207], v[104:107], v[172:175]
ds_read_b64_tr_b16 v[198:199], v225 offset:47104
s_waitcnt lgkmcnt(10)
v_mfma_f32_16x16x32_bf16 v[144:147], a[240:243], v[40:43], v[144:147]
ds_read_b64_tr_b16 v[200:201], v226 offset:45056
v_add_f32 v238, v238, v218
v_mfma_f32_16x16x32_bf16 v[176:179], a[240:243], v[104:107], v[176:179]
ds_read_b64_tr_b16 v[202:203], v226 offset:47104
s_waitcnt lgkmcnt(10)
v_mfma_f32_16x16x32_bf16 v[148:151], a[244:247], v[40:43], v[148:151]
ds_read_b64_tr_b16 v[204:205], v227 offset:45056
v_add_f32 v239, v239, v219
v_mfma_f32_16x16x32_bf16 v[180:183], a[244:247], v[104:107], v[180:183]
ds_read_b64_tr_b16 v[206:207], v227 offset:47104
s_waitcnt lgkmcnt(10)
v_mfma_f32_16x16x32_bf16 v[152:155], a[248:251], v[40:43], v[152:155]
ds_read_b64_tr_b16 a[240:241], v228 offset:45056
v_mov_b32 v216, v236
v_mfma_f32_16x16x32_bf16 v[184:187], a[248:251], v[104:107], v[184:187]
ds_read_b64_tr_b16 a[242:243], v228 offset:47104
v_mov_b32 v217, v237
s_waitcnt lgkmcnt(10)
v_mfma_f32_16x16x32_bf16 v[156:159], a[252:255], v[40:43], v[156:159]
ds_read_b64_tr_b16 a[244:245], v229 offset:45056
v_mov_b32 v218, v238
v_mfma_f32_16x16x32_bf16 v[188:191], a[252:255], v[104:107], v[188:191]
ds_read_b64_tr_b16 a[246:247], v229 offset:47104
s_waitcnt vmcnt(8)
s_waitcnt lgkmcnt(10)
v_mfma_f32_16x16x32_bf16 v[128:131], v[192:195], v[44:47], v[128:131]
ds_read_b64_tr_b16 a[248:249], v230 offset:45056
v_mov_b32 v219, v239
v_mfma_f32_16x16x32_bf16 v[160:163], v[192:195], v[108:111], v[160:163]
ds_read_b64_tr_b16 a[250:251], v230 offset:47104
s_waitcnt lgkmcnt(10)
v_mfma_f32_16x16x32_bf16 v[132:135], v[196:199], v[44:47], v[132:135]
ds_read_b64_tr_b16 a[252:253], v231 offset:45056
v_permlane32_swap_b32 v216, v236
v_mfma_f32_16x16x32_bf16 v[164:167], v[196:199], v[108:111], v[164:167]
ds_read_b64_tr_b16 a[254:255], v231 offset:47104
s_waitcnt lgkmcnt(10)
v_mfma_f32_16x16x32_bf16 v[136:139], v[200:203], v[44:47], v[136:139]
ds_read_b64_tr_b16 v[192:193], v224 offset:49152
v_permlane32_swap_b32 v217, v237
v_mfma_f32_16x16x32_bf16 v[168:171], v[200:203], v[108:111], v[168:171]
ds_read_b64_tr_b16 v[194:195], v224 offset:51200
s_waitcnt lgkmcnt(10)
v_mfma_f32_16x16x32_bf16 v[140:143], v[204:207], v[44:47], v[140:143]
ds_read_b64_tr_b16 v[196:197], v225 offset:49152
v_permlane32_swap_b32 v218, v238
v_mfma_f32_16x16x32_bf16 v[172:175], v[204:207], v[108:111], v[172:175]
ds_read_b64_tr_b16 v[198:199], v225 offset:51200
v_permlane32_swap_b32 v219, v239
s_waitcnt lgkmcnt(10)
v_mfma_f32_16x16x32_bf16 v[144:147], a[240:243], v[44:47], v[144:147]
ds_read_b64_tr_b16 v[200:201], v226 offset:49152
v_add_f32 v236, v236, v216
v_mfma_f32_16x16x32_bf16 v[176:179], a[240:243], v[108:111], v[176:179]
ds_read_b64_tr_b16 v[202:203], v226 offset:51200
s_waitcnt lgkmcnt(10)
v_mfma_f32_16x16x32_bf16 v[148:151], a[244:247], v[44:47], v[148:151]
ds_read_b64_tr_b16 v[204:205], v227 offset:49152
v_add_f32 v237, v237, v217
v_mfma_f32_16x16x32_bf16 v[180:183], a[244:247], v[108:111], v[180:183]
ds_read_b64_tr_b16 v[206:207], v227 offset:51200
s_waitcnt lgkmcnt(10)
v_mfma_f32_16x16x32_bf16 v[152:155], a[248:251], v[44:47], v[152:155]
ds_read_b64_tr_b16 a[240:241], v228 offset:49152
v_add_f32 v238, v238, v218
v_mfma_f32_16x16x32_bf16 v[184:187], a[248:251], v[108:111], v[184:187]
ds_read_b64_tr_b16 a[242:243], v228 offset:51200
s_waitcnt lgkmcnt(10)
v_mfma_f32_16x16x32_bf16 v[156:159], a[252:255], v[44:47], v[156:159]
ds_read_b64_tr_b16 a[244:245], v229 offset:49152
v_add_f32 v239, v239, v219
v_mfma_f32_16x16x32_bf16 v[188:191], a[252:255], v[108:111], v[188:191]
ds_read_b64_tr_b16 a[246:247], v229 offset:51200
s_waitcnt vmcnt(6)
s_waitcnt lgkmcnt(10)
v_mfma_f32_16x16x32_bf16 v[128:131], v[192:195], v[48:51], v[128:131]
ds_read_b64_tr_b16 a[248:249], v230 offset:49152
v_mul_f32 v236, 0x3b000000, v236
v_mfma_f32_16x16x32_bf16 v[160:163], v[192:195], v[112:115], v[160:163]
ds_read_b64_tr_b16 a[250:251], v230 offset:51200
v_mul_f32 v216, v236, v236
s_waitcnt lgkmcnt(10)
v_mfma_f32_16x16x32_bf16 v[132:135], v[196:199], v[48:51], v[132:135]
ds_read_b64_tr_b16 a[252:253], v231 offset:49152
v_fma_f32 v237, v237, s60, -v216
v_mfma_f32_16x16x32_bf16 v[164:167], v[196:199], v[112:115], v[164:167]
ds_read_b64_tr_b16 a[254:255], v231 offset:51200
s_waitcnt lgkmcnt(10)
v_mfma_f32_16x16x32_bf16 v[136:139], v[200:203], v[48:51], v[136:139]
ds_read_b64_tr_b16 v[192:193], v224 offset:53248
v_max_f32 v237, 0, v237
v_mfma_f32_16x16x32_bf16 v[168:171], v[200:203], v[112:115], v[168:171]
ds_read_b64_tr_b16 v[194:195], v224 offset:55296
s_waitcnt lgkmcnt(10)
v_mfma_f32_16x16x32_bf16 v[140:143], v[204:207], v[48:51], v[140:143]
ds_read_b64_tr_b16 v[196:197], v225 offset:53248
v_mul_f32 v237, 0x3f800054, v237
v_mfma_f32_16x16x32_bf16 v[172:175], v[204:207], v[112:115], v[172:175]
ds_read_b64_tr_b16 v[198:199], v225 offset:55296
s_waitcnt lgkmcnt(10)
v_mfma_f32_16x16x32_bf16 v[144:147], a[240:243], v[48:51], v[144:147]
ds_read_b64_tr_b16 v[200:201], v226 offset:53248
v_add_f32 v237, 0x2edbe6ff, v237
v_mfma_f32_16x16x32_bf16 v[176:179], a[240:243], v[112:115], v[176:179]
ds_read_b64_tr_b16 v[202:203], v226 offset:55296
s_waitcnt lgkmcnt(10)
v_mfma_f32_16x16x32_bf16 v[148:151], a[244:247], v[48:51], v[148:151]
ds_read_b64_tr_b16 v[204:205], v227 offset:53248
v_rsq_f32 v216, v237
v_mfma_f32_16x16x32_bf16 v[180:183], a[244:247], v[112:115], v[180:183]
ds_read_b64_tr_b16 v[206:207], v227 offset:55296
v_mul_f32 v216, 0x3eeff558, v216
s_waitcnt lgkmcnt(10)
v_mfma_f32_16x16x32_bf16 v[152:155], a[248:251], v[48:51], v[152:155]
ds_read_b64_tr_b16 a[240:241], v228 offset:53248
v_mul_f32 v237, -v236, v216
v_mfma_f32_16x16x32_bf16 v[184:187], a[248:251], v[112:115], v[184:187]
ds_read_b64_tr_b16 a[242:243], v228 offset:55296
s_waitcnt lgkmcnt(10)
v_mfma_f32_16x16x32_bf16 v[156:159], a[252:255], v[48:51], v[156:159]
ds_read_b64_tr_b16 a[244:245], v229 offset:53248
v_mov_b32 v236, v216
v_mfma_f32_16x16x32_bf16 v[188:191], a[252:255], v[112:115], v[188:191]
ds_read_b64_tr_b16 a[246:247], v229 offset:55296
s_waitcnt vmcnt(4)
s_waitcnt lgkmcnt(10)
v_mfma_f32_16x16x32_bf16 v[128:131], v[192:195], v[52:55], v[128:131]
ds_read_b64_tr_b16 a[248:249], v230 offset:53248
v_mul_f32 v238, 0x3b000000, v238
v_mfma_f32_16x16x32_bf16 v[160:163], v[192:195], v[116:119], v[160:163]
ds_read_b64_tr_b16 a[250:251], v230 offset:55296
s_waitcnt lgkmcnt(10)
v_mfma_f32_16x16x32_bf16 v[132:135], v[196:199], v[52:55], v[132:135]
ds_read_b64_tr_b16 a[252:253], v231 offset:53248
v_mul_f32 v217, v238, v238
v_mfma_f32_16x16x32_bf16 v[164:167], v[196:199], v[116:119], v[164:167]
ds_read_b64_tr_b16 a[254:255], v231 offset:55296
s_waitcnt lgkmcnt(10)
v_mfma_f32_16x16x32_bf16 v[136:139], v[200:203], v[52:55], v[136:139]
ds_read_b64_tr_b16 v[192:193], v224 offset:57344
v_fma_f32 v239, v239, s60, -v217
v_mfma_f32_16x16x32_bf16 v[168:171], v[200:203], v[116:119], v[168:171]
ds_read_b64_tr_b16 v[194:195], v224 offset:59392
v_max_f32 v239, 0, v239
s_waitcnt lgkmcnt(10)
v_mfma_f32_16x16x32_bf16 v[140:143], v[204:207], v[52:55], v[140:143]
ds_read_b64_tr_b16 v[196:197], v225 offset:57344
v_mul_f32 v239, 0x3f800054, v239
v_mfma_f32_16x16x32_bf16 v[172:175], v[204:207], v[116:119], v[172:175]
ds_read_b64_tr_b16 v[198:199], v225 offset:59392
s_waitcnt lgkmcnt(10)
v_mfma_f32_16x16x32_bf16 v[144:147], a[240:243], v[52:55], v[144:147]
ds_read_b64_tr_b16 v[200:201], v226 offset:57344
v_add_f32 v239, 0x2edbe6ff, v239
v_mfma_f32_16x16x32_bf16 v[176:179], a[240:243], v[116:119], v[176:179]
ds_read_b64_tr_b16 v[202:203], v226 offset:59392
s_waitcnt lgkmcnt(10)
v_mfma_f32_16x16x32_bf16 v[148:151], a[244:247], v[52:55], v[148:151]
ds_read_b64_tr_b16 v[204:205], v227 offset:57344
v_rsq_f32 v217, v239
v_mfma_f32_16x16x32_bf16 v[180:183], a[244:247], v[116:119], v[180:183]
ds_read_b64_tr_b16 v[206:207], v227 offset:59392
s_waitcnt lgkmcnt(10)
v_mfma_f32_16x16x32_bf16 v[152:155], a[248:251], v[52:55], v[152:155]
ds_read_b64_tr_b16 a[240:241], v228 offset:57344
v_mul_f32 v217, 0x3eeff558, v217
v_mfma_f32_16x16x32_bf16 v[184:187], a[248:251], v[116:119], v[184:187]
ds_read_b64_tr_b16 a[242:243], v228 offset:59392
s_waitcnt lgkmcnt(10)
v_mfma_f32_16x16x32_bf16 v[156:159], a[252:255], v[52:55], v[156:159]
ds_read_b64_tr_b16 a[244:245], v229 offset:57344
v_mul_f32 v239, -v238, v217
v_mfma_f32_16x16x32_bf16 v[188:191], a[252:255], v[116:119], v[188:191]
ds_read_b64_tr_b16 a[246:247], v229 offset:59392
v_mov_b32 v238, v217
s_waitcnt vmcnt(2)
s_waitcnt lgkmcnt(10)
v_mfma_f32_16x16x32_bf16 v[128:131], v[192:195], v[56:59], v[128:131]
ds_read_b64_tr_b16 a[248:249], v230 offset:57344
ds_read_b128 v[0:3], v232 offset:0
v_mfma_f32_16x16x32_bf16 v[160:163], v[192:195], v[120:123], v[160:163]
ds_read_b64_tr_b16 a[250:251], v230 offset:59392
s_waitcnt lgkmcnt(10)
v_mfma_f32_16x16x32_bf16 v[132:135], v[196:199], v[56:59], v[132:135]
ds_read_b64_tr_b16 a[252:253], v231 offset:57344
ds_read_b128 v[4:7], v232 offset:64
v_mfma_f32_16x16x32_bf16 v[164:167], v[196:199], v[120:123], v[164:167]
ds_read_b64_tr_b16 a[254:255], v231 offset:59392
s_waitcnt lgkmcnt(10)
v_mfma_f32_16x16x32_bf16 v[136:139], v[200:203], v[56:59], v[136:139]
ds_read_b64_tr_b16 v[192:193], v224 offset:61440
ds_read_b128 v[8:11], v232 offset:512
v_mfma_f32_16x16x32_bf16 v[168:171], v[200:203], v[120:123], v[168:171]
ds_read_b64_tr_b16 v[194:195], v224 offset:63488
s_waitcnt lgkmcnt(10)
v_mfma_f32_16x16x32_bf16 v[140:143], v[204:207], v[56:59], v[140:143]
ds_read_b64_tr_b16 v[196:197], v225 offset:61440
ds_read_b128 v[12:15], v232 offset:576
v_mfma_f32_16x16x32_bf16 v[172:175], v[204:207], v[120:123], v[172:175]
ds_read_b64_tr_b16 v[198:199], v225 offset:63488
s_waitcnt lgkmcnt(10)
v_mfma_f32_16x16x32_bf16 v[144:147], a[240:243], v[56:59], v[144:147]
ds_read_b64_tr_b16 v[200:201], v226 offset:61440
ds_read_b128 v[16:19], v232 offset:128
v_mfma_f32_16x16x32_bf16 v[176:179], a[240:243], v[120:123], v[176:179]
ds_read_b64_tr_b16 v[202:203], v226 offset:63488
s_waitcnt lgkmcnt(10)
v_mfma_f32_16x16x32_bf16 v[148:151], a[244:247], v[56:59], v[148:151]
ds_read_b64_tr_b16 v[204:205], v227 offset:61440
ds_read_b128 v[20:23], v232 offset:192
v_mfma_f32_16x16x32_bf16 v[180:183], a[244:247], v[120:123], v[180:183]
ds_read_b64_tr_b16 v[206:207], v227 offset:63488
s_waitcnt lgkmcnt(10)
v_mfma_f32_16x16x32_bf16 v[152:155], a[248:251], v[56:59], v[152:155]
ds_read_b64_tr_b16 a[240:241], v228 offset:61440
ds_read_b128 v[24:27], v232 offset:640
v_mfma_f32_16x16x32_bf16 v[184:187], a[248:251], v[120:123], v[184:187]
ds_read_b64_tr_b16 a[242:243], v228 offset:63488
s_waitcnt lgkmcnt(10)
v_mfma_f32_16x16x32_bf16 v[156:159], a[252:255], v[56:59], v[156:159]
ds_read_b64_tr_b16 a[244:245], v229 offset:61440
ds_read_b128 v[28:31], v232 offset:704
v_mfma_f32_16x16x32_bf16 v[188:191], a[252:255], v[120:123], v[188:191]
ds_read_b64_tr_b16 a[246:247], v229 offset:63488
s_waitcnt vmcnt(0)
s_waitcnt lgkmcnt(10)
v_mfma_f32_16x16x32_bf16 v[128:131], v[192:195], v[60:63], v[128:131]
ds_read_b64_tr_b16 a[248:249], v230 offset:61440
ds_read_b128 v[64:67], v232 offset:256
v_mfma_f32_16x16x32_bf16 v[160:163], v[192:195], v[124:127], v[160:163]
ds_read_b64_tr_b16 a[250:251], v230 offset:63488
s_waitcnt lgkmcnt(10)
v_mfma_f32_16x16x32_bf16 v[132:135], v[196:199], v[60:63], v[132:135]
ds_read_b64_tr_b16 a[252:253], v231 offset:61440
ds_read_b128 v[68:71], v232 offset:320
v_mfma_f32_16x16x32_bf16 v[164:167], v[196:199], v[124:127], v[164:167]
ds_read_b64_tr_b16 a[254:255], v231 offset:63488
s_waitcnt lgkmcnt(10)
v_mfma_f32_16x16x32_bf16 v[136:139], v[200:203], v[60:63], v[136:139]
ds_read_b128 v[72:75], v232 offset:768
v_mfma_f32_16x16x32_bf16 v[168:171], v[200:203], v[124:127], v[168:171]
s_waitcnt lgkmcnt(8)
v_mfma_f32_16x16x32_bf16 v[140:143], v[204:207], v[60:63], v[140:143]
ds_read_b128 v[76:79], v232 offset:832
v_mfma_f32_16x16x32_bf16 v[172:175], v[204:207], v[124:127], v[172:175]
s_waitcnt lgkmcnt(6)
v_mfma_f32_16x16x32_bf16 v[144:147], a[240:243], v[60:63], v[144:147]
ds_read_b128 v[80:83], v232 offset:384
v_mfma_f32_16x16x32_bf16 v[176:179], a[240:243], v[124:127], v[176:179]
s_waitcnt lgkmcnt(4)
v_mfma_f32_16x16x32_bf16 v[148:151], a[244:247], v[60:63], v[148:151]
ds_read_b128 v[84:87], v232 offset:448
v_mfma_f32_16x16x32_bf16 v[180:183], a[244:247], v[124:127], v[180:183]
s_waitcnt lgkmcnt(2)
v_mfma_f32_16x16x32_bf16 v[152:155], a[248:251], v[60:63], v[152:155]
ds_read_b128 v[88:91], v232 offset:896
v_mfma_f32_16x16x32_bf16 v[184:187], a[248:251], v[124:127], v[184:187]
s_waitcnt lgkmcnt(0)
v_mfma_f32_16x16x32_bf16 v[156:159], a[252:255], v[60:63], v[156:159]
ds_read_b128 v[92:95], v232 offset:960
v_mfma_f32_16x16x32_bf16 v[188:191], a[252:255], v[124:127], v[188:191]
s_waitcnt lgkmcnt(0)
.p2align 3
v_pk_fma_f32 v[208:209], v[0:1], v[236:237], v[8:9] op_sel:[0,1,0] op_sel_hi:[1,1,1]
v_pk_fma_f32 v[210:211], v[2:3], v[236:237], v[10:11] op_sel:[0,1,0] op_sel_hi:[1,1,1]
v_pk_fma_f32 v[212:213], v[4:5], v[236:237], v[12:13] op_sel:[0,1,0] op_sel_hi:[1,1,1]
v_pk_fma_f32 v[214:215], v[6:7], v[236:237], v[14:15] op_sel:[0,1,0] op_sel_hi:[1,1,1]
v_pk_fma_f32 v[128:129], v[128:129], v[236:237], v[208:209] op_sel:[0,0,0] op_sel_hi:[1,0,1]
v_pk_fma_f32 v[130:131], v[130:131], v[236:237], v[210:211] op_sel:[0,0,0] op_sel_hi:[1,0,1]
v_pk_fma_f32 v[132:133], v[132:133], v[236:237], v[212:213] op_sel:[0,0,0] op_sel_hi:[1,0,1]
v_pk_fma_f32 v[134:135], v[134:135], v[236:237], v[214:215] op_sel:[0,0,0] op_sel_hi:[1,0,1]
v_pk_fma_f32 v[208:209], v[128:129], v[128:129], s[90:91]
v_pk_fma_f32 v[210:211], v[130:131], v[130:131], s[90:91]
v_pk_fma_f32 v[212:213], v[132:133], v[132:133], s[90:91]
v_pk_fma_f32 v[214:215], v[134:135], v[134:135], s[90:91]
v_pk_mul_f32 v[208:209], v[208:209], v[128:129]
v_pk_mul_f32 v[210:211], v[210:211], v[130:131]
v_pk_mul_f32 v[212:213], v[212:213], v[132:133]
v_pk_mul_f32 v[214:215], v[214:215], v[134:135]
v_exp_f32_e64 v208, -v208
v_exp_f32_e64 v210, -v210
v_exp_f32_e64 v212, -v212
v_exp_f32_e64 v214, -v214
v_exp_f32_e64 v209, -v209
v_exp_f32_e64 v211, -v211
v_exp_f32_e64 v213, -v213
v_exp_f32_e64 v215, -v215
v_pk_fma_f32 v[208:209], v[208:209], s[92:93], s[92:93]
v_pk_fma_f32 v[210:211], v[210:211], s[92:93], s[92:93]
v_pk_fma_f32 v[212:213], v[212:213], s[92:93], s[92:93]
v_pk_fma_f32 v[214:215], v[214:215], s[92:93], s[92:93]
v_rcp_f32_e64 v208, v208
v_rcp_f32_e64 v210, v210
v_rcp_f32_e64 v212, v212
v_rcp_f32_e64 v214, v214
v_rcp_f32_e64 v209, v209
v_rcp_f32_e64 v211, v211
v_rcp_f32_e64 v213, v213
v_rcp_f32_e64 v215, v215
v_pk_mul_f32 v[128:129], v[128:129], v[208:209]
v_pk_mul_f32 v[130:131], v[130:131], v[210:211]
v_pk_mul_f32 v[132:133], v[132:133], v[212:213]
v_pk_mul_f32 v[134:135], v[134:135], v[214:215]
v_cvt_pk_bf16_f32 v128, v128, v129
v_cvt_pk_bf16_f32 v129, v130, v131
v_cvt_pk_bf16_f32 v130, v132, v133
v_cvt_pk_bf16_f32 v131, v134, v135
buffer_store_dwordx4 v[128:131], v255, s[28:31], s64 offen offset:0 sc1
v_pk_fma_f32 v[208:209], v[0:1], v[238:239], v[8:9] op_sel:[0,1,0] op_sel_hi:[1,1,1]
v_pk_fma_f32 v[210:211], v[2:3], v[238:239], v[10:11] op_sel:[0,1,0] op_sel_hi:[1,1,1]
v_pk_fma_f32 v[212:213], v[4:5], v[238:239], v[12:13] op_sel:[0,1,0] op_sel_hi:[1,1,1]
v_pk_fma_f32 v[214:215], v[6:7], v[238:239], v[14:15] op_sel:[0,1,0] op_sel_hi:[1,1,1]
v_pk_fma_f32 v[160:161], v[160:161], v[238:239], v[208:209] op_sel:[0,0,0] op_sel_hi:[1,0,1]
v_pk_fma_f32 v[162:163], v[162:163], v[238:239], v[210:211] op_sel:[0,0,0] op_sel_hi:[1,0,1]
v_pk_fma_f32 v[164:165], v[164:165], v[238:239], v[212:213] op_sel:[0,0,0] op_sel_hi:[1,0,1]
v_pk_fma_f32 v[166:167], v[166:167], v[238:239], v[214:215] op_sel:[0,0,0] op_sel_hi:[1,0,1]
v_pk_fma_f32 v[208:209], v[160:161], v[160:161], s[90:91]
v_pk_fma_f32 v[210:211], v[162:163], v[162:163], s[90:91]
v_pk_fma_f32 v[212:213], v[164:165], v[164:165], s[90:91]
v_pk_fma_f32 v[214:215], v[166:167], v[166:167], s[90:91]
v_pk_mul_f32 v[208:209], v[208:209], v[160:161]
v_pk_mul_f32 v[210:211], v[210:211], v[162:163]
v_pk_mul_f32 v[212:213], v[212:213], v[164:165]
v_pk_mul_f32 v[214:215], v[214:215], v[166:167]
v_exp_f32_e64 v208, -v208
v_exp_f32_e64 v210, -v210
v_exp_f32_e64 v212, -v212
v_exp_f32_e64 v214, -v214
v_exp_f32_e64 v209, -v209
v_exp_f32_e64 v211, -v211
v_exp_f32_e64 v213, -v213
v_exp_f32_e64 v215, -v215
v_pk_fma_f32 v[208:209], v[208:209], s[92:93], s[92:93]
v_pk_fma_f32 v[210:211], v[210:211], s[92:93], s[92:93]
v_pk_fma_f32 v[212:213], v[212:213], s[92:93], s[92:93]
v_pk_fma_f32 v[214:215], v[214:215], s[92:93], s[92:93]
v_rcp_f32_e64 v208, v208
v_rcp_f32_e64 v210, v210
v_rcp_f32_e64 v212, v212
v_rcp_f32_e64 v214, v214
v_rcp_f32_e64 v209, v209
v_rcp_f32_e64 v211, v211
v_rcp_f32_e64 v213, v213
v_rcp_f32_e64 v215, v215
v_pk_mul_f32 v[160:161], v[160:161], v[208:209]
v_pk_mul_f32 v[162:163], v[162:163], v[210:211]
v_pk_mul_f32 v[164:165], v[164:165], v[212:213]
v_pk_mul_f32 v[166:167], v[166:167], v[214:215]
v_cvt_pk_bf16_f32 v160, v160, v161
v_cvt_pk_bf16_f32 v161, v162, v163
v_cvt_pk_bf16_f32 v162, v164, v165
v_cvt_pk_bf16_f32 v163, v166, v167
buffer_store_dwordx4 v[160:163], v255, s[28:31], s65 offen offset:0 sc1
v_pk_fma_f32 v[208:209], v[16:17], v[236:237], v[24:25] op_sel:[0,1,0] op_sel_hi:[1,1,1]
v_pk_fma_f32 v[210:211], v[18:19], v[236:237], v[26:27] op_sel:[0,1,0] op_sel_hi:[1,1,1]
v_pk_fma_f32 v[212:213], v[20:21], v[236:237], v[28:29] op_sel:[0,1,0] op_sel_hi:[1,1,1]
v_pk_fma_f32 v[214:215], v[22:23], v[236:237], v[30:31] op_sel:[0,1,0] op_sel_hi:[1,1,1]
v_pk_fma_f32 v[136:137], v[136:137], v[236:237], v[208:209] op_sel:[0,0,0] op_sel_hi:[1,0,1]
v_pk_fma_f32 v[138:139], v[138:139], v[236:237], v[210:211] op_sel:[0,0,0] op_sel_hi:[1,0,1]
v_pk_fma_f32 v[140:141], v[140:141], v[236:237], v[212:213] op_sel:[0,0,0] op_sel_hi:[1,0,1]
v_pk_fma_f32 v[142:143], v[142:143], v[236:237], v[214:215] op_sel:[0,0,0] op_sel_hi:[1,0,1]
v_pk_fma_f32 v[208:209], v[136:137], v[136:137], s[90:91]
v_pk_fma_f32 v[210:211], v[138:139], v[138:139], s[90:91]
v_pk_fma_f32 v[212:213], v[140:141], v[140:141], s[90:91]
v_pk_fma_f32 v[214:215], v[142:143], v[142:143], s[90:91]
v_pk_mul_f32 v[208:209], v[208:209], v[136:137]
v_pk_mul_f32 v[210:211], v[210:211], v[138:139]
v_pk_mul_f32 v[212:213], v[212:213], v[140:141]
v_pk_mul_f32 v[214:215], v[214:215], v[142:143]
v_exp_f32_e64 v208, -v208
v_exp_f32_e64 v210, -v210
v_exp_f32_e64 v212, -v212
v_exp_f32_e64 v214, -v214
v_exp_f32_e64 v209, -v209
v_exp_f32_e64 v211, -v211
v_exp_f32_e64 v213, -v213
v_exp_f32_e64 v215, -v215
v_pk_fma_f32 v[208:209], v[208:209], s[92:93], s[92:93]
v_pk_fma_f32 v[210:211], v[210:211], s[92:93], s[92:93]
v_pk_fma_f32 v[212:213], v[212:213], s[92:93], s[92:93]
v_pk_fma_f32 v[214:215], v[214:215], s[92:93], s[92:93]
v_rcp_f32_e64 v208, v208
v_rcp_f32_e64 v210, v210
v_rcp_f32_e64 v212, v212
v_rcp_f32_e64 v214, v214
v_rcp_f32_e64 v209, v209
v_rcp_f32_e64 v211, v211
v_rcp_f32_e64 v213, v213
v_rcp_f32_e64 v215, v215
v_pk_mul_f32 v[136:137], v[136:137], v[208:209]
v_pk_mul_f32 v[138:139], v[138:139], v[210:211]
v_pk_mul_f32 v[140:141], v[140:141], v[212:213]
v_pk_mul_f32 v[142:143], v[142:143], v[214:215]
v_cvt_pk_bf16_f32 v136, v136, v137
v_cvt_pk_bf16_f32 v137, v138, v139
v_cvt_pk_bf16_f32 v138, v140, v141
v_cvt_pk_bf16_f32 v139, v142, v143
buffer_store_dwordx4 v[136:139], v255, s[28:31], s64 offen offset:1024 sc1
v_pk_fma_f32 v[208:209], v[16:17], v[238:239], v[24:25] op_sel:[0,1,0] op_sel_hi:[1,1,1]
v_pk_fma_f32 v[210:211], v[18:19], v[238:239], v[26:27] op_sel:[0,1,0] op_sel_hi:[1,1,1]
v_pk_fma_f32 v[212:213], v[20:21], v[238:239], v[28:29] op_sel:[0,1,0] op_sel_hi:[1,1,1]
v_pk_fma_f32 v[214:215], v[22:23], v[238:239], v[30:31] op_sel:[0,1,0] op_sel_hi:[1,1,1]
v_pk_fma_f32 v[168:169], v[168:169], v[238:239], v[208:209] op_sel:[0,0,0] op_sel_hi:[1,0,1]
v_pk_fma_f32 v[170:171], v[170:171], v[238:239], v[210:211] op_sel:[0,0,0] op_sel_hi:[1,0,1]
v_pk_fma_f32 v[172:173], v[172:173], v[238:239], v[212:213] op_sel:[0,0,0] op_sel_hi:[1,0,1]
v_pk_fma_f32 v[174:175], v[174:175], v[238:239], v[214:215] op_sel:[0,0,0] op_sel_hi:[1,0,1]
v_pk_fma_f32 v[208:209], v[168:169], v[168:169], s[90:91]
v_pk_fma_f32 v[210:211], v[170:171], v[170:171], s[90:91]
v_pk_fma_f32 v[212:213], v[172:173], v[172:173], s[90:91]
v_pk_fma_f32 v[214:215], v[174:175], v[174:175], s[90:91]
v_pk_mul_f32 v[208:209], v[208:209], v[168:169]
v_pk_mul_f32 v[210:211], v[210:211], v[170:171]
v_pk_mul_f32 v[212:213], v[212:213], v[172:173]
v_pk_mul_f32 v[214:215], v[214:215], v[174:175]
v_exp_f32_e64 v208, -v208
v_exp_f32_e64 v210, -v210
v_exp_f32_e64 v212, -v212
v_exp_f32_e64 v214, -v214
v_exp_f32_e64 v209, -v209
v_exp_f32_e64 v211, -v211
v_exp_f32_e64 v213, -v213
v_exp_f32_e64 v215, -v215
v_pk_fma_f32 v[208:209], v[208:209], s[92:93], s[92:93]
v_pk_fma_f32 v[210:211], v[210:211], s[92:93], s[92:93]
v_pk_fma_f32 v[212:213], v[212:213], s[92:93], s[92:93]
v_pk_fma_f32 v[214:215], v[214:215], s[92:93], s[92:93]
v_rcp_f32_e64 v208, v208
v_rcp_f32_e64 v210, v210
v_rcp_f32_e64 v212, v212
v_rcp_f32_e64 v214, v214
v_rcp_f32_e64 v209, v209
v_rcp_f32_e64 v211, v211
v_rcp_f32_e64 v213, v213
v_rcp_f32_e64 v215, v215
v_pk_mul_f32 v[168:169], v[168:169], v[208:209]
v_pk_mul_f32 v[170:171], v[170:171], v[210:211]
v_pk_mul_f32 v[172:173], v[172:173], v[212:213]
v_pk_mul_f32 v[174:175], v[174:175], v[214:215]
v_cvt_pk_bf16_f32 v168, v168, v169
v_cvt_pk_bf16_f32 v169, v170, v171
v_cvt_pk_bf16_f32 v170, v172, v173
v_cvt_pk_bf16_f32 v171, v174, v175
buffer_store_dwordx4 v[168:171], v255, s[28:31], s65 offen offset:1024 sc1
v_pk_fma_f32 v[208:209], v[64:65], v[236:237], v[72:73] op_sel:[0,1,0] op_sel_hi:[1,1,1]
v_pk_fma_f32 v[210:211], v[66:67], v[236:237], v[74:75] op_sel:[0,1,0] op_sel_hi:[1,1,1]
v_pk_fma_f32 v[212:213], v[68:69], v[236:237], v[76:77] op_sel:[0,1,0] op_sel_hi:[1,1,1]
v_pk_fma_f32 v[214:215], v[70:71], v[236:237], v[78:79] op_sel:[0,1,0] op_sel_hi:[1,1,1]
v_pk_fma_f32 v[144:145], v[144:145], v[236:237], v[208:209] op_sel:[0,0,0] op_sel_hi:[1,0,1]
v_pk_fma_f32 v[146:147], v[146:147], v[236:237], v[210:211] op_sel:[0,0,0] op_sel_hi:[1,0,1]
v_pk_fma_f32 v[148:149], v[148:149], v[236:237], v[212:213] op_sel:[0,0,0] op_sel_hi:[1,0,1]
v_pk_fma_f32 v[150:151], v[150:151], v[236:237], v[214:215] op_sel:[0,0,0] op_sel_hi:[1,0,1]
v_pk_fma_f32 v[208:209], v[144:145], v[144:145], s[90:91]
v_pk_fma_f32 v[210:211], v[146:147], v[146:147], s[90:91]
v_pk_fma_f32 v[212:213], v[148:149], v[148:149], s[90:91]
v_pk_fma_f32 v[214:215], v[150:151], v[150:151], s[90:91]
v_pk_mul_f32 v[208:209], v[208:209], v[144:145]
v_pk_mul_f32 v[210:211], v[210:211], v[146:147]
v_pk_mul_f32 v[212:213], v[212:213], v[148:149]
v_pk_mul_f32 v[214:215], v[214:215], v[150:151]
v_exp_f32_e64 v208, -v208
v_exp_f32_e64 v210, -v210
v_exp_f32_e64 v212, -v212
v_exp_f32_e64 v214, -v214
v_exp_f32_e64 v209, -v209
v_exp_f32_e64 v211, -v211
v_exp_f32_e64 v213, -v213
v_exp_f32_e64 v215, -v215
v_pk_fma_f32 v[208:209], v[208:209], s[92:93], s[92:93]
v_pk_fma_f32 v[210:211], v[210:211], s[92:93], s[92:93]
v_pk_fma_f32 v[212:213], v[212:213], s[92:93], s[92:93]
v_pk_fma_f32 v[214:215], v[214:215], s[92:93], s[92:93]
v_rcp_f32_e64 v208, v208
v_rcp_f32_e64 v210, v210
v_rcp_f32_e64 v212, v212
v_rcp_f32_e64 v214, v214
v_rcp_f32_e64 v209, v209
v_rcp_f32_e64 v211, v211
v_rcp_f32_e64 v213, v213
v_rcp_f32_e64 v215, v215
v_pk_mul_f32 v[144:145], v[144:145], v[208:209]
v_pk_mul_f32 v[146:147], v[146:147], v[210:211]
v_pk_mul_f32 v[148:149], v[148:149], v[212:213]
v_pk_mul_f32 v[150:151], v[150:151], v[214:215]
v_cvt_pk_bf16_f32 v144, v144, v145
v_cvt_pk_bf16_f32 v145, v146, v147
v_cvt_pk_bf16_f32 v146, v148, v149
v_cvt_pk_bf16_f32 v147, v150, v151
buffer_store_dwordx4 v[144:147], v255, s[28:31], s64 offen offset:2048 sc1
v_pk_fma_f32 v[208:209], v[64:65], v[238:239], v[72:73] op_sel:[0,1,0] op_sel_hi:[1,1,1]
v_pk_fma_f32 v[210:211], v[66:67], v[238:239], v[74:75] op_sel:[0,1,0] op_sel_hi:[1,1,1]
v_pk_fma_f32 v[212:213], v[68:69], v[238:239], v[76:77] op_sel:[0,1,0] op_sel_hi:[1,1,1]
v_pk_fma_f32 v[214:215], v[70:71], v[238:239], v[78:79] op_sel:[0,1,0] op_sel_hi:[1,1,1]
v_pk_fma_f32 v[176:177], v[176:177], v[238:239], v[208:209] op_sel:[0,0,0] op_sel_hi:[1,0,1]
v_pk_fma_f32 v[178:179], v[178:179], v[238:239], v[210:211] op_sel:[0,0,0] op_sel_hi:[1,0,1]
v_pk_fma_f32 v[180:181], v[180:181], v[238:239], v[212:213] op_sel:[0,0,0] op_sel_hi:[1,0,1]
v_pk_fma_f32 v[182:183], v[182:183], v[238:239], v[214:215] op_sel:[0,0,0] op_sel_hi:[1,0,1]
v_pk_fma_f32 v[208:209], v[176:177], v[176:177], s[90:91]
v_pk_fma_f32 v[210:211], v[178:179], v[178:179], s[90:91]
v_pk_fma_f32 v[212:213], v[180:181], v[180:181], s[90:91]
v_pk_fma_f32 v[214:215], v[182:183], v[182:183], s[90:91]
v_pk_mul_f32 v[208:209], v[208:209], v[176:177]
v_pk_mul_f32 v[210:211], v[210:211], v[178:179]
v_pk_mul_f32 v[212:213], v[212:213], v[180:181]
v_pk_mul_f32 v[214:215], v[214:215], v[182:183]
v_exp_f32_e64 v208, -v208
v_exp_f32_e64 v210, -v210
v_exp_f32_e64 v212, -v212
v_exp_f32_e64 v214, -v214
v_exp_f32_e64 v209, -v209
v_exp_f32_e64 v211, -v211
v_exp_f32_e64 v213, -v213
v_exp_f32_e64 v215, -v215
v_pk_fma_f32 v[208:209], v[208:209], s[92:93], s[92:93]
v_pk_fma_f32 v[210:211], v[210:211], s[92:93], s[92:93]
v_pk_fma_f32 v[212:213], v[212:213], s[92:93], s[92:93]
v_pk_fma_f32 v[214:215], v[214:215], s[92:93], s[92:93]
v_rcp_f32_e64 v208, v208
v_rcp_f32_e64 v210, v210
v_rcp_f32_e64 v212, v212
v_rcp_f32_e64 v214, v214
v_rcp_f32_e64 v209, v209
v_rcp_f32_e64 v211, v211
v_rcp_f32_e64 v213, v213
v_rcp_f32_e64 v215, v215
v_pk_mul_f32 v[176:177], v[176:177], v[208:209]
v_pk_mul_f32 v[178:179], v[178:179], v[210:211]
v_pk_mul_f32 v[180:181], v[180:181], v[212:213]
v_pk_mul_f32 v[182:183], v[182:183], v[214:215]
v_cvt_pk_bf16_f32 v176, v176, v177
v_cvt_pk_bf16_f32 v177, v178, v179
v_cvt_pk_bf16_f32 v178, v180, v181
v_cvt_pk_bf16_f32 v179, v182, v183
buffer_store_dwordx4 v[176:179], v255, s[28:31], s65 offen offset:2048 sc1
v_pk_fma_f32 v[208:209], v[80:81], v[236:237], v[88:89] op_sel:[0,1,0] op_sel_hi:[1,1,1]
v_pk_fma_f32 v[210:211], v[82:83], v[236:237], v[90:91] op_sel:[0,1,0] op_sel_hi:[1,1,1]
v_pk_fma_f32 v[212:213], v[84:85], v[236:237], v[92:93] op_sel:[0,1,0] op_sel_hi:[1,1,1]
v_pk_fma_f32 v[214:215], v[86:87], v[236:237], v[94:95] op_sel:[0,1,0] op_sel_hi:[1,1,1]
v_pk_fma_f32 v[152:153], v[152:153], v[236:237], v[208:209] op_sel:[0,0,0] op_sel_hi:[1,0,1]
v_pk_fma_f32 v[154:155], v[154:155], v[236:237], v[210:211] op_sel:[0,0,0] op_sel_hi:[1,0,1]
v_pk_fma_f32 v[156:157], v[156:157], v[236:237], v[212:213] op_sel:[0,0,0] op_sel_hi:[1,0,1]
v_pk_fma_f32 v[158:159], v[158:159], v[236:237], v[214:215] op_sel:[0,0,0] op_sel_hi:[1,0,1]
v_pk_fma_f32 v[208:209], v[152:153], v[152:153], s[90:91]
v_pk_fma_f32 v[210:211], v[154:155], v[154:155], s[90:91]
v_pk_fma_f32 v[212:213], v[156:157], v[156:157], s[90:91]
v_pk_fma_f32 v[214:215], v[158:159], v[158:159], s[90:91]
v_pk_mul_f32 v[208:209], v[208:209], v[152:153]
v_pk_mul_f32 v[210:211], v[210:211], v[154:155]
v_pk_mul_f32 v[212:213], v[212:213], v[156:157]
v_pk_mul_f32 v[214:215], v[214:215], v[158:159]
v_exp_f32_e64 v208, -v208
v_exp_f32_e64 v210, -v210
v_exp_f32_e64 v212, -v212
v_exp_f32_e64 v214, -v214
v_exp_f32_e64 v209, -v209
v_exp_f32_e64 v211, -v211
v_exp_f32_e64 v213, -v213
v_exp_f32_e64 v215, -v215
v_pk_fma_f32 v[208:209], v[208:209], s[92:93], s[92:93]
v_pk_fma_f32 v[210:211], v[210:211], s[92:93], s[92:93]
v_pk_fma_f32 v[212:213], v[212:213], s[92:93], s[92:93]
v_pk_fma_f32 v[214:215], v[214:215], s[92:93], s[92:93]
v_rcp_f32_e64 v208, v208
v_rcp_f32_e64 v210, v210
v_rcp_f32_e64 v212, v212
v_rcp_f32_e64 v214, v214
v_rcp_f32_e64 v209, v209
v_rcp_f32_e64 v211, v211
v_rcp_f32_e64 v213, v213
v_rcp_f32_e64 v215, v215
v_pk_mul_f32 v[152:153], v[152:153], v[208:209]
v_pk_mul_f32 v[154:155], v[154:155], v[210:211]
v_pk_mul_f32 v[156:157], v[156:157], v[212:213]
v_pk_mul_f32 v[158:159], v[158:159], v[214:215]
v_cvt_pk_bf16_f32 v152, v152, v153
v_cvt_pk_bf16_f32 v153, v154, v155
v_cvt_pk_bf16_f32 v154, v156, v157
v_cvt_pk_bf16_f32 v155, v158, v159
buffer_store_dwordx4 v[152:155], v255, s[28:31], s64 offen offset:3072 sc1
v_pk_fma_f32 v[208:209], v[80:81], v[238:239], v[88:89] op_sel:[0,1,0] op_sel_hi:[1,1,1]
v_pk_fma_f32 v[210:211], v[82:83], v[238:239], v[90:91] op_sel:[0,1,0] op_sel_hi:[1,1,1]
v_pk_fma_f32 v[212:213], v[84:85], v[238:239], v[92:93] op_sel:[0,1,0] op_sel_hi:[1,1,1]
v_pk_fma_f32 v[214:215], v[86:87], v[238:239], v[94:95] op_sel:[0,1,0] op_sel_hi:[1,1,1]
v_pk_fma_f32 v[184:185], v[184:185], v[238:239], v[208:209] op_sel:[0,0,0] op_sel_hi:[1,0,1]
v_pk_fma_f32 v[186:187], v[186:187], v[238:239], v[210:211] op_sel:[0,0,0] op_sel_hi:[1,0,1]
v_pk_fma_f32 v[188:189], v[188:189], v[238:239], v[212:213] op_sel:[0,0,0] op_sel_hi:[1,0,1]
v_pk_fma_f32 v[190:191], v[190:191], v[238:239], v[214:215] op_sel:[0,0,0] op_sel_hi:[1,0,1]
v_pk_fma_f32 v[208:209], v[184:185], v[184:185], s[90:91]
v_pk_fma_f32 v[210:211], v[186:187], v[186:187], s[90:91]
v_pk_fma_f32 v[212:213], v[188:189], v[188:189], s[90:91]
v_pk_fma_f32 v[214:215], v[190:191], v[190:191], s[90:91]
v_pk_mul_f32 v[208:209], v[208:209], v[184:185]
v_pk_mul_f32 v[210:211], v[210:211], v[186:187]
v_pk_mul_f32 v[212:213], v[212:213], v[188:189]
v_pk_mul_f32 v[214:215], v[214:215], v[190:191]
v_exp_f32_e64 v208, -v208
v_exp_f32_e64 v210, -v210
v_exp_f32_e64 v212, -v212
v_exp_f32_e64 v214, -v214
v_exp_f32_e64 v209, -v209
v_exp_f32_e64 v211, -v211
v_exp_f32_e64 v213, -v213
v_exp_f32_e64 v215, -v215
v_pk_fma_f32 v[208:209], v[208:209], s[92:93], s[92:93]
v_pk_fma_f32 v[210:211], v[210:211], s[92:93], s[92:93]
v_pk_fma_f32 v[212:213], v[212:213], s[92:93], s[92:93]
v_pk_fma_f32 v[214:215], v[214:215], s[92:93], s[92:93]
v_rcp_f32_e64 v208, v208
v_rcp_f32_e64 v210, v210
v_rcp_f32_e64 v212, v212
v_rcp_f32_e64 v214, v214
v_rcp_f32_e64 v209, v209
v_rcp_f32_e64 v211, v211
v_rcp_f32_e64 v213, v213
v_rcp_f32_e64 v215, v215
v_pk_mul_f32 v[184:185], v[184:185], v[208:209]
v_pk_mul_f32 v[186:187], v[186:187], v[210:211]
v_pk_mul_f32 v[188:189], v[188:189], v[212:213]
v_pk_mul_f32 v[190:191], v[190:191], v[214:215]
v_cvt_pk_bf16_f32 v184, v184, v185
v_cvt_pk_bf16_f32 v185, v186, v187
v_cvt_pk_bf16_f32 v186, v188, v189
v_cvt_pk_bf16_f32 v187, v190, v191
buffer_store_dwordx4 v[184:187], v255, s[28:31], s65 offen offset:3072 sc1
s_lshl_b32 s59, s51, 8
s_add_u32 s59, s59, 73728
s_lshl_b32 s56, s52, 2
s_add_u32 s56, s56, s48
s_lshl_b32 s56, s56, 2
s_add_u32 s56, s56, s59
s_waitcnt vmcnt(0)
s_mov_b64 exec, 1
v_mov_b32 v243, 1
s_cmp_lg_u32 s46, 0
s_cbranch_scc1 SG40
buffer_store_dword v243, off, s[28:31], s56
s_branch SG39
SG40:
buffer_wbl2 sc1
s_waitcnt vmcnt(0)
buffer_store_dword v243, off, s[28:31], s56 sc1
SG39:
s_mov_b64 exec, -1
ID35:
s_mul_i32 s54, s49, 229376
s_mul_i32 s55, s48, 14336
s_add_u32 s54, s54, s55
s_add_u32 s54, s54, 11534336
s_add_u32 s55, s48, 0
s_and_b32 s55, s55, 3
s_mul_i32 s55, s55, 57344
s_add_u32 s62, s54, s55
s_add_u32 s55, s48, 1
s_and_b32 s55, s55, 3
s_mul_i32 s55, s55, 57344
s_add_u32 s63, s54, s55
s_add_u32 s55, s48, 2
s_and_b32 s55, s55, 3
s_mul_i32 s55, s55, 57344
s_add_u32 s64, s54, s55
s_add_u32 s55, s48, 3
s_and_b32 s55, s55, 3
s_mul_i32 s55, s55, 57344
s_add_u32 s65, s54, s55
s_mul_i32 s54, s48, 14
s_lshr_b32 s54, s54, 2
s_lshl_b32 s54, s54, 4
s_and_b32 s55, s49, 1
s_lshl_b32 s55, s55, 3
s_add_u32 s54, s54, s55
s_lshl_b32 s55, s51, 8
s_add_u32 s54, s54, s55
s_add_u32 s54, s54, 73728
s_mov_b32 s88, s54
v_bfe_u32 v228, v255, 4, 4
v_lshrrev_b32 v229, 6, v255
v_and_b32 v229, 12, v229
v_sub_u32 v228, v228, v229
v_cmp_gt_u32 vcc, 4, v228
v_mov_b32 v222, 0x3f80
v_mov_b32 v223, 0
v_lshlrev_b32 v228, 4, v228
v_cndmask_b32 v222, 0, v222, vcc
v_lshlrev_b64 v[222:223], v228, v[222:223]
s_mov_b32 s89, 161792
v_lshl_add_u32 v229, v229, 2, s89
ds_read_b128 v[128:131], v229 offset:0
ds_read_b128 v[132:135], v229 offset:64
ds_read_b128 v[136:139], v229 offset:128
ds_read_b128 v[140:143], v229 offset:192
s_add_u32 s54, s48, 1
s_and_b32 s54, s54, 3
s_mul_i32 s54, s54, 6144
s_add_u32 s54, s54, 131072
v_add_u32 v225, s54, v255
s_add_u32 s54, s48, 2
s_and_b32 s54, s54, 3
s_mul_i32 s54, s54, 6144
s_add_u32 s54, s54, 133120
v_add_u32 v226, s54, v255
s_add_u32 s54, s48, 3
s_and_b32 s54, s54, 3
s_mul_i32 s54, s54, 6144
s_add_u32 s54, s54, 135168
v_add_u32 v227, s54, v255
s_mul_i32 s54, s48, 6144
s_add_u32 s54, s54, 131072
v_add_u32 v224, s54, v255
v_bfe_u32 v231, v255, 5, 2
v_lshlrev_b32 v231, 4, v231
v_bfe_u32 v230, v255, 4, 1
v_lshl_add_u32 v231, v230, 2, v231
s_waitcnt lgkmcnt(0)
v_mfma_f32_16x16x16_bf16 v[128:131], v[222:223], v[244:245], v[128:131]
v_mfma_f32_16x16x16_bf16 v[132:135], v[222:223], v[246:247], v[132:135]
v_mfma_f32_16x16x16_bf16 v[136:139], v[222:223], v[248:249], v[136:139]
v_mfma_f32_16x16x16_bf16 v[140:143], v[222:223], v[250:251], v[140:143]
s_mov_b32 s57, 100000
PL41:
buffer_load_dword v230, v231, s[28:31], s88 offen sc1
s_waitcnt vmcnt(0)
v_cmp_ne_u32 vcc, 1, v230
s_sub_u32 s57, s57, 1
s_nop 3
s_cbranch_vccz PL42
s_cmp_lg_u32 s57, 0
s_cbranch_scc1 PL41
PL42:
buffer_load_dwordx4 v[0:3], v255, s[28:31], s62 offen offset:0 sc1
buffer_load_dwordx4 v[4:7], v255, s[28:31], s63 offen offset:0 sc1
buffer_load_dwordx4 v[8:11], v255, s[28:31], s64 offen offset:0 sc1
buffer_load_dwordx4 v[12:15], v255, s[28:31], s65 offen offset:0 sc1
buffer_load_dwordx4 v[16:19], v255, s[28:31], s62 offen offset:1024 sc1
buffer_load_dwordx4 v[20:23], v255, s[28:31], s63 offen offset:1024 sc1
buffer_load_dwordx4 v[24:27], v255, s[28:31], s64 offen offset:1024 sc1
buffer_load_dwordx4 v[28:31], v255, s[28:31], s65 offen offset:1024 sc1
buffer_load_dwordx4 v[32:35], v255, s[28:31], s62 offen offset:2048 sc1
buffer_load_dwordx4 v[36:39], v255, s[28:31], s63 offen offset:2048 sc1
buffer_load_dwordx4 v[40:43], v255, s[28:31], s64 offen offset:2048 sc1
buffer_load_dwordx4 v[44:47], v255, s[28:31], s65 offen offset:2048 sc1
buffer_load_dwordx4 v[48:51], v255, s[28:31], s62 offen offset:3072 sc1
buffer_load_dwordx4 v[52:55], v255, s[28:31], s63 offen offset:3072 sc1
buffer_load_dwordx4 v[56:59], v255, s[28:31], s64 offen offset:3072 sc1
buffer_load_dwordx4 v[60:63], v255, s[28:31], s65 offen offset:3072 sc1
s_add_u32 s62, s62, 4096
s_add_u32 s63, s63, 4096
s_add_u32 s64, s64, 4096
s_add_u32 s65, s65, 4096
buffer_load_dwordx4 v[64:67], v255, s[28:31], s62 offen offset:0 sc1
buffer_load_dwordx4 v[68:71], v255, s[28:31], s63 offen offset:0 sc1
buffer_load_dwordx4 v[72:75], v255, s[28:31], s64 offen offset:0 sc1
buffer_load_dwordx4 v[76:79], v255, s[28:31], s65 offen offset:0 sc1
s_waitcnt vmcnt(19)
v_mfma_f32_16x16x32_bf16 v[128:131], a[0:3], v[0:3], v[128:131]
v_mfma_f32_16x16x32_bf16 v[132:135], a[4:7], v[0:3], v[132:135]
buffer_load_dwordx4 v[80:83], v255, s[28:31], s62 offen offset:1024 sc1
v_mfma_f32_16x16x32_bf16 v[136:139], a[8:11], v[0:3], v[136:139]
v_mfma_f32_16x16x32_bf16 v[140:143], a[12:15], v[0:3], v[140:143]
buffer_load_dwordx4 v[84:87], v255, s[28:31], s63 offen offset:1024 sc1
s_waitcnt vmcnt(20)
v_mfma_f32_16x16x32_bf16 v[144:147], a[0:3], v[4:7], 0
v_mfma_f32_16x16x32_bf16 v[148:151], a[4:7], v[4:7], 0
buffer_load_dwordx4 v[88:91], v255, s[28:31], s64 offen offset:1024 sc1
v_mfma_f32_16x16x32_bf16 v[152:155], a[8:11], v[4:7], 0
v_mfma_f32_16x16x32_bf16 v[156:159], a[12:15], v[4:7], 0
buffer_load_dwordx4 v[92:95], v255, s[28:31], s65 offen offset:1024 sc1
s_waitcnt vmcnt(21)
v_mfma_f32_16x16x32_bf16 v[160:163], a[0:3], v[8:11], 0
v_mfma_f32_16x16x32_bf16 v[164:167], a[4:7], v[8:11], 0
buffer_load_dwordx4 v[96:99], v255, s[28:31], s62 offen offset:2048 sc1
v_mfma_f32_16x16x32_bf16 v[168:171], a[8:11], v[8:11], 0
v_mfma_f32_16x16x32_bf16 v[172:175], a[12:15], v[8:11], 0
buffer_load_dwordx4 v[100:103], v255, s[28:31], s63 offen offset:2048 sc1
s_waitcnt vmcnt(22)
v_mfma_f32_16x16x32_bf16 v[176:179], a[0:3], v[12:15], 0
v_mfma_f32_16x16x32_bf16 v[180:183], a[4:7], v[12:15], 0
buffer_load_dwordx4 v[104:107], v255, s[28:31], s64 offen offset:2048 sc1
v_mfma_f32_16x16x32_bf16 v[184:187], a[8:11], v[12:15], 0
v_mfma_f32_16x16x32_bf16 v[188:191], a[12:15], v[12:15], 0
buffer_load_dwordx4 v[108:111], v255, s[28:31], s65 offen offset:2048 sc1
s_waitcnt vmcnt(23)
v_mfma_f32_16x16x32_bf16 v[128:131], a[16:19], v[16:19], v[128:131]
v_mfma_f32_16x16x32_bf16 v[132:135], a[20:23], v[16:19], v[132:135]
buffer_load_dwordx4 v[112:115], v255, s[28:31], s62 offen offset:3072 sc1
v_mfma_f32_16x16x32_bf16 v[136:139], a[24:27], v[16:19], v[136:139]
v_mfma_f32_16x16x32_bf16 v[140:143], a[28:31], v[16:19], v[140:143]
buffer_load_dwordx4 v[116:119], v255, s[28:31], s63 offen offset:3072 sc1
s_waitcnt vmcnt(24)
v_mfma_f32_16x16x32_bf16 v[144:147], a[16:19], v[20:23], v[144:147]
v_mfma_f32_16x16x32_bf16 v[148:151], a[20:23], v[20:23], v[148:151]
buffer_load_dwordx4 v[120:123], v255, s[28:31], s64 offen offset:3072 sc1
v_mfma_f32_16x16x32_bf16 v[152:155], a[24:27], v[20:23], v[152:155]
v_mfma_f32_16x16x32_bf16 v[156:159], a[28:31], v[20:23], v[156:159]
buffer_load_dwordx4 v[124:127], v255, s[28:31], s65 offen offset:3072 sc1
s_waitcnt vmcnt(25)
v_mfma_f32_16x16x32_bf16 v[160:163], a[16:19], v[24:27], v[160:163]
v_mfma_f32_16x16x32_bf16 v[164:167], a[20:23], v[24:27], v[164:167]
s_add_u32 s62, s62, 4096
s_add_u32 s63, s63, 4096
s_add_u32 s64, s64, 4096
s_add_u32 s65, s65, 4096
buffer_load_dwordx4 v[0:3], v255, s[28:31], s62 offen offset:0 sc1
v_mfma_f32_16x16x32_bf16 v[168:171], a[24:27], v[24:27], v[168:171]
v_mfma_f32_16x16x32_bf16 v[172:175], a[28:31], v[24:27], v[172:175]
buffer_load_dwordx4 v[4:7], v255, s[28:31], s63 offen offset:0 sc1
s_waitcnt vmcnt(26)
v_mfma_f32_16x16x32_bf16 v[176:179], a[16:19], v[28:31], v[176:179]
v_mfma_f32_16x16x32_bf16 v[180:183], a[20:23], v[28:31], v[180:183]
buffer_load_dwordx4 v[8:11], v255, s[28:31], s64 offen offset:0 sc1
v_mfma_f32_16x16x32_bf16 v[184:187], a[24:27], v[28:31], v[184:187]
v_mfma_f32_16x16x32_bf16 v[188:191], a[28:31], v[28:31], v[188:191]
buffer_load_dwordx4 v[12:15], v255, s[28:31], s65 offen offset:0 sc1
s_waitcnt vmcnt(27)
v_mfma_f32_16x16x32_bf16 v[128:131], a[32:35], v[32:35], v[128:131]
v_mfma_f32_16x16x32_bf16 v[132:135], a[36:39], v[32:35], v[132:135]
buffer_load_dwordx4 v[16:19], v255, s[28:31], s62 offen offset:1024 sc1
v_mfma_f32_16x16x32_bf16 v[136:139], a[40:43], v[32:35], v[136:139]
v_mfma_f32_16x16x32_bf16 v[140:143], a[44:47], v[32:35], v[140:143]
buffer_load_dwordx4 v[20:23], v255, s[28:31], s63 offen offset:1024 sc1
s_waitcnt vmcnt(28)
v_mfma_f32_16x16x32_bf16 v[144:147], a[32:35], v[36:39], v[144:147]
v_mfma_f32_16x16x32_bf16 v[148:151], a[36:39], v[36:39], v[148:151]
buffer_load_dwordx4 v[24:27], v255, s[28:31], s64 offen offset:1024 sc1
v_mfma_f32_16x16x32_bf16 v[152:155], a[40:43], v[36:39], v[152:155]
v_mfma_f32_16x16x32_bf16 v[156:159], a[44:47], v[36:39], v[156:159]
buffer_load_dwordx4 v[28:31], v255, s[28:31], s65 offen offset:1024 sc1
s_waitcnt vmcnt(29)
v_mfma_f32_16x16x32_bf16 v[160:163], a[32:35], v[40:43], v[160:163]
v_mfma_f32_16x16x32_bf16 v[164:167], a[36:39], v[40:43], v[164:167]
buffer_load_dwordx4 v[32:35], v255, s[28:31], s62 offen offset:2048 sc1
v_mfma_f32_16x16x32_bf16 v[168:171], a[40:43], v[40:43], v[168:171]
v_mfma_f32_16x16x32_bf16 v[172:175], a[44:47], v[40:43], v[172:175]
buffer_load_dwordx4 v[36:39], v255, s[28:31], s63 offen offset:2048 sc1
s_waitcnt vmcnt(30)
v_mfma_f32_16x16x32_bf16 v[176:179], a[32:35], v[44:47], v[176:179]
v_mfma_f32_16x16x32_bf16 v[180:183], a[36:39], v[44:47], v[180:183]
buffer_load_dwordx4 v[40:43], v255, s[28:31], s64 offen offset:2048 sc1
v_mfma_f32_16x16x32_bf16 v[184:187], a[40:43], v[44:47], v[184:187]
v_mfma_f32_16x16x32_bf16 v[188:191], a[44:47], v[44:47], v[188:191]
s_waitcnt vmcnt(30)
v_mfma_f32_16x16x32_bf16 v[128:131], a[48:51], v[48:51], v[128:131]
v_mfma_f32_16x16x32_bf16 v[132:135], a[52:55], v[48:51], v[132:135]
buffer_load_dwordx4 v[44:47], v255, s[28:31], s65 offen offset:2048 sc1
v_mfma_f32_16x16x32_bf16 v[136:139], a[56:59], v[48:51], v[136:139]
v_mfma_f32_16x16x32_bf16 v[140:143], a[60:63], v[48:51], v[140:143]
s_waitcnt vmcnt(30)
v_mfma_f32_16x16x32_bf16 v[144:147], a[48:51], v[52:55], v[144:147]
v_mfma_f32_16x16x32_bf16 v[148:151], a[52:55], v[52:55], v[148:151]
buffer_load_dwordx4 v[48:51], v255, s[28:31], s62 offen offset:3072 sc1
v_mfma_f32_16x16x32_bf16 v[152:155], a[56:59], v[52:55], v[152:155]
v_mfma_f32_16x16x32_bf16 v[156:159], a[60:63], v[52:55], v[156:159]
s_waitcnt vmcnt(30)
v_mfma_f32_16x16x32_bf16 v[160:163], a[48:51], v[56:59], v[160:163]
v_mfma_f32_16x16x32_bf16 v[164:167], a[52:55], v[56:59], v[164:167]
buffer_load_dwordx4 v[52:55], v255, s[28:31], s63 offen offset:3072 sc1
v_mfma_f32_16x16x32_bf16 v[168:171], a[56:59], v[56:59], v[168:171]
v_mfma_f32_16x16x32_bf16 v[172:175], a[60:63], v[56:59], v[172:175]
s_waitcnt vmcnt(30)
v_mfma_f32_16x16x32_bf16 v[176:179], a[48:51], v[60:63], v[176:179]
v_mfma_f32_16x16x32_bf16 v[180:183], a[52:55], v[60:63], v[180:183]
buffer_load_dwordx4 v[56:59], v255, s[28:31], s64 offen offset:3072 sc1
v_mfma_f32_16x16x32_bf16 v[184:187], a[56:59], v[60:63], v[184:187]
v_mfma_f32_16x16x32_bf16 v[188:191], a[60:63], v[60:63], v[188:191]
s_waitcnt vmcnt(30)
v_mfma_f32_16x16x32_bf16 v[128:131], a[64:67], v[64:67], v[128:131]
v_mfma_f32_16x16x32_bf16 v[132:135], a[68:71], v[64:67], v[132:135]
buffer_load_dwordx4 v[60:63], v255, s[28:31], s65 offen offset:3072 sc1
v_mfma_f32_16x16x32_bf16 v[136:139], a[72:75], v[64:67], v[136:139]
v_mfma_f32_16x16x32_bf16 v[140:143], a[76:79], v[64:67], v[140:143]
s_waitcnt vmcnt(30)
v_mfma_f32_16x16x32_bf16 v[144:147], a[64:67], v[68:71], v[144:147]
v_mfma_f32_16x16x32_bf16 v[148:151], a[68:71], v[68:71], v[148:151]
s_add_u32 s62, s62, 4096
s_add_u32 s63, s63, 4096
s_add_u32 s64, s64, 4096
s_add_u32 s65, s65, 4096
buffer_load_dwordx4 v[64:67], v255, s[28:31], s62 offen offset:0 sc1
v_mfma_f32_16x16x32_bf16 v[152:155], a[72:75], v[68:71], v[152:155]
v_mfma_f32_16x16x32_bf16 v[156:159], a[76:79], v[68:71], v[156:159]
s_waitcnt vmcnt(30)
v_mfma_f32_16x16x32_bf16 v[160:163], a[64:67], v[72:75], v[160:163]
v_mfma_f32_16x16x32_bf16 v[164:167], a[68:71], v[72:75], v[164:167]
buffer_load_dwordx4 v[68:71], v255, s[28:31], s63 offen offset:0 sc1
v_mfma_f32_16x16x32_bf16 v[168:171], a[72:75], v[72:75], v[168:171]
v_mfma_f32_16x16x32_bf16 v[172:175], a[76:79], v[72:75], v[172:175]
s_waitcnt vmcnt(30)
v_mfma_f32_16x16x32_bf16 v[176:179], a[64:67], v[76:79], v[176:179]
v_mfma_f32_16x16x32_bf16 v[180:183], a[68:71], v[76:79], v[180:183]
buffer_load_dwordx4 v[72:75], v255, s[28:31], s64 offen offset:0 sc1
v_mfma_f32_16x16x32_bf16 v[184:187], a[72:75], v[76:79], v[184:187]
v_mfma_f32_16x16x32_bf16 v[188:191], a[76:79], v[76:79], v[188:191]
s_waitcnt vmcnt(30)
v_mfma_f32_16x16x32_bf16 v[128:131], a[80:83], v[80:83], v[128:131]
v_mfma_f32_16x16x32_bf16 v[132:135], a[84:87], v[80:83], v[132:135]
buffer_load_dwordx4 v[76:79], v255, s[28:31], s65 offen offset:0 sc1
v_mfma_f32_16x16x32_bf16 v[136:139], a[88:91], v[80:83], v[136:139]
v_mfma_f32_16x16x32_bf16 v[140:143], a[92:95], v[80:83], v[140:143]
s_waitcnt vmcnt(30)
v_mfma_f32_16x16x32_bf16 v[144:147], a[80:83], v[84:87], v[144:147]
v_mfma_f32_16x16x32_bf16 v[148:151], a[84:87], v[84:87], v[148:151]
buffer_load_dwordx4 v[80:83], v255, s[28:31], s62 offen offset:1024 sc1
v_mfma_f32_16x16x32_bf16 v[152:155], a[88:91], v[84:87], v[152:155]
v_mfma_f32_16x16x32_bf16 v[156:159], a[92:95], v[84:87], v[156:159]
s_waitcnt vmcnt(30)
v_mfma_f32_16x16x32_bf16 v[160:163], a[80:83], v[88:91], v[160:163]
v_mfma_f32_16x16x32_bf16 v[164:167], a[84:87], v[88:91], v[164:167]
buffer_load_dwordx4 v[84:87], v255, s[28:31], s63 offen offset:1024 sc1
v_mfma_f32_16x16x32_bf16 v[168:171], a[88:91], v[88:91], v[168:171]
v_mfma_f32_16x16x32_bf16 v[172:175], a[92:95], v[88:91], v[172:175]
s_waitcnt vmcnt(30)
v_mfma_f32_16x16x32_bf16 v[176:179], a[80:83], v[92:95], v[176:179]
v_mfma_f32_16x16x32_bf16 v[180:183], a[84:87], v[92:95], v[180:183]
buffer_load_dwordx4 v[88:91], v255, s[28:31], s64 offen offset:1024 sc1
v_mfma_f32_16x16x32_bf16 v[184:187], a[88:91], v[92:95], v[184:187]
v_mfma_f32_16x16x32_bf16 v[188:191], a[92:95], v[92:95], v[188:191]
s_waitcnt vmcnt(30)
v_mfma_f32_16x16x32_bf16 v[128:131], a[96:99], v[96:99], v[128:131]
v_mfma_f32_16x16x32_bf16 v[132:135], a[100:103], v[96:99], v[132:135]
buffer_load_dwordx4 v[92:95], v255, s[28:31], s65 offen offset:1024 sc1
v_mfma_f32_16x16x32_bf16 v[136:139], a[104:107], v[96:99], v[136:139]
v_mfma_f32_16x16x32_bf16 v[140:143], a[108:111], v[96:99], v[140:143]
s_waitcnt vmcnt(30)
v_mfma_f32_16x16x32_bf16 v[144:147], a[96:99], v[100:103], v[144:147]
v_mfma_f32_16x16x32_bf16 v[148:151], a[100:103], v[100:103], v[148:151]
v_mfma_f32_16x16x32_bf16 v[152:155], a[104:107], v[100:103], v[152:155]
v_mfma_f32_16x16x32_bf16 v[156:159], a[108:111], v[100:103], v[156:159]
s_waitcnt vmcnt(29)
v_mfma_f32_16x16x32_bf16 v[160:163], a[96:99], v[104:107], v[160:163]
v_mfma_f32_16x16x32_bf16 v[164:167], a[100:103], v[104:107], v[164:167]
v_mfma_f32_16x16x32_bf16 v[168:171], a[104:107], v[104:107], v[168:171]
v_mfma_f32_16x16x32_bf16 v[172:175], a[108:111], v[104:107], v[172:175]
s_waitcnt vmcnt(28)
v_mfma_f32_16x16x32_bf16 v[176:179], a[96:99], v[108:111], v[176:179]
v_mfma_f32_16x16x32_bf16 v[180:183], a[100:103], v[108:111], v[180:183]
v_mfma_f32_16x16x32_bf16 v[184:187], a[104:107], v[108:111], v[184:187]
v_mfma_f32_16x16x32_bf16 v[188:191], a[108:111], v[108:111], v[188:191]
s_waitcnt vmcnt(27)
v_mfma_f32_16x16x32_bf16 v[128:131], a[112:115], v[112:115], v[128:131]
v_mfma_f32_16x16x32_bf16 v[132:135], a[116:119], v[112:115], v[132:135]
v_mfma_f32_16x16x32_bf16 v[136:139], a[120:123], v[112:115], v[136:139]
v_mfma_f32_16x16x32_bf16 v[140:143], a[124:127], v[112:115], v[140:143]
s_waitcnt vmcnt(26)
v_mfma_f32_16x16x32_bf16 v[144:147], a[112:115], v[116:119], v[144:147]
v_mfma_f32_16x16x32_bf16 v[148:151], a[116:119], v[116:119], v[148:151]
v_mfma_f32_16x16x32_bf16 v[152:155], a[120:123], v[116:119], v[152:155]
v_mfma_f32_16x16x32_bf16 v[156:159], a[124:127], v[116:119], v[156:159]
s_waitcnt vmcnt(25)
v_mfma_f32_16x16x32_bf16 v[160:163], a[112:115], v[120:123], v[160:163]
v_mfma_f32_16x16x32_bf16 v[164:167], a[116:119], v[120:123], v[164:167]
v_mfma_f32_16x16x32_bf16 v[168:171], a[120:123], v[120:123], v[168:171]
v_mfma_f32_16x16x32_bf16 v[172:175], a[124:127], v[120:123], v[172:175]
s_waitcnt vmcnt(24)
v_mfma_f32_16x16x32_bf16 v[176:179], a[112:115], v[124:127], v[176:179]
v_mfma_f32_16x16x32_bf16 v[180:183], a[116:119], v[124:127], v[180:183]
v_mfma_f32_16x16x32_bf16 v[184:187], a[120:123], v[124:127], v[184:187]
v_mfma_f32_16x16x32_bf16 v[188:191], a[124:127], v[124:127], v[188:191]
s_waitcnt vmcnt(23)
v_mfma_f32_16x16x32_bf16 v[128:131], a[128:131], v[0:3], v[128:131]
v_mfma_f32_16x16x32_bf16 v[132:135], a[132:135], v[0:3], v[132:135]
v_mfma_f32_16x16x32_bf16 v[136:139], a[136:139], v[0:3], v[136:139]
v_mfma_f32_16x16x32_bf16 v[140:143], a[140:143], v[0:3], v[140:143]
s_waitcnt vmcnt(22)
v_mfma_f32_16x16x32_bf16 v[144:147], a[128:131], v[4:7], v[144:147]
v_mfma_f32_16x16x32_bf16 v[148:151], a[132:135], v[4:7], v[148:151]
v_mfma_f32_16x16x32_bf16 v[152:155], a[136:139], v[4:7], v[152:155]
v_mfma_f32_16x16x32_bf16 v[156:159], a[140:143], v[4:7], v[156:159]
s_waitcnt vmcnt(21)
v_mfma_f32_16x16x32_bf16 v[160:163], a[128:131], v[8:11], v[160:163]
v_mfma_f32_16x16x32_bf16 v[164:167], a[132:135], v[8:11], v[164:167]
v_mfma_f32_16x16x32_bf16 v[168:171], a[136:139], v[8:11], v[168:171]
v_mfma_f32_16x16x32_bf16 v[172:175], a[140:143], v[8:11], v[172:175]
s_waitcnt vmcnt(20)
v_mfma_f32_16x16x32_bf16 v[176:179], a[128:131], v[12:15], v[176:179]
v_mfma_f32_16x16x32_bf16 v[180:183], a[132:135], v[12:15], v[180:183]
v_mfma_f32_16x16x32_bf16 v[184:187], a[136:139], v[12:15], v[184:187]
v_mfma_f32_16x16x32_bf16 v[188:191], a[140:143], v[12:15], v[188:191]
s_waitcnt vmcnt(19)
v_mfma_f32_16x16x32_bf16 v[128:131], a[144:147], v[16:19], v[128:131]
v_mfma_f32_16x16x32_bf16 v[132:135], a[148:151], v[16:19], v[132:135]
v_mfma_f32_16x16x32_bf16 v[136:139], a[152:155], v[16:19], v[136:139]
v_mfma_f32_16x16x32_bf16 v[140:143], a[156:159], v[16:19], v[140:143]
s_waitcnt vmcnt(18)
v_mfma_f32_16x16x32_bf16 v[144:147], a[144:147], v[20:23], v[144:147]
v_mfma_f32_16x16x32_bf16 v[148:151], a[148:151], v[20:23], v[148:151]
v_mfma_f32_16x16x32_bf16 v[152:155], a[152:155], v[20:23], v[152:155]
v_mfma_f32_16x16x32_bf16 v[156:159], a[156:159], v[20:23], v[156:159]
s_waitcnt vmcnt(17)
v_mfma_f32_16x16x32_bf16 v[160:163], a[144:147], v[24:27], v[160:163]
v_mfma_f32_16x16x32_bf16 v[164:167], a[148:151], v[24:27], v[164:167]
v_mfma_f32_16x16x32_bf16 v[168:171], a[152:155], v[24:27], v[168:171]
v_mfma_f32_16x16x32_bf16 v[172:175], a[156:159], v[24:27], v[172:175]
s_waitcnt vmcnt(16)
v_mfma_f32_16x16x32_bf16 v[176:179], a[144:147], v[28:31], v[176:179]
v_mfma_f32_16x16x32_bf16 v[180:183], a[148:151], v[28:31], v[180:183]
v_mfma_f32_16x16x32_bf16 v[184:187], a[152:155], v[28:31], v[184:187]
v_mfma_f32_16x16x32_bf16 v[188:191], a[156:159], v[28:31], v[188:191]
s_waitcnt vmcnt(15)
v_mfma_f32_16x16x32_bf16 v[128:131], a[160:163], v[32:35], v[128:131]
v_mfma_f32_16x16x32_bf16 v[132:135], a[164:167], v[32:35], v[132:135]
v_mfma_f32_16x16x32_bf16 v[136:139], a[168:171], v[32:35], v[136:139]
v_mfma_f32_16x16x32_bf16 v[140:143], a[172:175], v[32:35], v[140:143]
s_waitcnt vmcnt(14)
v_mfma_f32_16x16x32_bf16 v[144:147], a[160:163], v[36:39], v[144:147]
v_mfma_f32_16x16x32_bf16 v[148:151], a[164:167], v[36:39], v[148:151]
v_mfma_f32_16x16x32_bf16 v[152:155], a[168:171], v[36:39], v[152:155]
v_mfma_f32_16x16x32_bf16 v[156:159], a[172:175], v[36:39], v[156:159]
s_waitcnt vmcnt(13)
v_mfma_f32_16x16x32_bf16 v[160:163], a[160:163], v[40:43], v[160:163]
v_mfma_f32_16x16x32_bf16 v[164:167], a[164:167], v[40:43], v[164:167]
v_mfma_f32_16x16x32_bf16 v[168:171], a[168:171], v[40:43], v[168:171]
v_mfma_f32_16x16x32_bf16 v[172:175], a[172:175], v[40:43], v[172:175]
s_waitcnt vmcnt(12)
v_mfma_f32_16x16x32_bf16 v[176:179], a[160:163], v[44:47], v[176:179]
v_mfma_f32_16x16x32_bf16 v[180:183], a[164:167], v[44:47], v[180:183]
v_mfma_f32_16x16x32_bf16 v[184:187], a[168:171], v[44:47], v[184:187]
v_mfma_f32_16x16x32_bf16 v[188:191], a[172:175], v[44:47], v[188:191]
s_waitcnt vmcnt(11)
v_mfma_f32_16x16x32_bf16 v[128:131], a[176:179], v[48:51], v[128:131]
v_mfma_f32_16x16x32_bf16 v[132:135], a[180:183], v[48:51], v[132:135]
v_mfma_f32_16x16x32_bf16 v[136:139], a[184:187], v[48:51], v[136:139]
v_mfma_f32_16x16x32_bf16 v[140:143], a[188:191], v[48:51], v[140:143]
s_waitcnt vmcnt(10)
v_mfma_f32_16x16x32_bf16 v[144:147], a[176:179], v[52:55], v[144:147]
v_mfma_f32_16x16x32_bf16 v[148:151], a[180:183], v[52:55], v[148:151]
v_mfma_f32_16x16x32_bf16 v[152:155], a[184:187], v[52:55], v[152:155]
v_mfma_f32_16x16x32_bf16 v[156:159], a[188:191], v[52:55], v[156:159]
s_waitcnt vmcnt(9)
v_mfma_f32_16x16x32_bf16 v[160:163], a[176:179], v[56:59], v[160:163]
v_mfma_f32_16x16x32_bf16 v[164:167], a[180:183], v[56:59], v[164:167]
v_mfma_f32_16x16x32_bf16 v[168:171], a[184:187], v[56:59], v[168:171]
v_mfma_f32_16x16x32_bf16 v[172:175], a[188:191], v[56:59], v[172:175]
s_waitcnt vmcnt(8)
v_mfma_f32_16x16x32_bf16 v[176:179], a[176:179], v[60:63], v[176:179]
v_mfma_f32_16x16x32_bf16 v[180:183], a[180:183], v[60:63], v[180:183]
v_mfma_f32_16x16x32_bf16 v[184:187], a[184:187], v[60:63], v[184:187]
v_mfma_f32_16x16x32_bf16 v[188:191], a[188:191], v[60:63], v[188:191]
s_waitcnt vmcnt(7)
v_mfma_f32_16x16x32_bf16 v[128:131], a[192:195], v[64:67], v[128:131]
v_mfma_f32_16x16x32_bf16 v[132:135], a[196:199], v[64:67], v[132:135]
v_mfma_f32_16x16x32_bf16 v[136:139], a[200:203], v[64:67], v[136:139]
v_mfma_f32_16x16x32_bf16 v[140:143], a[204:207], v[64:67], v[140:143]
s_waitcnt vmcnt(6)
v_mfma_f32_16x16x32_bf16 v[144:147], a[192:195], v[68:71], v[144:147]
v_mfma_f32_16x16x32_bf16 v[148:151], a[196:199], v[68:71], v[148:151]
v_mfma_f32_16x16x32_bf16 v[152:155], a[200:203], v[68:71], v[152:155]
v_mfma_f32_16x16x32_bf16 v[156:159], a[204:207], v[68:71], v[156:159]
s_waitcnt vmcnt(5)
v_mfma_f32_16x16x32_bf16 v[160:163], a[192:195], v[72:75], v[160:163]
v_mfma_f32_16x16x32_bf16 v[164:167], a[196:199], v[72:75], v[164:167]
v_mfma_f32_16x16x32_bf16 v[168:171], a[200:203], v[72:75], v[168:171]
v_mfma_f32_16x16x32_bf16 v[172:175], a[204:207], v[72:75], v[172:175]
s_waitcnt vmcnt(4)
v_mfma_f32_16x16x32_bf16 v[176:179], a[192:195], v[76:79], v[176:179]
v_mfma_f32_16x16x32_bf16 v[180:183], a[196:199], v[76:79], v[180:183]
v_mfma_f32_16x16x32_bf16 v[184:187], a[200:203], v[76:79], v[184:187]
v_mfma_f32_16x16x32_bf16 v[188:191], a[204:207], v[76:79], v[188:191]
s_waitcnt vmcnt(3)
v_mfma_f32_16x16x32_bf16 v[128:131], a[208:211], v[80:83], v[128:131]
v_mfma_f32_16x16x32_bf16 v[132:135], a[212:215], v[80:83], v[132:135]
v_mfma_f32_16x16x32_bf16 v[136:139], a[216:219], v[80:83], v[136:139]
v_mfma_f32_16x16x32_bf16 v[140:143], a[220:223], v[80:83], v[140:143]
s_waitcnt vmcnt(2)
v_mfma_f32_16x16x32_bf16 v[144:147], a[208:211], v[84:87], v[144:147]
v_mfma_f32_16x16x32_bf16 v[148:151], a[212:215], v[84:87], v[148:151]
v_mfma_f32_16x16x32_bf16 v[152:155], a[216:219], v[84:87], v[152:155]
v_mfma_f32_16x16x32_bf16 v[156:159], a[220:223], v[84:87], v[156:159]
s_waitcnt vmcnt(1)
v_mfma_f32_16x16x32_bf16 v[160:163], a[208:211], v[88:91], v[160:163]
v_mfma_f32_16x16x32_bf16 v[164:167], a[212:215], v[88:91], v[164:167]
v_mfma_f32_16x16x32_bf16 v[168:171], a[216:219], v[88:91], v[168:171]
v_mfma_f32_16x16x32_bf16 v[172:175], a[220:223], v[88:91], v[172:175]
s_waitcnt vmcnt(0)
v_mfma_f32_16x16x32_bf16 v[176:179], a[208:211], v[92:95], v[176:179]
v_mfma_f32_16x16x32_bf16 v[180:183], a[212:215], v[92:95], v[180:183]
v_mfma_f32_16x16x32_bf16 v[184:187], a[216:219], v[92:95], v[184:187]
v_mfma_f32_16x16x32_bf16 v[188:191], a[220:223], v[92:95], v[188:191]
v_cvt_pk_bf16_f32 v144, v144, v145
v_cvt_pk_bf16_f32 v145, v146, v147
v_cvt_pk_bf16_f32 v146, v148, v149
v_cvt_pk_bf16_f32 v147, v150, v151
ds_write_b128 v225, v[144:147] offset:0
v_cvt_pk_bf16_f32 v152, v152, v153
v_cvt_pk_bf16_f32 v153, v154, v155
v_cvt_pk_bf16_f32 v154, v156, v157
v_cvt_pk_bf16_f32 v155, v158, v159
ds_write_b128 v225, v[152:155] offset:1024
v_cvt_pk_bf16_f32 v160, v160, v161
v_cvt_pk_bf16_f32 v161, v162, v163
v_cvt_pk_bf16_f32 v162, v164, v165
v_cvt_pk_bf16_f32 v163, v166, v167
ds_write_b128 v226, v[160:163] offset:0
v_cvt_pk_bf16_f32 v168, v168, v169
v_cvt_pk_bf16_f32 v169, v170, v171
v_cvt_pk_bf16_f32 v170, v172, v173
v_cvt_pk_bf16_f32 v171, v174, v175
ds_write_b128 v226, v[168:171] offset:1024
v_cvt_pk_bf16_f32 v176, v176, v177
v_cvt_pk_bf16_f32 v177, v178, v179
v_cvt_pk_bf16_f32 v178, v180, v181
v_cvt_pk_bf16_f32 v179, v182, v183
ds_write_b128 v227, v[176:179] offset:0
v_cvt_pk_bf16_f32 v184, v184, v185
v_cvt_pk_bf16_f32 v185, v186, v187
v_cvt_pk_bf16_f32 v186, v188, v189
v_cvt_pk_bf16_f32 v187, v190, v191
ds_write_b128 v227, v[184:187] offset:1024
s_lshl_b32 s54, s49, 2
s_add_u32 s54, s54, s48
v_bfe_u32 v228, v255, 4, 4
v_lshlrev_b32 v228, 10, v228
v_bfe_u32 v229, v255, 8, 1
v_lshl_add_u32 v228, v229, 5, v228
v_bfe_u32 v229, v255, 9, 1
v_lshl_add_u32 v228, v229, 4, v228
s_lshl_b32 s54, s54, 14
s_lshl_b32 s55, s50, 7
s_add_u32 s54, s54, s55
s_waitcnt lgkmcnt(0)
s_barrier
ds_read_b128 v[144:147], v224 offset:0
ds_read_b128 v[148:151], v224 offset:1024
ds_read_b128 v[152:155], v224 offset:2048
ds_read_b128 v[156:159], v224 offset:3072
ds_read_b128 v[160:163], v224 offset:4096
ds_read_b128 v[164:167], v224 offset:5120
s_waitcnt lgkmcnt(5)
v_mfma_f32_16x16x16_bf16 v[128:131], v[222:223], v[144:145], v[128:131]
v_mfma_f32_16x16x16_bf16 v[132:135], v[222:223], v[146:147], v[132:135]
s_waitcnt lgkmcnt(4)
v_mfma_f32_16x16x16_bf16 v[136:139], v[222:223], v[148:149], v[136:139]
v_mfma_f32_16x16x16_bf16 v[140:143], v[222:223], v[150:151], v[140:143]
s_waitcnt lgkmcnt(3)
v_mfma_f32_16x16x16_bf16 v[128:131], v[222:223], v[152:153], v[128:131]
v_mfma_f32_16x16x16_bf16 v[132:135], v[222:223], v[154:155], v[132:135]
s_waitcnt lgkmcnt(2)
v_mfma_f32_16x16x16_bf16 v[136:139], v[222:223], v[156:157], v[136:139]
v_mfma_f32_16x16x16_bf16 v[140:143], v[222:223], v[158:159], v[140:143]
s_waitcnt lgkmcnt(1)
v_mfma_f32_16x16x16_bf16 v[128:131], v[222:223], v[160:161], v[128:131]
v_mfma_f32_16x16x16_bf16 v[132:135], v[222:223], v[162:163], v[132:135]
s_waitcnt lgkmcnt(0)
v_mfma_f32_16x16x16_bf16 v[136:139], v[222:223], v[164:165], v[136:139]
v_mfma_f32_16x16x16_bf16 v[140:143], v[222:223], v[166:167], v[140:143]
s_nop 3
v_cvt_pk_bf16_f32 v244, v128, v129
v_cvt_pk_bf16_f32 v245, v130, v131
v_cvt_pk_bf16_f32 v246, v132, v133
v_cvt_pk_bf16_f32 v247, v134, v135
s_nop 0
v_permlane16_swap_b32 v244, v246
v_permlane16_swap_b32 v245, v247
buffer_store_dwordx4 v[244:247], v228, s[32:35], s54 offen offset:0 sc1
v_cvt_pk_bf16_f32 v248, v136, v137
v_cvt_pk_bf16_f32 v249, v138, v139
v_cvt_pk_bf16_f32 v250, v140, v141
v_cvt_pk_bf16_f32 v251, v142, v143
s_nop 0
v_permlane16_swap_b32 v248, v250
v_permlane16_swap_b32 v249, v251
buffer_store_dwordx4 v[248:251], v228, s[32:35], s54 offen offset:64 sc1
s_waitcnt vmcnt(0)
Lend:
s_endpgm
.section .rodata,"a"
.p2align 6
.amdhsa_kernel interleave_layers__linear_attn_block__mixer_channel_mlp__prompt_kernel
  .amdhsa_next_free_vgpr 512
  .amdhsa_next_free_sgpr 102
  .amdhsa_accum_offset 256
  .amdhsa_group_segment_fixed_size 0
  .amdhsa_kernarg_size 88
  .amdhsa_user_sgpr_count 2
  .amdhsa_user_sgpr_kernarg_segment_ptr 1
  .amdhsa_system_sgpr_workgroup_id_x 1
.end_amdhsa_kernel
```
